```python
import torch

def _softmax(x, axis=-1):
    return torch.softmax(x, dim=axis)

def _gelu(x):
    return torch.nn.functional.gelu(x, approximate='tanh')

def _silu(x):
    return torch.nn.functional.silu(x)

def _sigmoid(x):
    return torch.sigmoid(x)

def _layernorm(x, axis=-1, eps=1e-05):
    m = x.mean(dim=axis, keepdim=True)
    v = x.var(dim=axis, keepdim=True, unbiased=False)
    return (x - m) / torch.sqrt(v + eps)

def _scatter_add(tgt, idx, src, axis=0):
    return tgt.clone().index_add_(axis, idx, src)

def _segment_sum(src, seg, n):
    out = torch.zeros((n,) + src.shape[1:], dtype=src.dtype)
    return out.index_add_(0, seg, src)

def _pad(x, pw):
    flat = tuple((v for pair in reversed(pw) for v in pair))
    return torch.nn.functional.pad(x, flat)
kernel_name = 'gated_mix__memory_aug_recurrent_mem_tr__memory_aug_recurrent_mem_tr__prompt'

def setup_inputs():

    _w = lambda a: (lambda t: t.to(torch.bfloat16) if t.is_floating_point() else t)(torch.as_tensor(a))

    def _A_setup():
        B, S, Dm = (1, 2048, 576)
        H, Dh = (32, 128)
        M, seg = (8, 32)
        seg = min(seg, S)
        S = S // seg * seg
        return {'x': _w((lambda *s: torch.randn(*s, dtype=torch.bfloat16) * 0.05)(B, S, Dm)), 'mem0': _w((lambda *s: torch.randn(*s, dtype=torch.bfloat16) * 0.4)(B, M, Dm)), 'Wq': _w((lambda *s: torch.randn(*s, dtype=torch.bfloat16) * 6.4)(Dm, H, Dh) * Dm ** (-0.5)), 'Wk': _w((lambda *s: torch.randn(*s, dtype=torch.bfloat16) * 6.4)(Dm, H, Dh) * Dm ** (-0.5)), 'Wv': _w((lambda *s: torch.randn(*s, dtype=torch.bfloat16) * 0.4)(Dm, H, Dh) * Dm ** (-0.5)), 'Wo': _w((lambda *s: torch.randn(*s, dtype=torch.bfloat16) * 0.4)(H, Dh, Dm) * (H * Dh) ** (-0.5)), 'seg_len': seg}
    _A_in = _A_setup()

    def _B_setup():
        B, S, Dm = (1, 2048, 576)
        H, Dh = (32, 128)
        M, seg = (8, 32)
        seg = min(seg, S)
        S = S // seg * seg
        return {'x': _w((lambda *s: torch.randn(*s, dtype=torch.bfloat16) * 0.05)(B, S, Dm)), 'mem0': _w((lambda *s: torch.randn(*s, dtype=torch.bfloat16) * 0.4)(B, M, Dm)), 'Wq': _w((lambda *s: torch.randn(*s, dtype=torch.bfloat16) * 6.4)(Dm, H, Dh) * Dm ** (-0.5)), 'Wk': _w((lambda *s: torch.randn(*s, dtype=torch.bfloat16) * 6.4)(Dm, H, Dh) * Dm ** (-0.5)), 'Wv': _w((lambda *s: torch.randn(*s, dtype=torch.bfloat16) * 0.4)(Dm, H, Dh) * Dm ** (-0.5)), 'Wo': _w((lambda *s: torch.randn(*s, dtype=torch.bfloat16) * 0.4)(H, Dh, Dm) * (H * Dh) ** (-0.5)), 'seg_len': seg}
    _B_in = _B_setup()
    return {'A_x': _A_in['x'], 'A_mem0': _A_in['mem0'], 'A_Wq': _A_in['Wq'], 'A_Wk': _A_in['Wk'], 'A_Wv': _A_in['Wv'], 'A_Wo': _A_in['Wo'], 'A_seg_len': _A_in['seg_len'], 'B_x': _B_in['x'], 'B_mem0': _B_in['mem0'], 'B_Wq': _B_in['Wq'], 'B_Wk': _B_in['Wk'], 'B_Wv': _B_in['Wv'], 'B_Wo': _B_in['Wo'], 'B_seg_len': _B_in['seg_len'], 'gate_w': _w((lambda *s: torch.randn(*s, dtype=torch.bfloat16) * 0.05)(576) * 16.0)}

def reference(A_x, A_mem0, A_Wq, A_Wk, A_Wv, A_Wo, A_seg_len, B_x, B_mem0, B_Wq, B_Wk, B_Wv, B_Wo, B_seg_len, gate_w):

    def _A_ref(x, mem0, Wq, Wk, Wv, Wo, seg_len):
        B, S, Dm = x.shape
        H, Dh = (Wq.shape[1], Wq.shape[2])
        M = mem0.shape[1]
        scale = Dh ** (-0.5)
        n_seg = S // seg_len
        L = M + seg_len
        idx = torch.arange(L)
        mask = (idx[:, None] < M) | (idx[:, None] >= idx[None, :])
        mem = mem0
        outs = []
        for s in range(n_seg):
            xs = x[:, s * seg_len:(s + 1) * seg_len, :].clone()
            h = torch.concatenate([mem, xs], axis=1)
            q = torch.einsum('btd,dhe->bhte', h, Wq)
            k = torch.einsum('btd,dhe->bhte', h, Wk)
            v = torch.einsum('btd,dhe->bhte', h, Wv)
            scores = torch.einsum('bhqe,bhke->bhqk', q, k) * scale
            scores = torch.where(mask[None, None], scores, -1000000000.0)
            p = _softmax(scores, axis=-1)
            o = torch.einsum('bhqk,bhke->bhqe', p, v)
            o = torch.einsum('bhte,hed->btd', o, Wo)
            mem = o[:, :M, :].clone()
            outs.append(o[:, M:, :])
        return torch.concatenate(outs, axis=1)

    def _B_ref(x, mem0, Wq, Wk, Wv, Wo, seg_len):
        B, S, Dm = x.shape
        H, Dh = (Wq.shape[1], Wq.shape[2])
        M = mem0.shape[1]
        scale = Dh ** (-0.5)
        n_seg = S // seg_len
        L = M + seg_len
        idx = torch.arange(L)
        mask = (idx[:, None] < M) | (idx[:, None] >= idx[None, :])
        mem = mem0
        outs = []
        for s in range(n_seg):
            xs = x[:, s * seg_len:(s + 1) * seg_len, :].clone()
            h = torch.concatenate([mem, xs], axis=1)
            q = torch.einsum('btd,dhe->bhte', h, Wq)
            k = torch.einsum('btd,dhe->bhte', h, Wk)
            v = torch.einsum('btd,dhe->bhte', h, Wv)
            scores = torch.einsum('bhqe,bhke->bhqk', q, k) * scale
            scores = torch.where(mask[None, None], scores, -1000000000.0)
            p = _softmax(scores, axis=-1)
            o = torch.einsum('bhqk,bhke->bhqe', p, v)
            o = torch.einsum('bhte,hed->btd', o, Wo)
            mem = o[:, :M, :].clone()
            outs.append(o[:, M:, :])
        return torch.concatenate(outs, axis=1)
    x = A_x
    g = _sigmoid((x * gate_w).sum(-1, keepdims=True))
    a = _A_ref(x, A_mem0, A_Wq, A_Wk, A_Wv, A_Wo, A_seg_len)
    b = _B_ref(x, B_mem0, B_Wq, B_Wk, B_Wv, B_Wo, B_seg_len)
    return g * a + (1 - g) * b
```

```asm
; @launch grid=(256,1,1) block=(256,1,1) lds=163840
.amdgcn_target "amdgcn-amd-amdhsa--gfx950"
.text
.globl gated_mix__memory_aug_recurrent_mem_tr__memory_aug_recurrent_mem_tr__prompt_kernel
.p2align 8
.type gated_mix__memory_aug_recurrent_mem_tr__memory_aug_recurrent_mem_tr__prompt_kernel,@function
gated_mix__memory_aug_recurrent_mem_tr__memory_aug_recurrent_mem_tr__prompt_kernel:
    s_cmp_ge_u32 s2, 256
    s_cbranch_scc1 END
    s_load_dwordx16 s[8:23], s[0:1], 0
    s_load_dwordx16 s[24:39], s[0:1], 64
    s_load_dwordx4 s[40:43], s[0:1], 128
    s_getreg_b32 s4, hwreg(HW_REG_XCC_ID, 0, 4)
    s_and_b32 s4, s4, 7
    v_lshrrev_b32 v1, 6, v0
    s_mov_b32 s100, 0
    v_readfirstlane_b32 s3, v1
    v_and_b32 v0, 63, v0
    s_lshl_b32 s98, s4, 6
    s_lshl_b32 s99, s4, 2
    s_add_u32 s97, s99, 120
    s_cmp_ge_u32 s4, 2
    s_cselect_b32 s98, s97, s98
    s_add_u32 s97, s99, 172
    s_cmp_ge_u32 s4, 5
    s_cselect_b32 s98, s97, s98
    v_mov_b32 v3, 1
    v_mov_b32 v12, 0
    s_waitcnt lgkmcnt(0)
    s_mov_b32 s48, s40
    s_and_b32 s49, s41, 0xffff
    s_mov_b32 s50, 256
    s_mov_b32 s51, 0x20000
    s_cmp_lg_u32 s3, 0
    s_cbranch_scc1 notw0_1
    s_mov_b64 exec, 1
    buffer_atomic_add v3, off, s[48:51], s98 sc0
    s_waitcnt vmcnt(0)
    ds_write_b32 v12, v3
    s_mov_b64 exec, -1
    s_waitcnt lgkmcnt(0)
notw0_1:
    s_mov_b32 s44, s42
    s_and_b32 s45, s43, 0xffff
    s_mov_b32 s46, 268435456
    s_mov_b32 s47, 0x20000
    s_barrier
    ds_read_b32 v3, v12
    s_waitcnt lgkmcnt(0)
    v_readfirstlane_b32 s5, v3
    s_barrier
    s_cmp_lt_u32 s5, 32
    s_cbranch_scc1 role_ok_2
    v_lshlrev_b32 v1, 2, v0
waitd_3:
    buffer_load_dword v3, v1, s[48:51], 0 offen sc1
    s_waitcnt vmcnt(0)
    s_mov_b32 s99, 0
    v_readlane_b32 s98, v3, 0
    s_add_u32 s99, s99, s98
    v_readlane_b32 s98, v3, 16
    s_add_u32 s99, s99, s98
    v_readlane_b32 s98, v3, 32
    s_add_u32 s99, s99, s98
    v_readlane_b32 s98, v3, 33
    s_add_u32 s99, s99, s98
    v_readlane_b32 s98, v3, 34
    s_add_u32 s99, s99, s98
    v_readlane_b32 s98, v3, 48
    s_add_u32 s99, s99, s98
    v_readlane_b32 s98, v3, 49
    s_add_u32 s99, s99, s98
    v_readlane_b32 s98, v3, 50
    s_add_u32 s99, s99, s98
    s_cmp_ge_u32 s99, 256
    s_cbranch_scc1 waitd_done_4
dno_5:
    s_sleep 8
    s_add_u32 s100, s100, 1
    s_cmp_lt_u32 s100, 262144
    s_cbranch_scc1 spin_ok_6
    s_mov_b32 s98, 1
    s_branch FAIL
spin_ok_6:
    s_branch waitd_3
waitd_done_4:
    v_readlane_b32 s68, v3, 0
    v_readlane_b32 s69, v3, 16
    v_readlane_b32 s70, v3, 32
    v_readlane_b32 s71, v3, 33
    v_readlane_b32 s72, v3, 34
    v_readlane_b32 s73, v3, 48
    v_readlane_b32 s74, v3, 49
    v_readlane_b32 s75, v3, 50
    s_sub_u32 s5, s5, 32
    s_max_u32 s98, s68, 32
    s_sub_u32 s98, s98, 32
    s_cmp_gt_u32 s4, 0
    s_cselect_b32 s98, s98, 0
    s_add_u32 s5, s5, s98
    s_max_u32 s98, s69, 32
    s_sub_u32 s98, s98, 32
    s_cmp_gt_u32 s4, 1
    s_cselect_b32 s98, s98, 0
    s_add_u32 s5, s5, s98
    s_max_u32 s98, s70, 32
    s_sub_u32 s98, s98, 32
    s_cmp_gt_u32 s4, 2
    s_cselect_b32 s98, s98, 0
    s_add_u32 s5, s5, s98
    s_max_u32 s98, s71, 32
    s_sub_u32 s98, s98, 32
    s_cmp_gt_u32 s4, 3
    s_cselect_b32 s98, s98, 0
    s_add_u32 s5, s5, s98
    s_max_u32 s98, s72, 32
    s_sub_u32 s98, s98, 32
    s_cmp_gt_u32 s4, 4
    s_cselect_b32 s98, s98, 0
    s_add_u32 s5, s5, s98
    s_max_u32 s98, s73, 32
    s_sub_u32 s98, s98, 32
    s_cmp_gt_u32 s4, 5
    s_cselect_b32 s98, s98, 0
    s_add_u32 s5, s5, s98
    s_max_u32 s98, s74, 32
    s_sub_u32 s98, s98, 32
    s_cmp_gt_u32 s4, 6
    s_cselect_b32 s98, s98, 0
    s_add_u32 s5, s5, s98
    s_min_u32 s98, s68, 32
    s_sub_u32 s99, 32, s98
    s_cmp_lt_u32 s5, s99
    s_cbranch_scc0 vac_7
    s_add_u32 s5, s5, s98
    s_mov_b32 s4, 0
    s_branch role_ok_2
vac_7:
    s_sub_u32 s5, s5, s99
    s_min_u32 s98, s69, 32
    s_sub_u32 s99, 32, s98
    s_cmp_lt_u32 s5, s99
    s_cbranch_scc0 vac_8
    s_add_u32 s5, s5, s98
    s_mov_b32 s4, 1
    s_branch role_ok_2
vac_8:
    s_sub_u32 s5, s5, s99
    s_min_u32 s98, s70, 32
    s_sub_u32 s99, 32, s98
    s_cmp_lt_u32 s5, s99
    s_cbranch_scc0 vac_9
    s_add_u32 s5, s5, s98
    s_mov_b32 s4, 2
    s_branch role_ok_2
vac_9:
    s_sub_u32 s5, s5, s99
    s_min_u32 s98, s71, 32
    s_sub_u32 s99, 32, s98
    s_cmp_lt_u32 s5, s99
    s_cbranch_scc0 vac_10
    s_add_u32 s5, s5, s98
    s_mov_b32 s4, 3
    s_branch role_ok_2
vac_10:
    s_sub_u32 s5, s5, s99
    s_min_u32 s98, s72, 32
    s_sub_u32 s99, 32, s98
    s_cmp_lt_u32 s5, s99
    s_cbranch_scc0 vac_11
    s_add_u32 s5, s5, s98
    s_mov_b32 s4, 4
    s_branch role_ok_2
vac_11:
    s_sub_u32 s5, s5, s99
    s_min_u32 s98, s73, 32
    s_sub_u32 s99, 32, s98
    s_cmp_lt_u32 s5, s99
    s_cbranch_scc0 vac_12
    s_add_u32 s5, s5, s98
    s_mov_b32 s4, 5
    s_branch role_ok_2
vac_12:
    s_sub_u32 s5, s5, s99
    s_min_u32 s98, s74, 32
    s_sub_u32 s99, 32, s98
    s_cmp_lt_u32 s5, s99
    s_cbranch_scc0 vac_13
    s_add_u32 s5, s5, s98
    s_mov_b32 s4, 6
    s_branch role_ok_2
vac_13:
    s_sub_u32 s5, s5, s99
    s_min_u32 s98, s75, 32
    s_sub_u32 s99, 32, s98
    s_cmp_lt_u32 s5, s99
    s_cbranch_scc0 vac_14
    s_add_u32 s5, s5, s98
    s_mov_b32 s4, 7
    s_branch role_ok_2
vac_14:
    s_sub_u32 s5, s5, s99
    s_branch END
role_ok_2:
    s_and_b32 s5, s5, 31
    s_and_b32 s6, s4, 1
    s_cmp_eq_u32 s6, 1
    s_cselect_b64 s[10:11], s[24:25], s[10:11]
    s_cselect_b64 s[12:13], s[26:27], s[12:13]
    s_cselect_b64 s[14:15], s[28:29], s[14:15]
    s_cselect_b64 s[16:17], s[30:31], s[16:17]
    s_cselect_b64 s[18:19], s[32:33], s[18:19]
    s_cmp_lt_u32 s4, 2
    s_cbranch_scc1 ROLE_CHAIN
    s_mul_i32 s98, s5, 6
    s_add_u32 s98, s98, s4
    s_sub_u32 s98, s98, 2
    s_bfe_u32 s5, s98, 0x50001
    s_sub_u32 s97, s98, 64
    s_lshr_b32 s98, s98, 6
    s_lshl_b32 s4, s98, 1
    s_add_u32 s4, s4, s6
    s_add_u32 s4, s4, 2
    s_cmp_eq_u32 s98, 0
    s_cbranch_scc1 ROLE_S1
    s_lshl_b32 s98, s3, 10
    v_lshl_add_u32 v2, v0, 4, s98
    v_mov_b64 v[4:5], -1
    v_mov_b64 v[6:7], -1
    v_mov_b64 v[8:9], 0
    v_mov_b64 v[10:11], 0
    s_lshl_b32 s99, s97, 13
    s_add_u32 s99, s99, 131072
    s_add_u32 s98, s99, 4096
    buffer_store_dwordx4 v[4:7], v2, s[44:47], s99 offen sc1
    buffer_store_dwordx4 v[4:7], v2, s[44:47], s98 offen sc1
    s_lshl_b32 s97, s97, 9
    s_cmp_eq_u32 s3, 0
    s_cselect_b32 s97, s97, 1073741824
    s_mov_b64 exec, 0xffffffff
    buffer_store_dwordx4 v[8:11], v2, s[44:47], s97 offen sc1
    s_mov_b64 exec, -1
    s_cselect_b32 s97, 0, 64
    v_mov_b32 v4, 1
    s_waitcnt vmcnt(0)
    s_barrier
    s_mov_b64 exec, 1
    buffer_atomic_add v4, off, s[48:51], s97 offset:204
    s_mov_b64 exec, -1
    s_cmp_lt_u32 s4, 6
    s_cbranch_scc1 ROLE_S2
    s_cmp_lt_u32 s5, 24
    s_cbranch_scc0 ROLE_R
    s_mov_b32 s7, 0
TO_S3:
    s_mul_i32 s98, s5, 43
    s_lshr_b32 s98, s98, 7
    s_mul_i32 s99, s98, 3
    s_sub_u32 s99, s5, s99
    s_lshl_b32 s99, s99, 3
    s_add_u32 s5, s98, s99
    s_branch ROLE_S3
.p2align 6
ROLE_CHAIN:
    s_mul_i32 s98, s5, 256
    s_add_u32 s52, s12, s98
    s_addc_u32 s53, s13, 0
    s_and_b32 s53, s53, 0xffff
    s_sub_u32 s54, 4718592, s98
    s_mov_b32 s55, 0x20000
    s_mul_i32 s98, s5, 256
    s_add_u32 s56, s14, s98
    s_addc_u32 s57, s15, 0
    s_and_b32 s57, s57, 0xffff
    s_sub_u32 s58, 4718592, s98
    s_mov_b32 s59, 0x20000
    s_mul_i32 s98, s5, 256
    s_add_u32 s60, s16, s98
    s_addc_u32 s61, s17, 0
    s_and_b32 s61, s61, 0xffff
    s_sub_u32 s62, 4718592, s98
    s_mov_b32 s63, 0x20000
    s_mul_i32 s98, s5, 147456
    s_add_u32 s64, s18, s98
    s_addc_u32 s65, s19, 0
    s_and_b32 s65, s65, 0xffff
    s_sub_u32 s66, 4718592, s98
    s_mov_b32 s67, 0x20000
    s_lshl_b32 s69, s3, 10
    v_lshlrev_b32 v6, 4, v0
    v_add_u32 v6, s69, v6
    s_add_u32 m0, s69, 0
    s_mov_b32 s68, 0
    buffer_load_dwordx4 v6, s[64:67], s68 offen nt lds
    s_add_u32 m0, s69, 4096
    s_mov_b32 s68, 4096
    buffer_load_dwordx4 v6, s[64:67], s68 offen nt lds
    s_add_u32 m0, s69, 8192
    s_mov_b32 s68, 8192
    buffer_load_dwordx4 v6, s[64:67], s68 offen nt lds
    s_add_u32 m0, s69, 12288
    s_mov_b32 s68, 12288
    buffer_load_dwordx4 v6, s[64:67], s68 offen nt lds
    s_add_u32 m0, s69, 16384
    s_mov_b32 s68, 16384
    buffer_load_dwordx4 v6, s[64:67], s68 offen nt lds
    s_add_u32 m0, s69, 20480
    s_mov_b32 s68, 20480
    buffer_load_dwordx4 v6, s[64:67], s68 offen nt lds
    s_add_u32 m0, s69, 24576
    s_mov_b32 s68, 24576
    buffer_load_dwordx4 v6, s[64:67], s68 offen nt lds
    s_add_u32 m0, s69, 28672
    s_mov_b32 s68, 28672
    buffer_load_dwordx4 v6, s[64:67], s68 offen nt lds
    s_add_u32 m0, s69, 32768
    s_mov_b32 s68, 32768
    buffer_load_dwordx4 v6, s[64:67], s68 offen nt lds
    s_add_u32 m0, s69, 36864
    s_mov_b32 s68, 36864
    buffer_load_dwordx4 v6, s[64:67], s68 offen nt lds
    s_add_u32 m0, s69, 40960
    s_mov_b32 s68, 40960
    buffer_load_dwordx4 v6, s[64:67], s68 offen nt lds
    s_add_u32 m0, s69, 45056
    s_mov_b32 s68, 45056
    buffer_load_dwordx4 v6, s[64:67], s68 offen nt lds
    s_add_u32 m0, s69, 49152
    s_mov_b32 s68, 49152
    buffer_load_dwordx4 v6, s[64:67], s68 offen nt lds
    s_add_u32 m0, s69, 53248
    s_mov_b32 s68, 53248
    buffer_load_dwordx4 v6, s[64:67], s68 offen nt lds
    s_add_u32 m0, s69, 57344
    s_mov_b32 s68, 57344
    buffer_load_dwordx4 v6, s[64:67], s68 offen nt lds
    s_add_u32 m0, s69, 61440
    s_mov_b32 s68, 61440
    buffer_load_dwordx4 v6, s[64:67], s68 offen nt lds
    s_add_u32 m0, s69, 65536
    s_mov_b32 s68, 65536
    buffer_load_dwordx4 v6, s[64:67], s68 offen nt lds
    s_add_u32 m0, s69, 69632
    s_mov_b32 s68, 69632
    buffer_load_dwordx4 v6, s[64:67], s68 offen nt lds
    s_add_u32 m0, s69, 81920
    s_mov_b32 s68, 73728
    buffer_load_dwordx4 v6, s[64:67], s68 offen nt lds
    s_add_u32 m0, s69, 86016
    s_mov_b32 s68, 77824
    buffer_load_dwordx4 v6, s[64:67], s68 offen nt lds
    s_add_u32 m0, s69, 90112
    s_mov_b32 s68, 81920
    buffer_load_dwordx4 v6, s[64:67], s68 offen nt lds
    s_add_u32 m0, s69, 94208
    s_mov_b32 s68, 86016
    buffer_load_dwordx4 v6, s[64:67], s68 offen nt lds
    s_add_u32 m0, s69, 98304
    s_mov_b32 s68, 90112
    buffer_load_dwordx4 v6, s[64:67], s68 offen nt lds
    s_add_u32 m0, s69, 102400
    s_mov_b32 s68, 94208
    buffer_load_dwordx4 v6, s[64:67], s68 offen nt lds
    s_add_u32 m0, s69, 106496
    s_mov_b32 s68, 98304
    buffer_load_dwordx4 v6, s[64:67], s68 offen nt lds
    s_add_u32 m0, s69, 110592
    s_mov_b32 s68, 102400
    buffer_load_dwordx4 v6, s[64:67], s68 offen nt lds
    s_add_u32 m0, s69, 114688
    s_mov_b32 s68, 106496
    buffer_load_dwordx4 v6, s[64:67], s68 offen nt lds
    s_add_u32 m0, s69, 118784
    s_mov_b32 s68, 110592
    buffer_load_dwordx4 v6, s[64:67], s68 offen nt lds
    s_add_u32 m0, s69, 122880
    s_mov_b32 s68, 114688
    buffer_load_dwordx4 v6, s[64:67], s68 offen nt lds
    s_add_u32 m0, s69, 126976
    s_mov_b32 s68, 118784
    buffer_load_dwordx4 v6, s[64:67], s68 offen nt lds
    s_add_u32 m0, s69, 131072
    s_mov_b32 s68, 122880
    buffer_load_dwordx4 v6, s[64:67], s68 offen nt lds
    s_add_u32 m0, s69, 135168
    s_mov_b32 s68, 126976
    buffer_load_dwordx4 v6, s[64:67], s68 offen nt lds
    s_add_u32 m0, s69, 139264
    s_mov_b32 s68, 131072
    buffer_load_dwordx4 v6, s[64:67], s68 offen nt lds
    s_add_u32 m0, s69, 143360
    s_mov_b32 s68, 135168
    buffer_load_dwordx4 v6, s[64:67], s68 offen nt lds
    s_add_u32 m0, s69, 147456
    s_mov_b32 s68, 139264
    buffer_load_dwordx4 v6, s[64:67], s68 offen nt lds
    s_add_u32 m0, s69, 151552
    s_mov_b32 s68, 143360
    buffer_load_dwordx4 v6, s[64:67], s68 offen nt lds
    v_lshlrev_b32 v4, 4, v0
    v_add_u32 v4, 131072, v4
    s_lshl_b32 s89, s5, 2
    s_add_u32 s89, s89, s3
    s_lshl_b32 s89, s89, 7
    s_cmp_lt_u32 s89, 9216
    s_cselect_b32 s89, s89, 1073741824
    s_add_u32 s89, s89, 9216
    s_mul_i32 s73, s6, 608256
    s_add_u32 s73, s73, 2097152
    s_lshl_b32 s98, s6, 5
    s_add_u32 s98, s98, s5
    s_mul_i32 s98, s98, 65
    s_lshl_b32 s75, s98, 14
    s_lshl_b32 s99, s3, 12
    s_add_u32 s88, s75, s99
    s_add_u32 s88, s88, 16785408
    s_lshl_b32 s99, s3, 11
    s_add_u32 s92, s75, 16654336
    s_add_u32 s75, s75, s99
    s_add_u32 s75, s75, 16646144
    s_add_u32 s90, s99, 140288
    s_lshl_b32 s76, s98, 12
    s_add_u32 s76, s76, 85852160
    s_lshl_b32 s98, s6, 5
    s_add_u32 s98, s98, s5
    s_lshl_b32 s98, s98, 7
    s_add_u32 s77, s98, 0
    s_add_u32 s78, s98, 8192
    v_mov_b64 v[12:13], -1
    v_mov_b64 v[14:15], -1
    v_lshrrev_b32 v16, 3, v0
    v_mul_u32_u24 v16, 9216, v16
    v_and_b32 v17, 7, v0
    v_lshl_add_u32 v16, v17, 4, v16
    s_add_u32 s89, s73, s89
    s_add_u32 s99, s89, 0
    buffer_store_dwordx4 v[12:15], v16, s[44:47], s99 offen sc1
    s_add_u32 s99, s89, 73728
    buffer_store_dwordx4 v[12:15], v16, s[44:47], s99 offen sc1
    s_add_u32 s99, s89, 147456
    buffer_store_dwordx4 v[12:15], v16, s[44:47], s99 offen sc1
    s_add_u32 s99, s89, 221184
    buffer_store_dwordx4 v[12:15], v16, s[44:47], s99 offen sc1
    s_add_u32 s99, s89, 294912
    buffer_store_dwordx4 v[12:15], v16, s[44:47], s99 offen sc1
    s_add_u32 s99, s89, 368640
    buffer_store_dwordx4 v[12:15], v16, s[44:47], s99 offen sc1
    s_add_u32 s99, s89, 442368
    buffer_store_dwordx4 v[12:15], v16, s[44:47], s99 offen sc1
    s_add_u32 s99, s89, 516096
    buffer_store_dwordx4 v[12:15], v16, s[44:47], s99 offen sc1
    v_bfe_u32 v16, v0, 2, 2
    v_and_b32 v17, 1, v0
    v_lshl_add_u32 v16, v16, 1, v17
    v_mul_u32_u24 v16, 1152, v16
    v_bfe_u32 v17, v0, 1, 1
    v_lshl_add_u32 v16, v17, 4, v16
    v_lshrrev_b32 v17, 4, v0
    v_mul_u32_u24 v17, 288, v17
    s_lshl_b32 s98, s3, 5
    v_add3_u32 v16, v16, v17, s98
    s_mov_b32 s20, s10
    s_and_b32 s21, s11, 0xffff
    s_mov_b32 s22, 9216
    s_mov_b32 s23, 0x20000
    buffer_load_dwordx4 v[40:43], v16, s[20:23], 0 offen offset:0
    buffer_load_dwordx4 v[44:47], v16, s[20:23], 0 offen offset:96
    buffer_load_dwordx4 v[48:51], v16, s[20:23], 0 offen offset:192
    s_bfe_u32 s26, s12, 0x50008
    s_add_u32 s27, s26, s5
    s_and_b32 s27, s27, 31
    s_add_u32 s24, s27, 3
    s_and_b32 s24, s24, 3
    s_sub_u32 s25, s27, s24
    s_cmp_eq_u32 s24, 0
    s_cselect_b32 s28, 0, 1
    s_cmp_eq_u32 s27, 31
    s_cselect_b32 s28, 0, s28
    s_sub_u32 s29, s27, 18
    s_cmp_lt_u32 s29, 3
    s_cselect_b32 s29, 1, 0
    s_cselect_b32 s30, 31, 29
    s_cmp_eq_u32 s27, 23
    s_cselect_b32 s29, 1, s29
    s_cmp_eq_u32 s3, 1
    s_cselect_b32 s28, s29, s28
    s_cselect_b32 s25, s30, s25
    s_cmp_ge_u32 s3, 2
    s_cselect_b32 s28, 0, s28
    s_sub_u32 s25, s25, s26
    s_and_b32 s25, s25, 31
    s_lshl_b32 s25, s25, 8
    s_cmp_eq_u32 s24, 2
    s_cselect_b32 s98, 0, 2359296
    s_add_u32 s25, s25, s98
    s_cmp_eq_u32 s28, 0
    s_cselect_b32 s25, 1073741824, s25
    v_lshrrev_b32 v16, 5, v0
    v_mul_u32_u24 v16, 144, v16
    v_bfe_u32 v17, v0, 1, 4
    v_add_u32 v16, v16, v17
    v_lshlrev_b32 v16, 13, v16
    v_and_b32 v17, 1, v0
    v_lshl_add_u32 v39, v17, 7, v16
    v_lshrrev_b32 v16, 4, v0
    v_and_b32 v17, 15, v0
    v_and_b32 v18, 1, v16
    s_lshl_b32 s98, s3, 2
    v_lshl_add_u32 v18, v18, 1, s98
    v_xor_b32 v18, v18, v17
    v_lshlrev_b32 v18, 4, v18
    v_and_b32 v19, 1, v16
    v_lshrrev_b32 v20, 1, v16
    v_lshl_add_u32 v19, v19, 2, v20
    s_lshr_b32 s99, s3, 1
    s_mul_i32 s99, s99, 4
    s_lshl_b32 s68, s3, 1
    s_add_u32 s99, s99, s68
    v_add_u32 v19, s99, v19
    v_lshl_add_u32 v5, v19, 13, v18
    v_bfe_u32 v17, v0, 2, 1
    v_bfe_u32 v18, v0, 3, 1
    v_bfe_u32 v19, v0, 4, 1
    v_bfe_u32 v20, v0, 5, 1
    v_lshl_add_u32 v21, v20, 4, v17
    v_lshl_add_u32 v21, v19, 2, v21
    v_lshl_add_u32 v21, v18, 3, v21
    v_lshlrev_b32 v22, 1, v17
    v_lshl_add_u32 v22, v19, 2, v22
    v_lshl_add_u32 v22, v18, 3, v22
    v_bfe_u32 v23, v0, 1, 1
    v_add_u32 v23, s98, v23
    v_xor_b32 v23, v23, v22
    v_lshlrev_b32 v23, 4, v23
    v_lshl_add_u32 v23, v21, 8, v23
    v_and_b32 v24, 1, v0
    v_lshl_add_u32 v7, v24, 3, v23
    v_xor_b32 v8, 32, v7
    v_lshl_add_u32 v21, v18, 5, v17
    v_lshl_add_u32 v21, v19, 4, v21
    v_lshl_add_u32 v21, v20, 2, v21
    v_mul_u32_u24 v21, 1152, v21
    v_and_b32 v22, 3, v0
    v_lshl_add_u32 v21, v22, 3, v21
    s_mul_i32 s98, s3, 288
    v_add_u32 v9, s98, v21
    s_lshl_b32 s98, s3, 12
    v_lshl_add_u32 v2, v0, 4, s98
    v_add_u32 v3, 0x10000, v2
    s_waitcnt vmcnt(29)
    s_barrier
    v_add_u32 v10, 0, v9
    ds_read_b64_tr_b16 a[0:1], v10 offset:0
    ds_read_b64_tr_b16 a[2:3], v10 offset:2304
    ds_read_b64_tr_b16 a[4:5], v10 offset:9216
    ds_read_b64_tr_b16 a[6:7], v10 offset:11520
    ds_read_b64_tr_b16 a[16:17], v10 offset:32
    ds_read_b64_tr_b16 a[18:19], v10 offset:2336
    ds_read_b64_tr_b16 a[20:21], v10 offset:9248
    ds_read_b64_tr_b16 a[22:23], v10 offset:11552
    ds_read_b64_tr_b16 a[32:33], v10 offset:64
    ds_read_b64_tr_b16 a[34:35], v10 offset:2368
    ds_read_b64_tr_b16 a[36:37], v10 offset:9280
    ds_read_b64_tr_b16 a[38:39], v10 offset:11584
    ds_read_b64_tr_b16 a[48:49], v10 offset:96
    ds_read_b64_tr_b16 a[50:51], v10 offset:2400
    ds_read_b64_tr_b16 a[52:53], v10 offset:9312
    ds_read_b64_tr_b16 a[54:55], v10 offset:11616
    ds_read_b64_tr_b16 a[64:65], v10 offset:128
    ds_read_b64_tr_b16 a[66:67], v10 offset:2432
    ds_read_b64_tr_b16 a[68:69], v10 offset:9344
    ds_read_b64_tr_b16 a[70:71], v10 offset:11648
    ds_read_b64_tr_b16 a[80:81], v10 offset:160
    ds_read_b64_tr_b16 a[82:83], v10 offset:2464
    ds_read_b64_tr_b16 a[84:85], v10 offset:9376
    ds_read_b64_tr_b16 a[86:87], v10 offset:11680
    ds_read_b64_tr_b16 a[96:97], v10 offset:192
    ds_read_b64_tr_b16 a[98:99], v10 offset:2496
    ds_read_b64_tr_b16 a[100:101], v10 offset:9408
    ds_read_b64_tr_b16 a[102:103], v10 offset:11712
    ds_read_b64_tr_b16 a[112:113], v10 offset:224
    ds_read_b64_tr_b16 a[114:115], v10 offset:2528
    ds_read_b64_tr_b16 a[116:117], v10 offset:9440
    ds_read_b64_tr_b16 a[118:119], v10 offset:11744
    ds_read_b64_tr_b16 a[128:129], v10 offset:256
    ds_read_b64_tr_b16 a[130:131], v10 offset:2560
    ds_read_b64_tr_b16 a[132:133], v10 offset:9472
    ds_read_b64_tr_b16 a[134:135], v10 offset:11776
    s_waitcnt lgkmcnt(0)
    s_barrier
    s_mov_b32 s22, 4718592
    s_cmp_eq_u32 s24, 1
    s_cselect_b32 s20, s12, s12
    s_cselect_b32 s21, s13, s13
    s_cselect_b32 s68, 48, 64
    s_and_b32 s21, s21, 0xffff
    s_lshl_b32 s68, s68, 13
    s_add_u32 s68, s68, s25
    buffer_load_dword v13, v39, s[20:23], s68 offen
    s_add_u32 m0, s69, 0
    s_mov_b32 s68, 0
    buffer_load_dwordx4 v5, s[52:55], s68 offen nt lds
    s_add_u32 m0, s69, 4096
    s_mov_b32 s68, 1179648
    buffer_load_dwordx4 v5, s[52:55], s68 offen nt lds
    s_add_u32 m0, s69, 8192
    s_mov_b32 s68, 2359296
    buffer_load_dwordx4 v5, s[52:55], s68 offen nt lds
    s_add_u32 m0, s69, 12288
    s_mov_b32 s68, 3538944
    buffer_load_dwordx4 v5, s[52:55], s68 offen nt lds
    s_waitcnt vmcnt(16)
    s_barrier
    v_add_u32 v10, 81920, v9
    ds_read_b64_tr_b16 a[8:9], v10 offset:0
    ds_read_b64_tr_b16 a[10:11], v10 offset:2304
    ds_read_b64_tr_b16 a[12:13], v10 offset:9216
    ds_read_b64_tr_b16 a[14:15], v10 offset:11520
    ds_read_b64_tr_b16 a[24:25], v10 offset:32
    ds_read_b64_tr_b16 a[26:27], v10 offset:2336
    ds_read_b64_tr_b16 a[28:29], v10 offset:9248
    ds_read_b64_tr_b16 a[30:31], v10 offset:11552
    ds_read_b64_tr_b16 a[40:41], v10 offset:64
    ds_read_b64_tr_b16 a[42:43], v10 offset:2368
    ds_read_b64_tr_b16 a[44:45], v10 offset:9280
    ds_read_b64_tr_b16 a[46:47], v10 offset:11584
    ds_read_b64_tr_b16 a[56:57], v10 offset:96
    ds_read_b64_tr_b16 a[58:59], v10 offset:2400
    ds_read_b64_tr_b16 a[60:61], v10 offset:9312
    ds_read_b64_tr_b16 a[62:63], v10 offset:11616
    ds_read_b64_tr_b16 a[72:73], v10 offset:128
    ds_read_b64_tr_b16 a[74:75], v10 offset:2432
    ds_read_b64_tr_b16 a[76:77], v10 offset:9344
    ds_read_b64_tr_b16 a[78:79], v10 offset:11648
    ds_read_b64_tr_b16 a[88:89], v10 offset:160
    ds_read_b64_tr_b16 a[90:91], v10 offset:2464
    ds_read_b64_tr_b16 a[92:93], v10 offset:9376
    ds_read_b64_tr_b16 a[94:95], v10 offset:11680
    ds_read_b64_tr_b16 a[104:105], v10 offset:192
    ds_read_b64_tr_b16 a[106:107], v10 offset:2496
    ds_read_b64_tr_b16 a[108:109], v10 offset:9408
    ds_read_b64_tr_b16 a[110:111], v10 offset:11712
    ds_read_b64_tr_b16 a[120:121], v10 offset:224
    ds_read_b64_tr_b16 a[122:123], v10 offset:2528
    ds_read_b64_tr_b16 a[124:125], v10 offset:9440
    ds_read_b64_tr_b16 a[126:127], v10 offset:11744
    ds_read_b64_tr_b16 a[136:137], v10 offset:256
    ds_read_b64_tr_b16 a[138:139], v10 offset:2560
    ds_read_b64_tr_b16 a[140:141], v10 offset:9472
    ds_read_b64_tr_b16 a[142:143], v10 offset:11776
    s_waitcnt lgkmcnt(0)
    s_barrier
    s_add_u32 m0, s69, 16384
    s_mov_b32 s68, 131072
    buffer_load_dwordx4 v5, s[52:55], s68 offen nt lds
    s_add_u32 m0, s69, 20480
    s_mov_b32 s68, 1310720
    buffer_load_dwordx4 v5, s[52:55], s68 offen nt lds
    s_add_u32 m0, s69, 24576
    s_mov_b32 s68, 2490368
    buffer_load_dwordx4 v5, s[52:55], s68 offen nt lds
    s_add_u32 m0, s69, 28672
    s_mov_b32 s68, 3670016
    buffer_load_dwordx4 v5, s[52:55], s68 offen nt lds
    s_add_u32 m0, s69, 32768
    s_mov_b32 s68, 262144
    buffer_load_dwordx4 v5, s[52:55], s68 offen nt lds
    s_add_u32 m0, s69, 36864
    s_mov_b32 s68, 1441792
    buffer_load_dwordx4 v5, s[52:55], s68 offen nt lds
    s_add_u32 m0, s69, 40960
    s_mov_b32 s68, 2621440
    buffer_load_dwordx4 v5, s[52:55], s68 offen nt lds
    s_add_u32 m0, s69, 45056
    s_mov_b32 s68, 3801088
    buffer_load_dwordx4 v5, s[52:55], s68 offen nt lds
    s_add_u32 m0, s69, 49152
    s_mov_b32 s68, 393216
    buffer_load_dwordx4 v5, s[52:55], s68 offen nt lds
    s_add_u32 m0, s69, 53248
    s_mov_b32 s68, 1572864
    buffer_load_dwordx4 v5, s[52:55], s68 offen nt lds
    s_add_u32 m0, s69, 57344
    s_mov_b32 s68, 2752512
    buffer_load_dwordx4 v5, s[52:55], s68 offen nt lds
    s_add_u32 m0, s69, 61440
    s_mov_b32 s68, 3932160
    buffer_load_dwordx4 v5, s[52:55], s68 offen nt lds
    s_add_u32 m0, s69, 65536
    s_mov_b32 s68, 524288
    buffer_load_dwordx4 v5, s[52:55], s68 offen nt lds
    s_add_u32 m0, s69, 69632
    s_mov_b32 s68, 1703936
    buffer_load_dwordx4 v5, s[52:55], s68 offen nt lds
    s_add_u32 m0, s69, 73728
    s_mov_b32 s68, 2883584
    buffer_load_dwordx4 v5, s[52:55], s68 offen nt lds
    s_add_u32 m0, s69, 77824
    s_mov_b32 s68, 4063232
    buffer_load_dwordx4 v5, s[52:55], s68 offen nt lds
    s_waitcnt vmcnt(12)
    s_barrier
    v_add_u32 v10, 0, v7
    v_add_u32 v11, 0, v8
    ds_read_b64_tr_b16 a[144:145], v10 offset:0
    ds_read_b64_tr_b16 a[146:147], v10 offset:512
    ds_read_b64_tr_b16 a[148:149], v10 offset:8192
    ds_read_b64_tr_b16 a[150:151], v10 offset:8704
    ds_read_b64_tr_b16 a[152:153], v11 offset:0
    ds_read_b64_tr_b16 a[154:155], v11 offset:512
    ds_read_b64_tr_b16 a[156:157], v11 offset:8192
    ds_read_b64_tr_b16 a[158:159], v11 offset:8704
    v_add_u32 v10, 16384, v7
    v_add_u32 v11, 16384, v8
    ds_read_b64_tr_b16 a[160:161], v10 offset:0
    ds_read_b64_tr_b16 a[162:163], v10 offset:512
    ds_read_b64_tr_b16 a[164:165], v10 offset:8192
    ds_read_b64_tr_b16 a[166:167], v10 offset:8704
    ds_read_b64_tr_b16 a[168:169], v11 offset:0
    ds_read_b64_tr_b16 a[170:171], v11 offset:512
    ds_read_b64_tr_b16 a[172:173], v11 offset:8192
    ds_read_b64_tr_b16 a[174:175], v11 offset:8704
    s_waitcnt lgkmcnt(0)
    s_barrier
    s_mov_b32 s96, 0x05040100
    s_mov_b32 s97, 0x07060302
    v_perm_b32 v52, v42, v40, s96
    v_perm_b32 v53, v42, v40, s97
    v_perm_b32 v54, v43, v41, s96
    v_perm_b32 v55, v43, v41, s97
    v_perm_b32 v56, v46, v44, s96
    v_perm_b32 v57, v46, v44, s97
    v_perm_b32 v58, v47, v45, s96
    v_perm_b32 v59, v47, v45, s97
    v_perm_b32 v60, v50, v48, s96
    v_perm_b32 v61, v50, v48, s97
    v_perm_b32 v62, v51, v49, s96
    v_perm_b32 v63, v51, v49, s97
    v_min_u32 v52, -2, v52
    v_min_u32 v53, -2, v53
    v_min_u32 v54, -2, v54
    v_min_u32 v55, -2, v55
    v_min_u32 v56, -2, v56
    v_min_u32 v57, -2, v57
    v_min_u32 v58, -2, v58
    v_min_u32 v59, -2, v59
    v_min_u32 v60, -2, v60
    v_min_u32 v61, -2, v61
    v_min_u32 v62, -2, v62
    v_min_u32 v63, -2, v63
    s_cmp_eq_u32 s3, 3
    s_cselect_b32 s98, 1073741824, s73
    s_add_u32 s99, s98, 3072
    buffer_store_dwordx4 v[52:55], v6, s[44:47], s98 offen sc1
    buffer_store_dwordx4 v[56:59], v6, s[44:47], s98 offen offset:3072 sc1
    buffer_store_dwordx4 v[60:63], v6, s[44:47], s99 offen offset:3072 sc1
    v_mul_u32_u24 v12, 9216, v0
    buffer_load_dword v13, v12, s[44:47], s89 offen sc1
    v_lshlrev_b32 v14, 2, v0
    buffer_load_dword v15, v14, s[48:51], 0 offen sc1
    s_cmp_eq_u32 s24, 1
    s_cselect_b32 s20, s12, s16
    s_cselect_b32 s21, s13, s17
    s_cselect_b32 s68, 8, 0
    s_lshl_b32 s68, s68, 4
    s_and_b32 s21, s21, 0xffff
    s_lshl_b32 s68, s68, 13
    s_add_u32 s68, s68, s25
    buffer_load_dword v13, v39, s[20:23], s68 offen
    s_add_u32 m0, s69, 81920
    s_mov_b32 s68, 655360
    buffer_load_dwordx4 v5, s[52:55], s68 offen nt lds
    s_add_u32 m0, s69, 86016
    s_mov_b32 s68, 1835008
    buffer_load_dwordx4 v5, s[52:55], s68 offen nt lds
    s_add_u32 m0, s69, 90112
    s_mov_b32 s68, 3014656
    buffer_load_dwordx4 v5, s[52:55], s68 offen nt lds
    s_add_u32 m0, s69, 94208
    s_mov_b32 s68, 4194304
    buffer_load_dwordx4 v5, s[52:55], s68 offen nt lds
    s_add_u32 m0, s69, 98304
    s_mov_b32 s68, 786432
    buffer_load_dwordx4 v5, s[52:55], s68 offen nt lds
    s_add_u32 m0, s69, 102400
    s_mov_b32 s68, 1966080
    buffer_load_dwordx4 v5, s[52:55], s68 offen nt lds
    s_add_u32 m0, s69, 106496
    s_mov_b32 s68, 3145728
    buffer_load_dwordx4 v5, s[52:55], s68 offen nt lds
    s_add_u32 m0, s69, 110592
    s_mov_b32 s68, 4325376
    buffer_load_dwordx4 v5, s[52:55], s68 offen nt lds
    s_waitcnt vmcnt(18)
    s_barrier
    v_add_u32 v10, 32768, v7
    v_add_u32 v11, 32768, v8
    ds_read_b64_tr_b16 a[176:177], v10 offset:0
    ds_read_b64_tr_b16 a[178:179], v10 offset:512
    ds_read_b64_tr_b16 a[180:181], v10 offset:8192
    ds_read_b64_tr_b16 a[182:183], v10 offset:8704
    ds_read_b64_tr_b16 a[184:185], v11 offset:0
    ds_read_b64_tr_b16 a[186:187], v11 offset:512
    ds_read_b64_tr_b16 a[188:189], v11 offset:8192
    ds_read_b64_tr_b16 a[190:191], v11 offset:8704
    v_add_u32 v10, 49152, v7
    v_add_u32 v11, 49152, v8
    ds_read_b64_tr_b16 a[192:193], v10 offset:0
    ds_read_b64_tr_b16 a[194:195], v10 offset:512
    ds_read_b64_tr_b16 a[196:197], v10 offset:8192
    ds_read_b64_tr_b16 a[198:199], v10 offset:8704
    ds_read_b64_tr_b16 a[200:201], v11 offset:0
    ds_read_b64_tr_b16 a[202:203], v11 offset:512
    ds_read_b64_tr_b16 a[204:205], v11 offset:8192
    ds_read_b64_tr_b16 a[206:207], v11 offset:8704
    s_waitcnt lgkmcnt(0)
    s_barrier
    s_add_u32 m0, s69, 114688
    s_mov_b32 s68, 917504
    buffer_load_dwordx4 v5, s[52:55], s68 offen nt lds
    s_add_u32 m0, s69, 118784
    s_mov_b32 s68, 2097152
    buffer_load_dwordx4 v5, s[52:55], s68 offen nt lds
    s_add_u32 m0, s69, 122880
    s_mov_b32 s68, 3276800
    buffer_load_dwordx4 v5, s[52:55], s68 offen nt lds
    s_add_u32 m0, s69, 126976
    s_mov_b32 s68, 4456448
    buffer_load_dwordx4 v5, s[52:55], s68 offen nt lds
    s_add_u32 m0, s69, 131072
    s_mov_b32 s68, 1048576
    buffer_load_dwordx4 v5, s[52:55], s68 offen nt lds
    s_add_u32 m0, s69, 135168
    s_mov_b32 s68, 2228224
    buffer_load_dwordx4 v5, s[52:55], s68 offen nt lds
    s_add_u32 m0, s69, 139264
    s_mov_b32 s68, 3407872
    buffer_load_dwordx4 v5, s[52:55], s68 offen nt lds
    s_add_u32 m0, s69, 143360
    s_mov_b32 s68, 4587520
    buffer_load_dwordx4 v5, s[52:55], s68 offen nt lds
    s_waitcnt vmcnt(12)
    s_barrier
    v_add_u32 v10, 65536, v7
    v_add_u32 v11, 65536, v8
    ds_read_b64_tr_b16 a[208:209], v10 offset:0
    ds_read_b64_tr_b16 a[210:211], v10 offset:512
    ds_read_b64_tr_b16 a[212:213], v10 offset:8192
    ds_read_b64_tr_b16 a[214:215], v10 offset:8704
    ds_read_b64_tr_b16 a[216:217], v11 offset:0
    ds_read_b64_tr_b16 a[218:219], v11 offset:512
    ds_read_b64_tr_b16 a[220:221], v11 offset:8192
    ds_read_b64_tr_b16 a[222:223], v11 offset:8704
    v_add_u32 v10, 81920, v7
    v_add_u32 v11, 81920, v8
    ds_read_b64_tr_b16 a[224:225], v10 offset:0
    ds_read_b64_tr_b16 a[226:227], v10 offset:512
    ds_read_b64_tr_b16 a[228:229], v10 offset:8192
    ds_read_b64_tr_b16 a[230:231], v10 offset:8704
    ds_read_b64_tr_b16 a[232:233], v11 offset:0
    ds_read_b64_tr_b16 a[234:235], v11 offset:512
    ds_read_b64_tr_b16 a[236:237], v11 offset:8192
    ds_read_b64_tr_b16 a[238:239], v11 offset:8704
    s_waitcnt lgkmcnt(0)
    s_barrier
    s_add_u32 m0, s69, 147456
    s_mov_b32 s68, 0
    buffer_load_dwordx4 v5, s[60:63], s68 offen nt lds
    s_add_u32 m0, s69, 151552
    s_mov_b32 s68, 1179648
    buffer_load_dwordx4 v5, s[60:63], s68 offen nt lds
    s_add_u32 m0, s69, 155648
    s_mov_b32 s68, 2359296
    buffer_load_dwordx4 v5, s[60:63], s68 offen nt lds
    s_add_u32 m0, s69, 159744
    s_mov_b32 s68, 3538944
    buffer_load_dwordx4 v5, s[60:63], s68 offen nt lds
    s_cmp_eq_u32 s24, 1
    s_cselect_b32 s20, s14, s14
    s_cselect_b32 s21, s15, s15
    s_cselect_b32 s68, 48, 64
    s_and_b32 s21, s21, 0xffff
    s_lshl_b32 s68, s68, 13
    s_add_u32 s68, s68, s25
    buffer_load_dword v13, v39, s[20:23], s68 offen
    s_add_u32 m0, s69, 0
    s_mov_b32 s68, 0
    buffer_load_dwordx4 v5, s[56:59], s68 offen nt lds
    s_add_u32 m0, s69, 4096
    s_mov_b32 s68, 1179648
    buffer_load_dwordx4 v5, s[56:59], s68 offen nt lds
    s_add_u32 m0, s69, 8192
    s_mov_b32 s68, 2359296
    buffer_load_dwordx4 v5, s[56:59], s68 offen nt lds
    s_add_u32 m0, s69, 12288
    s_mov_b32 s68, 3538944
    buffer_load_dwordx4 v5, s[56:59], s68 offen nt lds
    s_waitcnt vmcnt(13)
    s_barrier
    v_add_u32 v10, 98304, v7
    v_add_u32 v11, 98304, v8
    ds_read_b64_tr_b16 a[240:241], v10 offset:0
    ds_read_b64_tr_b16 a[242:243], v10 offset:512
    ds_read_b64_tr_b16 a[244:245], v10 offset:8192
    ds_read_b64_tr_b16 a[246:247], v10 offset:8704
    ds_read_b64_tr_b16 a[248:249], v11 offset:0
    ds_read_b64_tr_b16 a[250:251], v11 offset:512
    ds_read_b64_tr_b16 a[252:253], v11 offset:8192
    ds_read_b64_tr_b16 a[254:255], v11 offset:8704
    v_add_u32 v10, 114688, v7
    v_add_u32 v11, 114688, v8
    ds_read_b64_tr_b16 v[64:65], v10 offset:0
    ds_read_b64_tr_b16 v[66:67], v10 offset:512
    ds_read_b64_tr_b16 v[68:69], v10 offset:8192
    ds_read_b64_tr_b16 v[70:71], v10 offset:8704
    ds_read_b64_tr_b16 v[72:73], v11 offset:0
    ds_read_b64_tr_b16 v[74:75], v11 offset:512
    ds_read_b64_tr_b16 v[76:77], v11 offset:8192
    ds_read_b64_tr_b16 v[78:79], v11 offset:8704
    s_waitcnt lgkmcnt(0)
    s_barrier
    s_add_u32 m0, s69, 16384
    s_mov_b32 s68, 131072
    buffer_load_dwordx4 v5, s[56:59], s68 offen nt lds
    s_add_u32 m0, s69, 20480
    s_mov_b32 s68, 1310720
    buffer_load_dwordx4 v5, s[56:59], s68 offen nt lds
    s_add_u32 m0, s69, 24576
    s_mov_b32 s68, 2490368
    buffer_load_dwordx4 v5, s[56:59], s68 offen nt lds
    s_add_u32 m0, s69, 28672
    s_mov_b32 s68, 3670016
    buffer_load_dwordx4 v5, s[56:59], s68 offen nt lds
    s_add_u32 m0, s69, 32768
    s_mov_b32 s68, 262144
    buffer_load_dwordx4 v5, s[56:59], s68 offen nt lds
    s_add_u32 m0, s69, 36864
    s_mov_b32 s68, 1441792
    buffer_load_dwordx4 v5, s[56:59], s68 offen nt lds
    s_add_u32 m0, s69, 40960
    s_mov_b32 s68, 2621440
    buffer_load_dwordx4 v5, s[56:59], s68 offen nt lds
    s_add_u32 m0, s69, 45056
    s_mov_b32 s68, 3801088
    buffer_load_dwordx4 v5, s[56:59], s68 offen nt lds
    s_waitcnt vmcnt(13)
    s_barrier
    v_add_u32 v10, 131072, v7
    v_add_u32 v11, 131072, v8
    ds_read_b64_tr_b16 v[80:81], v10 offset:0
    ds_read_b64_tr_b16 v[82:83], v10 offset:512
    ds_read_b64_tr_b16 v[84:85], v10 offset:8192
    ds_read_b64_tr_b16 v[86:87], v10 offset:8704
    ds_read_b64_tr_b16 v[88:89], v11 offset:0
    ds_read_b64_tr_b16 v[90:91], v11 offset:512
    ds_read_b64_tr_b16 v[92:93], v11 offset:8192
    ds_read_b64_tr_b16 v[94:95], v11 offset:8704
    v_add_u32 v10, 147456, v7
    v_add_u32 v11, 147456, v8
    ds_read_b64_tr_b16 v[240:241], v10 offset:0
    ds_read_b64_tr_b16 v[242:243], v10 offset:512
    ds_read_b64_tr_b16 v[244:245], v10 offset:8192
    ds_read_b64_tr_b16 v[246:247], v10 offset:8704
    ds_read_b64_tr_b16 v[248:249], v11 offset:0
    ds_read_b64_tr_b16 v[250:251], v11 offset:512
    ds_read_b64_tr_b16 v[252:253], v11 offset:8192
    ds_read_b64_tr_b16 v[254:255], v11 offset:8704
    s_waitcnt lgkmcnt(0)
    s_barrier
    s_add_u32 m0, s69, 49152
    s_mov_b32 s68, 393216
    buffer_load_dwordx4 v5, s[56:59], s68 offen nt lds
    s_add_u32 m0, s69, 53248
    s_mov_b32 s68, 1572864
    buffer_load_dwordx4 v5, s[56:59], s68 offen nt lds
    s_add_u32 m0, s69, 57344
    s_mov_b32 s68, 2752512
    buffer_load_dwordx4 v5, s[56:59], s68 offen nt lds
    s_add_u32 m0, s69, 61440
    s_mov_b32 s68, 3932160
    buffer_load_dwordx4 v5, s[56:59], s68 offen nt lds
    s_add_u32 m0, s69, 65536
    s_mov_b32 s68, 524288
    buffer_load_dwordx4 v5, s[56:59], s68 offen nt lds
    s_add_u32 m0, s69, 69632
    s_mov_b32 s68, 1703936
    buffer_load_dwordx4 v5, s[56:59], s68 offen nt lds
    s_add_u32 m0, s69, 73728
    s_mov_b32 s68, 2883584
    buffer_load_dwordx4 v5, s[56:59], s68 offen nt lds
    s_add_u32 m0, s69, 77824
    s_mov_b32 s68, 4063232
    buffer_load_dwordx4 v5, s[56:59], s68 offen nt lds
    s_waitcnt vmcnt(12)
    s_barrier
    v_add_u32 v10, 0, v7
    v_add_u32 v11, 0, v8
    ds_read_b64_tr_b16 v[96:97], v10 offset:0
    ds_read_b64_tr_b16 v[98:99], v10 offset:512
    ds_read_b64_tr_b16 v[100:101], v10 offset:8192
    ds_read_b64_tr_b16 v[102:103], v10 offset:8704
    ds_read_b64_tr_b16 v[104:105], v11 offset:0
    ds_read_b64_tr_b16 v[106:107], v11 offset:512
    ds_read_b64_tr_b16 v[108:109], v11 offset:8192
    ds_read_b64_tr_b16 v[110:111], v11 offset:8704
    v_add_u32 v10, 16384, v7
    v_add_u32 v11, 16384, v8
    ds_read_b64_tr_b16 v[112:113], v10 offset:0
    ds_read_b64_tr_b16 v[114:115], v10 offset:512
    ds_read_b64_tr_b16 v[116:117], v10 offset:8192
    ds_read_b64_tr_b16 v[118:119], v10 offset:8704
    ds_read_b64_tr_b16 v[120:121], v11 offset:0
    ds_read_b64_tr_b16 v[122:123], v11 offset:512
    ds_read_b64_tr_b16 v[124:125], v11 offset:8192
    ds_read_b64_tr_b16 v[126:127], v11 offset:8704
    s_waitcnt lgkmcnt(0)
    s_barrier
    s_cmp_eq_u32 s24, 1
    s_cselect_b32 s20, s14, s14
    s_cselect_b32 s21, s15, s15
    s_cselect_b32 s68, 7, 8
    s_lshl_b32 s68, s68, 4
    s_and_b32 s21, s21, 0xffff
    s_lshl_b32 s68, s68, 13
    s_add_u32 s68, s68, s25
    buffer_load_dword v13, v39, s[20:23], s68 offen
    s_add_u32 m0, s69, 81920
    s_mov_b32 s68, 655360
    buffer_load_dwordx4 v5, s[56:59], s68 offen nt lds
    s_add_u32 m0, s69, 86016
    s_mov_b32 s68, 1835008
    buffer_load_dwordx4 v5, s[56:59], s68 offen nt lds
    s_add_u32 m0, s69, 90112
    s_mov_b32 s68, 3014656
    buffer_load_dwordx4 v5, s[56:59], s68 offen nt lds
    s_add_u32 m0, s69, 94208
    s_mov_b32 s68, 4194304
    buffer_load_dwordx4 v5, s[56:59], s68 offen nt lds
    s_add_u32 m0, s69, 98304
    s_mov_b32 s68, 786432
    buffer_load_dwordx4 v5, s[56:59], s68 offen nt lds
    s_add_u32 m0, s69, 102400
    s_mov_b32 s68, 1966080
    buffer_load_dwordx4 v5, s[56:59], s68 offen nt lds
    s_add_u32 m0, s69, 106496
    s_mov_b32 s68, 3145728
    buffer_load_dwordx4 v5, s[56:59], s68 offen nt lds
    s_add_u32 m0, s69, 110592
    s_mov_b32 s68, 4325376
    buffer_load_dwordx4 v5, s[56:59], s68 offen nt lds
    s_waitcnt vmcnt(13)
    s_barrier
    v_add_u32 v10, 32768, v7
    v_add_u32 v11, 32768, v8
    ds_read_b64_tr_b16 v[128:129], v10 offset:0
    ds_read_b64_tr_b16 v[130:131], v10 offset:512
    ds_read_b64_tr_b16 v[132:133], v10 offset:8192
    ds_read_b64_tr_b16 v[134:135], v10 offset:8704
    ds_read_b64_tr_b16 v[136:137], v11 offset:0
    ds_read_b64_tr_b16 v[138:139], v11 offset:512
    ds_read_b64_tr_b16 v[140:141], v11 offset:8192
    ds_read_b64_tr_b16 v[142:143], v11 offset:8704
    v_add_u32 v10, 49152, v7
    v_add_u32 v11, 49152, v8
    ds_read_b64_tr_b16 v[144:145], v10 offset:0
    ds_read_b64_tr_b16 v[146:147], v10 offset:512
    ds_read_b64_tr_b16 v[148:149], v10 offset:8192
    ds_read_b64_tr_b16 v[150:151], v10 offset:8704
    ds_read_b64_tr_b16 v[152:153], v11 offset:0
    ds_read_b64_tr_b16 v[154:155], v11 offset:512
    ds_read_b64_tr_b16 v[156:157], v11 offset:8192
    ds_read_b64_tr_b16 v[158:159], v11 offset:8704
    s_waitcnt lgkmcnt(0)
    s_barrier
    v_readlane_b32 s98, v15, 51
    s_cmp_ge_u32 s98, 128
    s_cbranch_scc0 dno_15
    s_mov_b32 s99, 0
    v_readlane_b32 s98, v15, 0
    s_add_u32 s99, s99, s98
    v_readlane_b32 s98, v15, 16
    s_add_u32 s99, s99, s98
    v_readlane_b32 s98, v15, 32
    s_add_u32 s99, s99, s98
    v_readlane_b32 s98, v15, 33
    s_add_u32 s99, s99, s98
    v_readlane_b32 s98, v15, 34
    s_add_u32 s99, s99, s98
    v_readlane_b32 s98, v15, 48
    s_add_u32 s99, s99, s98
    v_readlane_b32 s98, v15, 49
    s_add_u32 s99, s99, s98
    v_readlane_b32 s98, v15, 50
    s_add_u32 s99, s99, s98
    s_cmp_ge_u32 s99, 256
    s_cbranch_scc1 CH_DOK
dno_15:
waitd_16:
    buffer_load_dword v15, v14, s[48:51], 0 offen sc1
    s_waitcnt vmcnt(0)
    v_readlane_b32 s98, v15, 51
    s_cmp_ge_u32 s98, 128
    s_cbranch_scc0 dno_18
    s_mov_b32 s99, 0
    v_readlane_b32 s98, v15, 0
    s_add_u32 s99, s99, s98
    v_readlane_b32 s98, v15, 16
    s_add_u32 s99, s99, s98
    v_readlane_b32 s98, v15, 32
    s_add_u32 s99, s99, s98
    v_readlane_b32 s98, v15, 33
    s_add_u32 s99, s99, s98
    v_readlane_b32 s98, v15, 34
    s_add_u32 s99, s99, s98
    v_readlane_b32 s98, v15, 48
    s_add_u32 s99, s99, s98
    v_readlane_b32 s98, v15, 49
    s_add_u32 s99, s99, s98
    v_readlane_b32 s98, v15, 50
    s_add_u32 s99, s99, s98
    s_cmp_ge_u32 s99, 256
    s_cbranch_scc1 waitd_done_17
dno_18:
    s_sleep 8
    s_add_u32 s100, s100, 1
    s_cmp_lt_u32 s100, 262144
    s_cbranch_scc1 spin_ok_19
    s_mov_b32 s98, 1
    s_branch FAIL
spin_ok_19:
    s_branch waitd_16
waitd_done_17:
CH_DOK:
    s_mov_b32 s7, 0
    v_readlane_b32 s98, v15, 0
    s_cmp_lg_u32 s98, 32
    s_cselect_b32 s7, 1, s7
    v_readlane_b32 s98, v15, 16
    s_cmp_lg_u32 s98, 32
    s_cselect_b32 s7, 1, s7
    v_readlane_b32 s98, v15, 32
    s_cmp_lg_u32 s98, 32
    s_cselect_b32 s7, 1, s7
    v_readlane_b32 s98, v15, 33
    s_cmp_lg_u32 s98, 32
    s_cselect_b32 s7, 1, s7
    v_readlane_b32 s98, v15, 34
    s_cmp_lg_u32 s98, 32
    s_cselect_b32 s7, 1, s7
    v_readlane_b32 s98, v15, 48
    s_cmp_lg_u32 s98, 32
    s_cselect_b32 s7, 1, s7
    v_readlane_b32 s98, v15, 49
    s_cmp_lg_u32 s98, 32
    s_cselect_b32 s7, 1, s7
    v_readlane_b32 s98, v15, 50
    s_cmp_lg_u32 s98, 32
    s_cselect_b32 s7, 1, s7
    s_add_u32 m0, s69, 114688
    s_mov_b32 s68, 917504
    buffer_load_dwordx4 v5, s[56:59], s68 offen nt lds
    s_add_u32 m0, s69, 118784
    s_mov_b32 s68, 2097152
    buffer_load_dwordx4 v5, s[56:59], s68 offen nt lds
    s_add_u32 m0, s69, 122880
    s_mov_b32 s68, 3276800
    buffer_load_dwordx4 v5, s[56:59], s68 offen nt lds
    s_add_u32 m0, s69, 126976
    s_mov_b32 s68, 4456448
    buffer_load_dwordx4 v5, s[56:59], s68 offen nt lds
    s_add_u32 m0, s69, 131072
    s_mov_b32 s68, 1048576
    buffer_load_dwordx4 v5, s[56:59], s68 offen nt lds
    s_add_u32 m0, s69, 135168
    s_mov_b32 s68, 2228224
    buffer_load_dwordx4 v5, s[56:59], s68 offen nt lds
    s_add_u32 m0, s69, 139264
    s_mov_b32 s68, 3407872
    buffer_load_dwordx4 v5, s[56:59], s68 offen nt lds
    s_add_u32 m0, s69, 143360
    s_mov_b32 s68, 4587520
    buffer_load_dwordx4 v5, s[56:59], s68 offen nt lds
    s_waitcnt vmcnt(12)
    s_barrier
    v_add_u32 v10, 65536, v7
    v_add_u32 v11, 65536, v8
    ds_read_b64_tr_b16 v[160:161], v10 offset:0
    ds_read_b64_tr_b16 v[162:163], v10 offset:512
    ds_read_b64_tr_b16 v[164:165], v10 offset:8192
    ds_read_b64_tr_b16 v[166:167], v10 offset:8704
    ds_read_b64_tr_b16 v[168:169], v11 offset:0
    ds_read_b64_tr_b16 v[170:171], v11 offset:512
    ds_read_b64_tr_b16 v[172:173], v11 offset:8192
    ds_read_b64_tr_b16 v[174:175], v11 offset:8704
    v_add_u32 v10, 81920, v7
    v_add_u32 v11, 81920, v8
    ds_read_b64_tr_b16 v[176:177], v10 offset:0
    ds_read_b64_tr_b16 v[178:179], v10 offset:512
    ds_read_b64_tr_b16 v[180:181], v10 offset:8192
    ds_read_b64_tr_b16 v[182:183], v10 offset:8704
    ds_read_b64_tr_b16 v[184:185], v11 offset:0
    ds_read_b64_tr_b16 v[186:187], v11 offset:512
    ds_read_b64_tr_b16 v[188:189], v11 offset:8192
    ds_read_b64_tr_b16 v[190:191], v11 offset:8704
    s_waitcnt lgkmcnt(0)
    s_barrier
    s_cmp_eq_u32 s24, 1
    s_cselect_b32 s20, s16, s16
    s_cselect_b32 s21, s17, s17
    s_cselect_b32 s68, 4, 5
    s_lshl_b32 s68, s68, 4
    s_and_b32 s21, s21, 0xffff
    s_lshl_b32 s68, s68, 13
    s_add_u32 s68, s68, s25
    buffer_load_dword v13, v39, s[20:23], s68 offen
    s_add_u32 m0, s69, 0
    s_mov_b32 s68, 131072
    buffer_load_dwordx4 v5, s[60:63], s68 offen nt lds
    s_add_u32 m0, s69, 4096
    s_mov_b32 s68, 1310720
    buffer_load_dwordx4 v5, s[60:63], s68 offen nt lds
    s_add_u32 m0, s69, 8192
    s_mov_b32 s68, 2490368
    buffer_load_dwordx4 v5, s[60:63], s68 offen nt lds
    s_add_u32 m0, s69, 12288
    s_mov_b32 s68, 3670016
    buffer_load_dwordx4 v5, s[60:63], s68 offen nt lds
    s_waitcnt vmcnt(9)
    s_barrier
    v_add_u32 v10, 98304, v7
    v_add_u32 v11, 98304, v8
    ds_read_b64_tr_b16 v[192:193], v10 offset:0
    ds_read_b64_tr_b16 v[194:195], v10 offset:512
    ds_read_b64_tr_b16 v[196:197], v10 offset:8192
    ds_read_b64_tr_b16 v[198:199], v10 offset:8704
    ds_read_b64_tr_b16 v[200:201], v11 offset:0
    ds_read_b64_tr_b16 v[202:203], v11 offset:512
    ds_read_b64_tr_b16 v[204:205], v11 offset:8192
    ds_read_b64_tr_b16 v[206:207], v11 offset:8704
    v_add_u32 v10, 114688, v7
    v_add_u32 v11, 114688, v8
    ds_read_b64_tr_b16 v[208:209], v10 offset:0
    ds_read_b64_tr_b16 v[210:211], v10 offset:512
    ds_read_b64_tr_b16 v[212:213], v10 offset:8192
    ds_read_b64_tr_b16 v[214:215], v10 offset:8704
    ds_read_b64_tr_b16 v[216:217], v11 offset:0
    ds_read_b64_tr_b16 v[218:219], v11 offset:512
    ds_read_b64_tr_b16 v[220:221], v11 offset:8192
    ds_read_b64_tr_b16 v[222:223], v11 offset:8704
    s_waitcnt lgkmcnt(0)
    s_barrier
    v_mov_b32 v14, v0
    v_mov_b32 v58, v5
    v_mov_b32 v59, v39
    v_mov_b32 v60, v7
    v_mov_b32 v61, v8
    v_lshlrev_b32 v16, 4, v0
    v_add_u32 v4, 131072, v16
    v_add_u32 v5, s69, v4
    v_and_b32 v17, 15, v0
    v_lshrrev_b32 v20, 4, v0
    v_bfe_u32 v22, v0, 1, 1
    v_mul_u32_u24 v23, 1088, v20
    v_lshl_add_u32 v23, v17, 3, v23
    s_lshl_b32 s98, s3, 8
    s_add_u32 s98, s98, 156672
    v_add_u32 v6, s98, v23
    v_bfe_u32 v23, v0, 2, 2
    v_bfe_u32 v18, v0, 4, 1
    v_lshrrev_b32 v19, 5, v0
    v_lshl_add_u32 v23, v18, 2, v23
    v_lshl_add_u32 v23, v19, 4, v23
    v_and_b32 v24, 3, v0
    v_mul_u32_u24 v24, 1088, v24
    v_lshl_add_u32 v23, v23, 3, v24
    v_add_u32 v7, 156672, v23
    v_and_b32 v23, 0x3d, v0
    v_lshlrev_b32 v23, 4, v23
    s_lshr_b32 s98, s3, 1
    s_lshl_b32 s98, s98, 10
    s_and_b32 s99, s3, 1
    s_lshl_b32 s99, s99, 5
    s_add_u32 s98, s98, s99
    s_add_u32 s98, s98, 161024
    v_add_u32 v8, s98, v23
    s_mov_b32 s94, 0xcccccccc
    s_mov_b32 s95, 0xcccccccc
    v_cmp_eq_u32 vcc, 1, v22
    v_mov_b32 v23, 0x44444444
    v_mov_b32 v24, 0xeeeeeeee
    v_cndmask_b32 v30, v23, v24, vcc
    v_and_b32 v24, 1, v0
    v_lshrrev_b32 v23, 3, v0
    v_mul_u32_u24 v23, 9216, v23
    v_and_b32 v21, 7, v0
    v_lshl_add_u32 v9, v21, 4, v23
    v_mov_b32 v23, 0x3f80
    v_mov_b32 v25, 0x3f800000
    v_cmp_eq_u32 vcc, 1, v24
    s_nop 1
    v_cndmask_b32 v23, v23, v25, vcc
    v_lshrrev_b32 v25, 1, v17
    v_cmp_eq_u32 vcc, 0, v25
    s_nop 1
    v_cndmask_b32 v48, 0, v23, vcc
    v_cmp_eq_u32 vcc, 1, v25
    s_nop 1
    v_cndmask_b32 v49, 0, v23, vcc
    v_cmp_eq_u32 vcc, 2, v25
    s_nop 1
    v_cndmask_b32 v50, 0, v23, vcc
    v_cmp_eq_u32 vcc, 3, v25
    s_nop 1
    v_cndmask_b32 v51, 0, v23, vcc
    s_mul_i32 s68, s6, 294912
    s_add_u32 s68, s68, 196608
    s_mul_i32 s79, s5, 9216
    s_add_u32 s79, s79, s68
    s_mul_i32 s98, s3, 2304
    s_add_u32 s79, s79, s98
    s_lshr_b32 s96, s5, 3
    s_lshl_b32 s98, s3, 2
    s_add_u32 s96, s96, s98
    s_and_b32 s97, s5, 7
    s_lshr_b32 s98, s5, 2
    s_cmp_eq_u32 s3, 2
    s_cselect_b32 s96, 8, s96
    s_cselect_b32 s97, s98, s97
    s_cselect_b32 s52, s98, s5
    v_lshlrev_b32 v23, 2, v25
    v_lshl_add_u32 v23, v24, 4, v23
    v_lshl_add_u32 v23, v18, 6, v23
    v_lshl_add_u32 v23, v19, 5, v23
    s_lshl_b32 s98, s96, 10
    s_lshl_b32 s99, s97, 7
    s_add_u32 s99, s99, s98
    v_add_u32 v23, s99, v23
    v_mov_b32 v26, 1073741824
    v_cmp_gt_u32 vcc, 8, v17
    s_nop 1
    v_cndmask_b32 v10, v26, v23, vcc
    s_lshl_b32 s96, s96, 8
    s_add_u32 s80, s68, s96
    s_lshr_b32 s98, s97, 1
    s_mul_i32 s98, s98, 2304
    s_add_u32 s80, s80, s98
    s_and_b32 s98, s97, 1
    s_lshl_b32 s98, s98, 7
    s_add_u32 s80, s80, s98
    s_add_u32 s81, s80, 73728
    s_add_u32 s82, s80, 147456
    s_add_u32 s83, s80, 221184
    s_and_b32 s98, s5, 3
    s_cmp_eq_u32 s98, 0
    s_cselect_b32 s98, 1, 2
    s_cmp_eq_u32 s3, 2
    s_cselect_b32 s57, s98, s3
    s_lshl_b32 s98, s3, 5
    s_add_u32 s72, s98, s5
    s_lshl_b32 s98, s6, 15
    s_add_u32 s98, s98, 131072
    s_add_u32 s53, s98, 0x100
    s_add_u32 s99, s5, s98
    s_cmp_eq_u32 s3, 3
    s_cselect_b32 s56, s99, 1073741824
    s_cselect_b32 s59, s53, s98
    s_lshl_b32 s99, s3, 5
    s_add_u32 s52, s52, s99
    s_add_u32 s52, s52, s53
    s_cmp_lt_u32 s72, 32
    s_cselect_b32 s52, s52, 1073741824
    s_cmp_eq_u32 s3, 3
    s_cselect_b32 s78, s78, 1073741824
    s_mov_b32 s86, 16384
    s_mov_b32 s58, 0xfff
    s_lshl_b32 s98, s5, 9
    s_min_u32 s98, s98, 8704
    s_add_u32 s98, s98, s73
    s_add_u32 s98, s98, 9216
    s_cmp_eq_u32 s3, 2
    s_cselect_b32 s88, s98, s88
    s_cselect_b32 s86, 9216, s86
    s_cselect_b32 s58, 0x180, s58
    s_cmp_eq_u32 s3, 3
    s_cselect_b32 s88, s77, s88
    s_cselect_b32 s86, 0, s86
    s_cselect_b32 s58, 0, s58
    s_mov_b32 s84, 1040356334
    s_mov_b32 s85, 1040356334
    s_mov_b32 s70, 0
    v_mov_b32 v0, v30
    s_waitcnt lgkmcnt(0)
    s_add_u32 m0, s69, 16384
    s_mov_b32 s68, 262144
    buffer_load_dwordx4 v58, s[60:63], s68 offen nt lds
    s_add_u32 m0, s69, 20480
    s_mov_b32 s68, 1441792
    buffer_load_dwordx4 v58, s[60:63], s68 offen nt lds
    s_add_u32 m0, s69, 24576
    s_mov_b32 s68, 2621440
    buffer_load_dwordx4 v58, s[60:63], s68 offen nt lds
    s_add_u32 m0, s69, 28672
    s_mov_b32 s68, 3801088
    buffer_load_dwordx4 v58, s[60:63], s68 offen nt lds
    s_add_u32 m0, s69, 32768
    s_mov_b32 s68, 393216
    buffer_load_dwordx4 v58, s[60:63], s68 offen nt lds
    s_add_u32 m0, s69, 36864
    s_mov_b32 s68, 1572864
    buffer_load_dwordx4 v58, s[60:63], s68 offen nt lds
    s_add_u32 m0, s69, 40960
    s_mov_b32 s68, 2752512
    buffer_load_dwordx4 v58, s[60:63], s68 offen nt lds
    s_add_u32 m0, s69, 45056
    s_mov_b32 s68, 3932160
    buffer_load_dwordx4 v58, s[60:63], s68 offen nt lds
    s_waitcnt vmcnt(13)
    s_barrier
    v_add_u32 v62, 131072, v60
    v_add_u32 v63, 131072, v61
    ds_read_b64_tr_b16 v[224:225], v62 offset:0
    ds_read_b64_tr_b16 v[226:227], v62 offset:512
    ds_read_b64_tr_b16 v[228:229], v62 offset:8192
    ds_read_b64_tr_b16 v[230:231], v62 offset:8704
    ds_read_b64_tr_b16 v[232:233], v63 offset:0
    ds_read_b64_tr_b16 v[234:235], v63 offset:512
    ds_read_b64_tr_b16 v[236:237], v63 offset:8192
    ds_read_b64_tr_b16 v[238:239], v63 offset:8704
    s_waitcnt lgkmcnt(0)
    s_barrier
    buffer_load_dword v15, off, s[44:47], s77 sc1
    s_add_u32 m0, s69, 49152
    s_mov_b32 s68, 524288
    buffer_load_dwordx4 v58, s[60:63], s68 offen nt lds
    s_add_u32 m0, s69, 53248
    s_mov_b32 s68, 1703936
    buffer_load_dwordx4 v58, s[60:63], s68 offen nt lds
    s_add_u32 m0, s69, 57344
    s_mov_b32 s68, 2883584
    buffer_load_dwordx4 v58, s[60:63], s68 offen nt lds
    s_add_u32 m0, s69, 61440
    s_mov_b32 s68, 4063232
    buffer_load_dwordx4 v58, s[60:63], s68 offen nt lds
    s_add_u32 m0, s69, 65536
    s_mov_b32 s68, 655360
    buffer_load_dwordx4 v58, s[60:63], s68 offen nt lds
    s_add_u32 m0, s69, 69632
    s_mov_b32 s68, 1835008
    buffer_load_dwordx4 v58, s[60:63], s68 offen nt lds
    s_add_u32 m0, s69, 73728
    s_mov_b32 s68, 3014656
    buffer_load_dwordx4 v58, s[60:63], s68 offen nt lds
    s_add_u32 m0, s69, 77824
    s_mov_b32 s68, 4194304
    buffer_load_dwordx4 v58, s[60:63], s68 offen nt lds
    s_waitcnt vmcnt(13)
    s_barrier
    v_add_u32 v62, 0, v60
    v_add_u32 v63, 0, v61
    ds_read_b64_tr_b16 v[16:17], v62 offset:0
    ds_read_b64_tr_b16 v[18:19], v62 offset:512
    ds_read_b64_tr_b16 v[20:21], v62 offset:8192
    ds_read_b64_tr_b16 v[22:23], v62 offset:8704
    ds_read_b64_tr_b16 v[24:25], v63 offset:0
    ds_read_b64_tr_b16 v[26:27], v63 offset:512
    ds_read_b64_tr_b16 v[28:29], v63 offset:8192
    ds_read_b64_tr_b16 v[30:31], v63 offset:8704
    v_add_u32 v62, 16384, v60
    v_add_u32 v63, 16384, v61
    ds_read_b64_tr_b16 v[32:33], v62 offset:0
    ds_read_b64_tr_b16 v[34:35], v62 offset:512
    ds_read_b64_tr_b16 v[36:37], v62 offset:8192
    ds_read_b64_tr_b16 v[38:39], v62 offset:8704
    ds_read_b64_tr_b16 v[40:41], v63 offset:0
    ds_read_b64_tr_b16 v[42:43], v63 offset:512
    ds_read_b64_tr_b16 v[44:45], v63 offset:8192
    ds_read_b64_tr_b16 v[46:47], v63 offset:8704
    s_waitcnt lgkmcnt(0)
    s_barrier
    ds_write_b128 v2, v[16:19] offset:0
    ds_write_b128 v2, v[20:23] offset:1024
    ds_write_b128 v2, v[24:27] offset:2048
    ds_write_b128 v2, v[28:31] offset:3072
    ds_write_b128 v2, v[32:35] offset:16384
    ds_write_b128 v2, v[36:39] offset:17408
    ds_write_b128 v2, v[40:43] offset:18432
    ds_write_b128 v2, v[44:47] offset:19456
    s_waitcnt lgkmcnt(0)
    s_cmp_eq_u32 s24, 1
    s_cselect_b32 s20, s16, s16
    s_cselect_b32 s21, s17, s17
    s_cselect_b32 s68, 7, 8
    s_lshl_b32 s68, s68, 4
    s_and_b32 s21, s21, 0xffff
    s_lshl_b32 s68, s68, 13
    s_add_u32 s68, s68, s25
    buffer_load_dword v13, v59, s[20:23], s68 offen
    s_add_u32 m0, s69, 81920
    s_mov_b32 s68, 786432
    buffer_load_dwordx4 v58, s[60:63], s68 offen nt lds
    s_add_u32 m0, s69, 86016
    s_mov_b32 s68, 1966080
    buffer_load_dwordx4 v58, s[60:63], s68 offen nt lds
    s_add_u32 m0, s69, 90112
    s_mov_b32 s68, 3145728
    buffer_load_dwordx4 v58, s[60:63], s68 offen nt lds
    s_add_u32 m0, s69, 94208
    s_mov_b32 s68, 4325376
    buffer_load_dwordx4 v58, s[60:63], s68 offen nt lds
    s_add_u32 m0, s69, 98304
    s_mov_b32 s68, 917504
    buffer_load_dwordx4 v58, s[60:63], s68 offen nt lds
    s_add_u32 m0, s69, 102400
    s_mov_b32 s68, 2097152
    buffer_load_dwordx4 v58, s[60:63], s68 offen nt lds
    s_add_u32 m0, s69, 106496
    s_mov_b32 s68, 3276800
    buffer_load_dwordx4 v58, s[60:63], s68 offen nt lds
    s_add_u32 m0, s69, 110592
    s_mov_b32 s68, 4456448
    buffer_load_dwordx4 v58, s[60:63], s68 offen nt lds
    s_waitcnt vmcnt(13)
    s_barrier
    v_add_u32 v62, 32768, v60
    v_add_u32 v63, 32768, v61
    ds_read_b64_tr_b16 v[16:17], v62 offset:0
    ds_read_b64_tr_b16 v[18:19], v62 offset:512
    ds_read_b64_tr_b16 v[20:21], v62 offset:8192
    ds_read_b64_tr_b16 v[22:23], v62 offset:8704
    ds_read_b64_tr_b16 v[24:25], v63 offset:0
    ds_read_b64_tr_b16 v[26:27], v63 offset:512
    ds_read_b64_tr_b16 v[28:29], v63 offset:8192
    ds_read_b64_tr_b16 v[30:31], v63 offset:8704
    v_add_u32 v62, 49152, v60
    v_add_u32 v63, 49152, v61
    ds_read_b64_tr_b16 v[32:33], v62 offset:0
    ds_read_b64_tr_b16 v[34:35], v62 offset:512
    ds_read_b64_tr_b16 v[36:37], v62 offset:8192
    ds_read_b64_tr_b16 v[38:39], v62 offset:8704
    ds_read_b64_tr_b16 v[40:41], v63 offset:0
    ds_read_b64_tr_b16 v[42:43], v63 offset:512
    ds_read_b64_tr_b16 v[44:45], v63 offset:8192
    ds_read_b64_tr_b16 v[46:47], v63 offset:8704
    s_waitcnt lgkmcnt(0)
    s_barrier
    ds_write_b128 v2, v[16:19] offset:32768
    ds_write_b128 v2, v[20:23] offset:33792
    ds_write_b128 v2, v[24:27] offset:34816
    ds_write_b128 v2, v[28:31] offset:35840
    ds_write_b128 v2, v[32:35] offset:49152
    ds_write_b128 v2, v[36:39] offset:50176
    ds_write_b128 v2, v[40:43] offset:51200
    ds_write_b128 v2, v[44:47] offset:52224
    s_waitcnt lgkmcnt(0)
    s_waitcnt vmcnt(17)
    v_mov_b32 v12, 1
    buffer_store_dword v12, off, s[44:47], s78 offset:64 sc1
    v_readfirstlane_b32 s98, v15
    s_mov_b32 s87, 0
    s_cmp_ge_u32 s98, 1
    s_cbranch_scc0 CH_NOKV
    s_mov_b32 m0, s90
    s_mov_b32 s87, 1
    buffer_load_dwordx4 v4, s[44:47], s75 offen offset:0 sc1 lds
    buffer_load_dwordx4 v4, s[44:47], s75 offen offset:1024 sc1 lds
    v_lshlrev_b32 v12, 5, v14
    s_add_u32 s98, s75, 139264
    buffer_load_dword v13, v12, s[44:47], s98 offen sc1
CH_NOKV:
    s_add_u32 m0, s69, 114688
    s_mov_b32 s68, 1048576
    buffer_load_dwordx4 v58, s[60:63], s68 offen nt lds
    s_add_u32 m0, s69, 118784
    s_mov_b32 s68, 2228224
    buffer_load_dwordx4 v58, s[60:63], s68 offen nt lds
    s_add_u32 m0, s69, 122880
    s_mov_b32 s68, 3407872
    buffer_load_dwordx4 v58, s[60:63], s68 offen nt lds
    s_add_u32 m0, s69, 126976
    s_mov_b32 s68, 4587520
    buffer_load_dwordx4 v58, s[60:63], s68 offen nt lds
    v_lshlrev_b32 v12, 7, v14
    s_lshl_b32 s98, s3, 13
    s_add_u32 s98, s98, s73
    buffer_load_dword v13, v12, s[44:47], s98 offen sc1
    s_lshl_b32 s98, s6, 5
    s_add_u32 s98, s98, s5
    s_mul_i32 s98, s98, 9216
    s_mul_i32 s99, s3, 2304
    s_add_u32 s98, s98, s99
    s_add_u32 s98, s98, 196608
    v_mul_u32_u24 v12, 36, v14
    buffer_load_dword v13, v12, s[44:47], s98 offen sc1
    s_waitcnt vmcnt(11)
    s_barrier
    v_add_u32 v62, 65536, v60
    v_add_u32 v63, 65536, v61
    ds_read_b64_tr_b16 v[16:17], v62 offset:0
    ds_read_b64_tr_b16 v[18:19], v62 offset:512
    ds_read_b64_tr_b16 v[20:21], v62 offset:8192
    ds_read_b64_tr_b16 v[22:23], v62 offset:8704
    ds_read_b64_tr_b16 v[24:25], v63 offset:0
    ds_read_b64_tr_b16 v[26:27], v63 offset:512
    ds_read_b64_tr_b16 v[28:29], v63 offset:8192
    ds_read_b64_tr_b16 v[30:31], v63 offset:8704
    v_add_u32 v62, 81920, v60
    v_add_u32 v63, 81920, v61
    ds_read_b64_tr_b16 v[32:33], v62 offset:0
    ds_read_b64_tr_b16 v[34:35], v62 offset:512
    ds_read_b64_tr_b16 v[36:37], v62 offset:8192
    ds_read_b64_tr_b16 v[38:39], v62 offset:8704
    ds_read_b64_tr_b16 v[40:41], v63 offset:0
    ds_read_b64_tr_b16 v[42:43], v63 offset:512
    ds_read_b64_tr_b16 v[44:45], v63 offset:8192
    ds_read_b64_tr_b16 v[46:47], v63 offset:8704
    s_waitcnt lgkmcnt(0)
    s_barrier
    ds_write_b128 v3, v[16:19] offset:0
    ds_write_b128 v3, v[20:23] offset:1024
    ds_write_b128 v3, v[24:27] offset:2048
    ds_write_b128 v3, v[28:31] offset:3072
    ds_write_b128 v3, v[32:35] offset:16384
    ds_write_b128 v3, v[36:39] offset:17408
    ds_write_b128 v3, v[40:43] offset:18432
    ds_write_b128 v3, v[44:47] offset:19456
    s_waitcnt lgkmcnt(0)
    buffer_load_dword v11, off, s[44:47], s77 sc1
    s_waitcnt vmcnt(3)
    s_barrier
    v_add_u32 v62, 98304, v60
    v_add_u32 v63, 98304, v61
    ds_read_b64_tr_b16 v[16:17], v62 offset:0
    ds_read_b64_tr_b16 v[18:19], v62 offset:512
    ds_read_b64_tr_b16 v[20:21], v62 offset:8192
    ds_read_b64_tr_b16 v[22:23], v62 offset:8704
    ds_read_b64_tr_b16 v[24:25], v63 offset:0
    ds_read_b64_tr_b16 v[26:27], v63 offset:512
    ds_read_b64_tr_b16 v[28:29], v63 offset:8192
    ds_read_b64_tr_b16 v[30:31], v63 offset:8704
    v_add_u32 v62, 114688, v60
    v_add_u32 v63, 114688, v61
    ds_read_b64_tr_b16 v[32:33], v62 offset:0
    ds_read_b64_tr_b16 v[34:35], v62 offset:512
    ds_read_b64_tr_b16 v[36:37], v62 offset:8192
    ds_read_b64_tr_b16 v[38:39], v62 offset:8704
    ds_read_b64_tr_b16 v[40:41], v63 offset:0
    ds_read_b64_tr_b16 v[42:43], v63 offset:512
    ds_read_b64_tr_b16 v[44:45], v63 offset:8192
    ds_read_b64_tr_b16 v[46:47], v63 offset:8704
    s_waitcnt lgkmcnt(0)
    s_barrier
    ds_write_b128 v3, v[16:19] offset:32768
    ds_write_b128 v3, v[20:23] offset:33792
    ds_write_b128 v3, v[24:27] offset:34816
    ds_write_b128 v3, v[28:31] offset:35840
    ds_write_b128 v3, v[32:35] offset:49152
    ds_write_b128 v3, v[36:39] offset:50176
    ds_write_b128 v3, v[40:43] offset:51200
    ds_write_b128 v3, v[44:47] offset:52224
    s_waitcnt lgkmcnt(0)
    ds_write_b128 v4, v[48:51] offset:0
    ds_write_b128 v5, v[248:251] offset:1024
    ds_write_b128 v5, v[252:255] offset:5120
CH_KV0:
    s_waitcnt vmcnt(0)
    v_readfirstlane_b32 s98, v11
    s_cmp_ge_u32 s98, 2
    s_cbranch_scc1 CH_KV0OK
    buffer_load_dword v11, off, s[44:47], s77 sc1
    s_add_u32 s100, s100, 1
    s_cmp_lt_u32 s100, 262144
    s_cbranch_scc1 spin_ok_20
    s_mov_b32 s98, 2
    s_branch FAIL
spin_ok_20:
    s_branch CH_KV0
CH_KV0OK:
    s_cmp_eq_u32 s87, 1
    s_cbranch_scc1 CH_INIT
    s_mov_b32 m0, s90
    s_nop 0
    buffer_load_dwordx4 v4, s[44:47], s75 offen offset:0 sc1 lds
    buffer_load_dwordx4 v4, s[44:47], s75 offen offset:1024 sc1 lds
    s_waitcnt vmcnt(0)
CH_INIT:
    s_waitcnt lgkmcnt(0)
    v_mov_b64 v[40:41], 0
    v_mov_b64 v[42:43], 0
    v_mov_b64 v[44:45], 0
    v_mov_b64 v[46:47], 0
    v_mov_b64 v[48:49], 0
    v_mov_b64 v[50:51], 0
    v_mov_b64 v[52:53], 0
    v_mov_b64 v[54:55], 0
    v_mov_b64 v[56:57], 0
    v_mov_b64 v[58:59], 0
    v_mov_b64 v[60:61], 0
    v_mov_b64 v[62:63], 0
    s_sub_u32 s71, s73, 131072
    s_add_u32 s93, s71, 4096
    s_add_u32 s74, s71, 8192
    s_add_u32 s73, s73, 9216
    s_mov_b32 s87, 0
    s_mov_b32 s89, 0
    v_mov_b32 v1, -1
CH_NOT3:
    s_add_u32 s64, s44, s53
    s_addc_u32 s65, s45, 0
    s_mov_b32 s66, 72
    s_mov_b32 s67, 0x20000
    s_mov_b32 s59, 0x01010101
    s_mov_b32 s53, -1
    s_cmp_eq_u32 s7, 0
    s_cbranch_scc0 CH_safe0_ENTER
    s_branch CH_fast0_ENTER
.p2align 6
CH_fast0_ENTER3:
CH_fast0_ENTER:
    s_barrier
    s_mov_b64 exec, -1
    buffer_load_dwordx4 v[248:251], v4, s[44:47], s71 offen offset:0
    ds_read_b128 v[24:27], v2 offset:0
    ds_read_b128 v[28:31], v2 offset:1024
    ds_read_b128 v[32:35], v5 offset:1024
    ds_read_b128 v[36:39], v5 offset:5120
    buffer_load_dwordx4 v[16:19], v4, s[44:47], s71 offen offset:1024
    s_add_u32 s91, s92, 4096
    s_add_u32 m0, s90, 8192
    s_add_u32 s75, s75, 16384
    s_add_u32 s88, s88, s86
    v_lshlrev_b32 v11, 2, v4
    v_and_b32 v11, s58, v11
    buffer_load_dwordx4 v[20:23], v4, s[44:47], s71 offen offset:2048
    s_waitcnt vmcnt(2)
    v_smfmac_f32_16x16x64_bf16 v[56:59], v[248:251], v[240:247], v0
    buffer_load_dwordx4 v[12:15], v4, s[44:47], s71 offen offset:3072
    v_smfmac_f32_16x16x64_bf16 v[40:43], v[248:251], a[144:151], v0
    v_smfmac_f32_16x16x64_bf16 v[44:47], v[248:251], a[152:159], v0
    s_waitcnt lgkmcnt(0)
    v_smfmac_f32_16x16x64_bf16 v[60:63], v[248:251], v[32:39], v0
    ds_read_b128 v[32:35], v2 offset:2048
    v_smfmac_f32_16x16x64_bf16 v[48:51], v[248:251], v[96:103], v0
    ds_read_b128 v[36:39], v2 offset:3072
    buffer_load_dwordx4 v[252:255], v4, s[44:47], s93 offen offset:0
    v_smfmac_f32_16x16x64_bf16 v[52:55], v[248:251], v[104:111], v0
    buffer_load_dwordx4 v[248:251], v4, s[44:47], s93 offen offset:1024
    s_waitcnt vmcnt(4)
    v_smfmac_f32_16x16x64_bf16 v[56:59], v[16:19], v[24:31], v0
    ds_read_b128 v[24:27], v2 offset:16384
    v_smfmac_f32_16x16x64_bf16 v[40:43], v[16:19], a[160:167], v0
    ds_read_b128 v[28:31], v2 offset:17408
    v_smfmac_f32_16x16x64_bf16 v[44:47], v[16:19], a[168:175], v0
    s_waitcnt lgkmcnt(2)
    v_smfmac_f32_16x16x64_bf16 v[60:63], v[16:19], v[32:39], v0
    ds_read_b128 v[32:35], v2 offset:18432
    v_smfmac_f32_16x16x64_bf16 v[48:51], v[16:19], v[112:119], v0
    ds_read_b128 v[36:39], v2 offset:19456
    v_smfmac_f32_16x16x64_bf16 v[52:55], v[16:19], v[120:127], v0
    buffer_load_dwordx4 v[16:19], v4, s[44:47], s93 offen offset:2048
    s_waitcnt vmcnt(4) lgkmcnt(2)
    v_smfmac_f32_16x16x64_bf16 v[56:59], v[20:23], v[24:31], v0
    ds_read_b128 v[24:27], v2 offset:32768
    v_smfmac_f32_16x16x64_bf16 v[40:43], v[20:23], a[176:183], v0
    ds_read_b128 v[28:31], v2 offset:33792
    v_smfmac_f32_16x16x64_bf16 v[44:47], v[20:23], a[184:191], v0
    s_waitcnt lgkmcnt(2)
    v_smfmac_f32_16x16x64_bf16 v[60:63], v[20:23], v[32:39], v0
    ds_read_b128 v[32:35], v2 offset:34816
    v_smfmac_f32_16x16x64_bf16 v[48:51], v[20:23], v[128:135], v0
    ds_read_b128 v[36:39], v2 offset:35840
    v_smfmac_f32_16x16x64_bf16 v[52:55], v[20:23], v[136:143], v0
    buffer_load_dwordx4 v[20:23], v4, s[44:47], s93 offen offset:3072
    s_waitcnt vmcnt(4) lgkmcnt(2)
    v_smfmac_f32_16x16x64_bf16 v[56:59], v[12:15], v[24:31], v0
    ds_read_b128 v[24:27], v2 offset:49152
    v_smfmac_f32_16x16x64_bf16 v[40:43], v[12:15], a[192:199], v0
    ds_read_b128 v[28:31], v2 offset:50176
    v_smfmac_f32_16x16x64_bf16 v[44:47], v[12:15], a[200:207], v0
    s_waitcnt lgkmcnt(2)
    v_smfmac_f32_16x16x64_bf16 v[60:63], v[12:15], v[32:39], v0
    ds_read_b128 v[32:35], v2 offset:51200
    v_smfmac_f32_16x16x64_bf16 v[48:51], v[12:15], v[144:151], v0
    ds_read_b128 v[36:39], v2 offset:52224
    v_smfmac_f32_16x16x64_bf16 v[52:55], v[12:15], v[152:159], v0
    buffer_load_dwordx4 v[12:15], v4, s[44:47], s74 offen offset:0
    s_waitcnt vmcnt(4) lgkmcnt(2)
    v_smfmac_f32_16x16x64_bf16 v[56:59], v[252:255], v[24:31], v0
    ds_read_b128 v[24:27], v3 offset:0
    v_smfmac_f32_16x16x64_bf16 v[40:43], v[252:255], a[208:215], v0
    ds_read_b128 v[28:31], v3 offset:1024
    v_smfmac_f32_16x16x64_bf16 v[44:47], v[252:255], a[216:223], v0
    s_waitcnt lgkmcnt(2)
    v_smfmac_f32_16x16x64_bf16 v[60:63], v[252:255], v[32:39], v0
    ds_read_b128 v[32:35], v3 offset:2048
    v_smfmac_f32_16x16x64_bf16 v[48:51], v[252:255], v[160:167], v0
    ds_read_b128 v[36:39], v3 offset:3072
    v_smfmac_f32_16x16x64_bf16 v[52:55], v[252:255], v[168:175], v0
    buffer_load_dwordx4 v[252:255], v5, s[44:47], s92 offen sc1
    s_waitcnt vmcnt(4) lgkmcnt(2)
    v_smfmac_f32_16x16x64_bf16 v[56:59], v[248:251], v[24:31], v0
    ds_read_b128 v[24:27], v3 offset:16384
    v_smfmac_f32_16x16x64_bf16 v[40:43], v[248:251], a[224:231], v0
    ds_read_b128 v[28:31], v3 offset:17408
    v_smfmac_f32_16x16x64_bf16 v[44:47], v[248:251], a[232:239], v0
    s_waitcnt lgkmcnt(2)
    v_smfmac_f32_16x16x64_bf16 v[60:63], v[248:251], v[32:39], v0
    ds_read_b128 v[32:35], v3 offset:18432
    v_smfmac_f32_16x16x64_bf16 v[48:51], v[248:251], v[176:183], v0
    ds_read_b128 v[36:39], v3 offset:19456
    v_smfmac_f32_16x16x64_bf16 v[52:55], v[248:251], v[184:191], v0
    buffer_load_dwordx4 v[248:251], v5, s[44:47], s91 offen sc1
    s_waitcnt vmcnt(4) lgkmcnt(2)
    v_smfmac_f32_16x16x64_bf16 v[56:59], v[16:19], v[24:31], v0
    ds_read_b128 v[24:27], v3 offset:32768
    v_smfmac_f32_16x16x64_bf16 v[40:43], v[16:19], a[240:247], v0
    ds_read_b128 v[28:31], v3 offset:33792
    v_smfmac_f32_16x16x64_bf16 v[44:47], v[16:19], a[248:255], v0
    s_waitcnt lgkmcnt(2)
    v_smfmac_f32_16x16x64_bf16 v[60:63], v[16:19], v[32:39], v0
    ds_read_b128 v[32:35], v3 offset:34816
    v_smfmac_f32_16x16x64_bf16 v[48:51], v[16:19], v[192:199], v0
    ds_read_b128 v[36:39], v3 offset:35840
    v_smfmac_f32_16x16x64_bf16 v[52:55], v[16:19], v[200:207], v0
    buffer_load_dwordx4 v4, s[44:47], s75 offen offset:0 sc1 lds
    s_waitcnt vmcnt(4) lgkmcnt(2)
    v_smfmac_f32_16x16x64_bf16 v[56:59], v[20:23], v[24:31], v0
    ds_read_b128 v[24:27], v3 offset:49152
    v_smfmac_f32_16x16x64_bf16 v[40:43], v[20:23], v[64:71], v0
    ds_read_b128 v[28:31], v3 offset:50176
    v_smfmac_f32_16x16x64_bf16 v[44:47], v[20:23], v[72:79], v0
    s_waitcnt lgkmcnt(2)
    v_smfmac_f32_16x16x64_bf16 v[60:63], v[20:23], v[32:39], v0
    ds_read_b128 v[32:35], v3 offset:51200
    v_smfmac_f32_16x16x64_bf16 v[48:51], v[20:23], v[208:215], v0
    ds_read_b128 v[36:39], v3 offset:52224
    v_smfmac_f32_16x16x64_bf16 v[52:55], v[20:23], v[216:223], v0
    buffer_load_dwordx4 v4, s[44:47], s75 offen offset:1024 sc1 lds
    s_waitcnt vmcnt(4) lgkmcnt(2)
    v_smfmac_f32_16x16x64_bf16 v[48:51], v[12:15], v[224:231], v0
    v_mov_b32 v1, s70
    v_smfmac_f32_16x16x64_bf16 v[40:43], v[12:15], v[80:87], v0
    buffer_store_dword v1, off, s[44:47], s78 sc1
    v_smfmac_f32_16x16x64_bf16 v[56:59], v[12:15], v[24:31], v0
    ds_read_b128 v[24:27], v4 offset:9216
    ds_read_b128 v[28:31], v4 offset:10240
    v_smfmac_f32_16x16x64_bf16 v[52:55], v[12:15], v[232:239], v0
    s_waitcnt lgkmcnt(2)
    v_smfmac_f32_16x16x64_bf16 v[44:47], v[12:15], v[88:95], v0
CH_fast0_COMB:
    v_smfmac_f32_16x16x64_bf16 v[60:63], v[12:15], v[32:39], v0
    v_add_f32 v48, v48, v50
    v_add_f32 v49, v49, v51
    v_add_f32 v40, v40, v42
    v_add_f32 v41, v41, v43
    v_cvt_pk_bf16_f32 v20, v48, v49
    v_cvt_pk_bf16_f32 v21, v40, v41
    v_add_f32 v52, v52, v54
    v_add_f32 v53, v53, v55
    v_add_f32 v44, v44, v46
    v_add_f32 v45, v45, v47
    v_cvt_pk_bf16_f32 v22, v52, v53
    v_cvt_pk_bf16_f32 v23, v44, v45
    ds_write2_b64 v6, v[20:21], v[22:23] offset0:0 offset1:16
    ds_read_b128 v[32:35], v4 offset:11264
    ds_read_b128 v[36:39], v4 offset:12288
    v_cmp_u_f32 vcc, v48, v49
    v_pk_add_f32 v[56:57], v[56:57], v[58:59]
    v_pk_add_f32 v[60:61], v[60:61], v[62:63]
    v_mov_b32 v16, v20
    v_mov_b32 v17, v22
    v_cvt_pk_bf16_f32 v18, v56, v57
    v_cvt_pk_bf16_f32 v19, v60, v61
    s_cbranch_vccnz CH_fast0_REDO
CH_fast0_COMBOK:
    s_waitcnt lgkmcnt(2)
    s_barrier
    ds_read_b64_tr_b16 v[40:41], v7 offset:0
    ds_read_b64_tr_b16 v[42:43], v7 offset:64
    ds_read_b64_tr_b16 v[44:45], v7 offset:256
    ds_read_b64_tr_b16 v[46:47], v7 offset:320
    ds_read_b64_tr_b16 v[48:49], v7 offset:512
    ds_read_b64_tr_b16 v[50:51], v7 offset:576
    ds_read_b64_tr_b16 v[52:53], v7 offset:768
    ds_read_b64_tr_b16 v[54:55], v7 offset:832
    buffer_load_dword v11, v11, s[44:47], s88 offen sc1
    s_waitcnt lgkmcnt(6)
    v_mfma_f32_16x16x32_bf16 v[56:59], v[24:27], v[40:43], 0
    ds_read_b128 v[24:27], v4 offset:13312
    v_mfma_f32_16x16x32_bf16 v[60:63], v[28:31], v[40:43], 0
    ds_read_b128 v[28:31], v4 offset:14336
    v_mfma_f32_16x16x32_bf16 v[12:15], v[40:43], v[40:43], 0
    s_waitcnt lgkmcnt(6)
    v_mfma_f32_16x16x32_bf16 v[56:59], v[32:35], v[44:47], v[56:59]
    ds_read_b128 v[32:35], v4 offset:15360
    v_mfma_f32_16x16x32_bf16 v[60:63], v[36:39], v[44:47], v[60:63]
    ds_read_b128 v[36:39], v4 offset:16384
    v_mfma_f32_16x16x32_bf16 v[12:15], v[44:47], v[44:47], v[12:15]
    s_waitcnt lgkmcnt(2)
    v_mfma_f32_16x16x32_bf16 v[56:59], v[24:27], v[48:51], v[56:59]
    buffer_store_dwordx4 v[16:19], v5, s[44:47], s76 offen sc1
    v_mfma_f32_16x16x32_bf16 v[60:63], v[28:31], v[48:51], v[60:63]
    v_mfma_f32_16x16x32_bf16 v[12:15], v[48:51], v[48:51], v[12:15]
    s_waitcnt lgkmcnt(0)
    v_mfma_f32_16x16x32_bf16 v[56:59], v[32:35], v[52:55], v[56:59]
    v_mov_b32 v45, 0
    v_mfma_f32_16x16x32_bf16 v[60:63], v[36:39], v[52:55], v[60:63]
    v_mov_b32 v46, 0
    v_mfma_f32_16x16x32_bf16 v[12:15], v[52:55], v[52:55], v[12:15]
    v_mov_b32 v32, 0x3f803f80
    v_mov_b32 v33, 0x3f803f80
    v_mov_b32 v34, 0x3f803f80
    v_mov_b32 v35, 0x3f803f80
    v_max3_f32 v24, v56, v57, v58
    s_nop 0
    v_max3_f32 v26, v60, v61, v62
    v_max3_f32 v24, v24, v59, v63
    v_max3_f32 v26, v26, v12, v13
    v_max_f32 v24, v24, v26
    v_mov_b32 v26, v24
    v_mov_b64 v[48:49], 0
    v_mov_b64 v[50:51], 0
    v_permlane32_swap_b32 v24, v26
    v_max_f32 v24, v24, v26
    v_mov_b32 v26, v24
    v_mov_b64 v[52:53], 0
    v_mov_b64 v[54:55], 0
    v_permlane16_swap_b32 v24, v26
    v_max_f32 v24, v24, v26
    v_mul_f32 v24, s84, v24
    v_pk_fma_f32 v[56:57], v[56:57], s[84:85], v[24:25] op_sel_hi:[1,1,0] neg_lo:[0,0,1] neg_hi:[0,0,1]
    v_pk_fma_f32 v[58:59], v[58:59], s[84:85], v[24:25] op_sel_hi:[1,1,0] neg_lo:[0,0,1] neg_hi:[0,0,1]
    v_pk_fma_f32 v[60:61], v[60:61], s[84:85], v[24:25] op_sel_hi:[1,1,0] neg_lo:[0,0,1] neg_hi:[0,0,1]
    v_pk_fma_f32 v[62:63], v[62:63], s[84:85], v[24:25] op_sel_hi:[1,1,0] neg_lo:[0,0,1] neg_hi:[0,0,1]
    v_pk_fma_f32 v[12:13], v[12:13], s[84:85], v[24:25] op_sel_hi:[1,1,0] neg_lo:[0,0,1] neg_hi:[0,0,1]
    v_exp_f32 v56, v56
    v_exp_f32 v57, v57
    v_exp_f32 v58, v58
    v_exp_f32 v59, v59
    v_exp_f32 v60, v60
    v_exp_f32 v61, v61
    v_exp_f32 v62, v62
    v_exp_f32 v63, v63
    v_cvt_pk_bf16_f32 v40, v56, v57
    v_cvt_pk_bf16_f32 v41, v58, v59
    v_cvt_pk_bf16_f32 v42, v60, v61
    v_cvt_pk_bf16_f32 v43, v62, v63
    v_exp_f32 v12, v12
    s_waitcnt vmcnt(5)
    v_mfma_f32_16x16x32_bf16 v[20:23], v[32:35], v[40:43], 0
    v_exp_f32 v13, v13
    v_mfma_f32_16x16x32_bf16 v[56:59], v[252:255], v[40:43], 0
    v_cvt_pk_bf16_f32 v44, v12, v13
    v_mfma_f32_16x16x32_bf16 v[60:63], v[248:251], v[40:43], 0
    v_cvt_pk_bf16_f32 v47, v12, v13
    v_mov_b64 v[36:37], 0
    v_mfma_f32_16x16x16_bf16 v[20:23], v[32:33], v[44:45], v[20:23]
    v_mov_b64 v[38:39], 0
    v_mfma_f32_16x16x16_bf16 v[56:59], v[18:19], v[44:45], v[56:59]
    v_mov_b64 v[40:41], 0
    v_mfma_f32_16x16x16_bf16 v[60:63], v[18:19], v[46:47], v[60:63]
    v_mov_b64 v[28:29], 0
    v_mov_b64 v[30:31], 0
    v_mov_b64 v[32:33], 0
    v_mov_b64 v[34:35], 0
    v_rcp_f32 v24, v20
    v_mov_b64 v[42:43], 0
    v_pk_mul_f32 v[56:57], v[56:57], v[24:25] op_sel_hi:[1,0]
    v_pk_mul_f32 v[58:59], v[58:59], v[24:25] op_sel_hi:[1,0]
    v_pk_mul_f32 v[60:61], v[60:61], v[24:25] op_sel_hi:[1,0]
    v_pk_mul_f32 v[62:63], v[62:63], v[24:25] op_sel_hi:[1,0]
    v_cvt_pk_bf16_f32 v16, v56, v57
    v_cvt_pk_bf16_f32 v17, v58, v59
    v_cvt_pk_bf16_f32 v18, v60, v61
    v_cvt_pk_bf16_f32 v19, v62, v63
    s_mov_b64 exec, s[94:95]
    ds_write_b128 v8, v[16:19]
    s_mov_b64 exec, -1
    v_mov_b64 v[44:45], 0
    v_mov_b64 v[46:47], 0
    v_mov_b64 v[56:57], 0
    v_mov_b64 v[58:59], 0
    v_mov_b64 v[60:61], 0
    v_mov_b64 v[62:63], 0
    v_mov_b32 v15, s59
    v_bfe_u32 v14, v4, 2, 8
    v_bfe_u32 v13, v4, 4, 2
    v_lshrrev_b32 v13, v13, 1
    v_not_b32 v13, v13
    s_waitcnt lgkmcnt(0)
    s_barrier
    ds_read_b128 v[20:23], v4 offset:29952
    ds_read_b128 v[24:27], v4 offset:30976
    s_add_u32 s76, s76, 4096
    s_add_u32 s92, s92, 16384
    s_cmp_ge_u32 s72, 32
    s_waitcnt lgkmcnt(1)
    v_smfmac_f32_16x16x64_bf16 v[28:31], v[20:23], a[0:7], v0
    s_waitcnt lgkmcnt(0)
    v_smfmac_f32_16x16x64_bf16 v[28:31], v[24:27], a[8:15], v0
    v_smfmac_f32_16x16x64_bf16 v[32:35], v[20:23], a[16:23], v0
    v_smfmac_f32_16x16x64_bf16 v[32:35], v[24:27], a[24:31], v0
    v_smfmac_f32_16x16x64_bf16 v[36:39], v[20:23], a[32:39], v0
    s_nop 4
    v_add_f32 v28, v28, v30
    v_add_f32 v29, v29, v31
    v_smfmac_f32_16x16x64_bf16 v[36:39], v[24:27], a[40:47], v0
    v_cvt_pk_bf16_f32 v28, v28, v29
    v_smfmac_f32_16x16x64_bf16 v[40:43], v[20:23], a[48:55], v0
    v_and_b32 v28, v13, v28
    v_add_f32 v32, v32, v34
    v_add_f32 v33, v33, v35
    v_smfmac_f32_16x16x64_bf16 v[40:43], v[24:27], a[56:63], v0
    buffer_store_dword v28, v14, s[44:47], s79 offen offset:0
    v_cvt_pk_bf16_f32 v32, v32, v33
    v_smfmac_f32_16x16x64_bf16 v[44:47], v[20:23], a[64:71], v0
    v_and_b32 v32, v13, v32
    v_add_f32 v36, v36, v38
    v_add_f32 v37, v37, v39
    v_smfmac_f32_16x16x64_bf16 v[44:47], v[24:27], a[72:79], v0
    buffer_store_dword v32, v14, s[44:47], s79 offen offset:256
    v_cvt_pk_bf16_f32 v36, v36, v37
    v_smfmac_f32_16x16x64_bf16 v[48:51], v[20:23], a[80:87], v0
    v_and_b32 v36, v13, v36
    v_add_f32 v40, v40, v42
    v_add_f32 v41, v41, v43
    v_smfmac_f32_16x16x64_bf16 v[48:51], v[24:27], a[88:95], v0
    buffer_store_dword v36, v14, s[44:47], s79 offen offset:512
    v_cvt_pk_bf16_f32 v40, v40, v41
    v_smfmac_f32_16x16x64_bf16 v[52:55], v[20:23], a[96:103], v0
    v_and_b32 v40, v13, v40
    v_add_f32 v44, v44, v46
    v_add_f32 v45, v45, v47
    v_smfmac_f32_16x16x64_bf16 v[52:55], v[24:27], a[104:111], v0
    buffer_store_dword v40, v14, s[44:47], s79 offen offset:768
    v_cvt_pk_bf16_f32 v44, v44, v45
    v_smfmac_f32_16x16x64_bf16 v[56:59], v[20:23], a[112:119], v0
    v_and_b32 v44, v13, v44
    v_add_f32 v48, v48, v50
    v_add_f32 v49, v49, v51
    v_smfmac_f32_16x16x64_bf16 v[56:59], v[24:27], a[120:127], v0
    buffer_store_dword v44, v14, s[44:47], s79 offen offset:1024
    v_cvt_pk_bf16_f32 v48, v48, v49
    v_smfmac_f32_16x16x64_bf16 v[60:63], v[20:23], a[128:135], v0
    v_and_b32 v48, v13, v48
    v_add_f32 v52, v52, v54
    v_add_f32 v53, v53, v55
    v_smfmac_f32_16x16x64_bf16 v[60:63], v[24:27], a[136:143], v0
    buffer_store_dword v48, v14, s[44:47], s79 offen offset:1280
    v_cvt_pk_bf16_f32 v52, v52, v53
    v_and_b32 v52, v13, v52
    v_add_f32 v56, v56, v58
    v_add_f32 v57, v57, v59
    buffer_store_dword v52, v14, s[44:47], s79 offen offset:1536
    v_cvt_pk_bf16_f32 v56, v56, v57
    v_and_b32 v56, v13, v56
    v_add_f32 v60, v60, v62
    v_add_f32 v61, v61, v63
    buffer_store_dword v56, v14, s[44:47], s79 offen offset:1792
    v_cvt_pk_bf16_f32 v60, v60, v61
    v_and_b32 v60, v13, v60
    buffer_store_dword v60, v14, s[44:47], s79 offen offset:2048
    s_cbranch_scc0 CH_fast0_RLOAD
    s_cmp_ge_u32 s57, 2
    s_cbranch_scc1 CH_fast0_IDLE
    s_nop 3
    s_nop 3
    s_nop 3
    s_nop 3
    s_nop 3
    s_nop 3
    s_nop 3
    s_nop 3
    s_nop 3
    s_nop 3
    s_nop 3
    s_nop 3
CH_fast0_RLOAD:
    buffer_load_dwordx4 v[32:35], v9, s[44:47], s80 offen sc1
    buffer_load_dwordx4 v[36:39], v9, s[44:47], s81 offen sc1
    buffer_load_dwordx4 v[248:251], v9, s[44:47], s82 offen sc1
    buffer_load_dwordx4 v[252:255], v9, s[44:47], s83 offen sc1
    ds_read_b128 v[20:23], v4 offset:0
    v_mov_b64 v[40:41], 0
    v_mov_b64 v[42:43], 0
    v_mov_b64 v[44:45], 0
    v_mov_b64 v[46:47], 0
    v_mov_b64 v[48:49], 0
    v_mov_b64 v[50:51], 0
    v_mov_b64 v[52:53], 0
    v_mov_b64 v[54:55], 0
    v_mov_b64 v[56:57], 0
    v_mov_b64 v[58:59], 0
    v_mov_b64 v[60:61], 0
    v_mov_b64 v[62:63], 0
    s_waitcnt lgkmcnt(0)
CH_fast0_RSUM:
    s_waitcnt vmcnt(3)
    v_mfma_f32_16x16x32_bf16 v[24:27], v[32:35], v[20:23], 0
    s_waitcnt vmcnt(2)
    v_mfma_f32_16x16x32_bf16 v[24:27], v[36:39], v[20:23], v[24:27]
    v_or_b32 v28, v32, v36
    s_waitcnt vmcnt(1)
    v_mfma_f32_16x16x32_bf16 v[24:27], v[248:251], v[20:23], v[24:27]
    v_or_b32 v28, v28, v248
    s_waitcnt vmcnt(0)
    v_or_b32 v28, v28, v252
    v_and_b32 v28, 1, v28
    v_cmp_ne_u32 vcc, 0, v28
    v_mfma_f32_16x16x32_bf16 v[24:27], v[252:255], v[20:23], v[24:27]
CH_fast0_RCHK:
    s_cbranch_vccnz CH_fast0_RRETRY
    buffer_store_byte v15, off, s[44:47], s52
    s_add_u32 s70, s70, 1
    s_mov_b32 s53, s59
    s_add_u32 s59, s59, 0x01010101
    s_sub_u32 s71, s73, 131072
    s_add_u32 s93, s71, 4096
    s_add_u32 s74, s71, 8192
    s_mov_b32 s87, 0
    v_permlane32_swap_b32 v24, v26
    v_permlane32_swap_b32 v25, v27
    v_pk_add_f32 v[24:25], v[24:25], v[26:27]
    v_cvt_pk_bf16_f32 v28, v24, v25
    v_min_u32 v28, -2, v28
    buffer_store_dword v28, v10, s[44:47], s73 offen
    s_add_u32 s73, s73, 9216
CH_fast1_ENTER3:
CH_fast1_ENTER:
    s_barrier
    s_mov_b64 exec, -1
    buffer_load_dwordx4 v[248:251], v4, s[44:47], s71 offen offset:0
    ds_read_b128 v[24:27], v2 offset:0
    ds_read_b128 v[28:31], v2 offset:1024
    ds_read_b128 v[32:35], v5 offset:1024
    ds_read_b128 v[36:39], v5 offset:5120
    buffer_load_dwordx4 v[16:19], v4, s[44:47], s71 offen offset:1024
    s_add_u32 s91, s92, 4096
    s_add_u32 m0, s90, 0
    s_add_u32 s75, s75, 16384
    s_cmp_eq_u32 s70, 63
    s_cselect_b32 s75, 1073741824, s75
    s_add_u32 s88, s88, s86
    v_lshlrev_b32 v11, 2, v4
    v_and_b32 v11, s58, v11
    buffer_load_dwordx4 v[20:23], v4, s[44:47], s71 offen offset:2048
    s_waitcnt vmcnt(2)
    v_smfmac_f32_16x16x64_bf16 v[56:59], v[248:251], v[240:247], v0
    buffer_load_dwordx4 v[12:15], v4, s[44:47], s71 offen offset:3072
    v_smfmac_f32_16x16x64_bf16 v[40:43], v[248:251], a[144:151], v0
    v_smfmac_f32_16x16x64_bf16 v[44:47], v[248:251], a[152:159], v0
    s_waitcnt lgkmcnt(0)
    v_smfmac_f32_16x16x64_bf16 v[60:63], v[248:251], v[32:39], v0
    ds_read_b128 v[32:35], v2 offset:2048
    v_smfmac_f32_16x16x64_bf16 v[48:51], v[248:251], v[96:103], v0
    ds_read_b128 v[36:39], v2 offset:3072
    buffer_load_dwordx4 v[252:255], v4, s[44:47], s93 offen offset:0
    v_smfmac_f32_16x16x64_bf16 v[52:55], v[248:251], v[104:111], v0
    buffer_load_dwordx4 v[248:251], v4, s[44:47], s93 offen offset:1024
    s_waitcnt vmcnt(4)
    v_smfmac_f32_16x16x64_bf16 v[56:59], v[16:19], v[24:31], v0
    ds_read_b128 v[24:27], v2 offset:16384
    v_smfmac_f32_16x16x64_bf16 v[40:43], v[16:19], a[160:167], v0
    ds_read_b128 v[28:31], v2 offset:17408
    v_smfmac_f32_16x16x64_bf16 v[44:47], v[16:19], a[168:175], v0
    s_waitcnt lgkmcnt(2)
    v_smfmac_f32_16x16x64_bf16 v[60:63], v[16:19], v[32:39], v0
    ds_read_b128 v[32:35], v2 offset:18432
    v_smfmac_f32_16x16x64_bf16 v[48:51], v[16:19], v[112:119], v0
    ds_read_b128 v[36:39], v2 offset:19456
    v_smfmac_f32_16x16x64_bf16 v[52:55], v[16:19], v[120:127], v0
    buffer_load_dwordx4 v[16:19], v4, s[44:47], s93 offen offset:2048
    s_waitcnt vmcnt(4) lgkmcnt(2)
    v_smfmac_f32_16x16x64_bf16 v[56:59], v[20:23], v[24:31], v0
    ds_read_b128 v[24:27], v2 offset:32768
    v_smfmac_f32_16x16x64_bf16 v[40:43], v[20:23], a[176:183], v0
    ds_read_b128 v[28:31], v2 offset:33792
    v_smfmac_f32_16x16x64_bf16 v[44:47], v[20:23], a[184:191], v0
    s_waitcnt lgkmcnt(2)
    v_smfmac_f32_16x16x64_bf16 v[60:63], v[20:23], v[32:39], v0
    ds_read_b128 v[32:35], v2 offset:34816
    v_smfmac_f32_16x16x64_bf16 v[48:51], v[20:23], v[128:135], v0
    ds_read_b128 v[36:39], v2 offset:35840
    v_smfmac_f32_16x16x64_bf16 v[52:55], v[20:23], v[136:143], v0
    buffer_load_dwordx4 v[20:23], v4, s[44:47], s93 offen offset:3072
    s_waitcnt vmcnt(4) lgkmcnt(2)
    v_smfmac_f32_16x16x64_bf16 v[56:59], v[12:15], v[24:31], v0
    ds_read_b128 v[24:27], v2 offset:49152
    v_smfmac_f32_16x16x64_bf16 v[40:43], v[12:15], a[192:199], v0
    ds_read_b128 v[28:31], v2 offset:50176
    v_smfmac_f32_16x16x64_bf16 v[44:47], v[12:15], a[200:207], v0
    s_waitcnt lgkmcnt(2)
    v_smfmac_f32_16x16x64_bf16 v[60:63], v[12:15], v[32:39], v0
    ds_read_b128 v[32:35], v2 offset:51200
    v_smfmac_f32_16x16x64_bf16 v[48:51], v[12:15], v[144:151], v0
    ds_read_b128 v[36:39], v2 offset:52224
    v_smfmac_f32_16x16x64_bf16 v[52:55], v[12:15], v[152:159], v0
    buffer_load_dwordx4 v[12:15], v4, s[44:47], s74 offen offset:0
    s_waitcnt vmcnt(4) lgkmcnt(2)
    v_smfmac_f32_16x16x64_bf16 v[56:59], v[252:255], v[24:31], v0
    ds_read_b128 v[24:27], v3 offset:0
    v_smfmac_f32_16x16x64_bf16 v[40:43], v[252:255], a[208:215], v0
    ds_read_b128 v[28:31], v3 offset:1024
    v_smfmac_f32_16x16x64_bf16 v[44:47], v[252:255], a[216:223], v0
    s_waitcnt lgkmcnt(2)
    v_smfmac_f32_16x16x64_bf16 v[60:63], v[252:255], v[32:39], v0
    ds_read_b128 v[32:35], v3 offset:2048
    v_smfmac_f32_16x16x64_bf16 v[48:51], v[252:255], v[160:167], v0
    ds_read_b128 v[36:39], v3 offset:3072
    v_smfmac_f32_16x16x64_bf16 v[52:55], v[252:255], v[168:175], v0
    buffer_load_dwordx4 v[252:255], v5, s[44:47], s92 offen sc1
    s_waitcnt vmcnt(4) lgkmcnt(2)
    v_smfmac_f32_16x16x64_bf16 v[56:59], v[248:251], v[24:31], v0
    ds_read_b128 v[24:27], v3 offset:16384
    v_smfmac_f32_16x16x64_bf16 v[40:43], v[248:251], a[224:231], v0
    ds_read_b128 v[28:31], v3 offset:17408
    v_smfmac_f32_16x16x64_bf16 v[44:47], v[248:251], a[232:239], v0
    s_waitcnt lgkmcnt(2)
    v_smfmac_f32_16x16x64_bf16 v[60:63], v[248:251], v[32:39], v0
    ds_read_b128 v[32:35], v3 offset:18432
    v_smfmac_f32_16x16x64_bf16 v[48:51], v[248:251], v[176:183], v0
    ds_read_b128 v[36:39], v3 offset:19456
    v_smfmac_f32_16x16x64_bf16 v[52:55], v[248:251], v[184:191], v0
    buffer_load_dwordx4 v[248:251], v5, s[44:47], s91 offen sc1
    s_waitcnt vmcnt(4) lgkmcnt(2)
    v_smfmac_f32_16x16x64_bf16 v[56:59], v[16:19], v[24:31], v0
    ds_read_b128 v[24:27], v3 offset:32768
    v_smfmac_f32_16x16x64_bf16 v[40:43], v[16:19], a[240:247], v0
    ds_read_b128 v[28:31], v3 offset:33792
    v_smfmac_f32_16x16x64_bf16 v[44:47], v[16:19], a[248:255], v0
    s_waitcnt lgkmcnt(2)
    v_smfmac_f32_16x16x64_bf16 v[60:63], v[16:19], v[32:39], v0
    ds_read_b128 v[32:35], v3 offset:34816
    v_smfmac_f32_16x16x64_bf16 v[48:51], v[16:19], v[192:199], v0
    ds_read_b128 v[36:39], v3 offset:35840
    v_smfmac_f32_16x16x64_bf16 v[52:55], v[16:19], v[200:207], v0
    buffer_load_dwordx4 v4, s[44:47], s75 offen offset:0 sc1 lds
    s_waitcnt vmcnt(4) lgkmcnt(2)
    v_smfmac_f32_16x16x64_bf16 v[56:59], v[20:23], v[24:31], v0
    ds_read_b128 v[24:27], v3 offset:49152
    v_smfmac_f32_16x16x64_bf16 v[40:43], v[20:23], v[64:71], v0
    ds_read_b128 v[28:31], v3 offset:50176
    v_smfmac_f32_16x16x64_bf16 v[44:47], v[20:23], v[72:79], v0
    s_waitcnt lgkmcnt(2)
    v_smfmac_f32_16x16x64_bf16 v[60:63], v[20:23], v[32:39], v0
    ds_read_b128 v[32:35], v3 offset:51200
    v_smfmac_f32_16x16x64_bf16 v[48:51], v[20:23], v[208:215], v0
    ds_read_b128 v[36:39], v3 offset:52224
    v_smfmac_f32_16x16x64_bf16 v[52:55], v[20:23], v[216:223], v0
    buffer_load_dwordx4 v4, s[44:47], s75 offen offset:1024 sc1 lds
    s_waitcnt vmcnt(4) lgkmcnt(2)
    v_smfmac_f32_16x16x64_bf16 v[48:51], v[12:15], v[224:231], v0
    v_mov_b32 v1, s70
    v_smfmac_f32_16x16x64_bf16 v[40:43], v[12:15], v[80:87], v0
    buffer_store_dword v1, off, s[44:47], s78 sc1
    v_smfmac_f32_16x16x64_bf16 v[56:59], v[12:15], v[24:31], v0
    ds_read_b128 v[24:27], v4 offset:17408
    ds_read_b128 v[28:31], v4 offset:18432
    v_smfmac_f32_16x16x64_bf16 v[52:55], v[12:15], v[232:239], v0
    s_waitcnt lgkmcnt(2)
    v_smfmac_f32_16x16x64_bf16 v[44:47], v[12:15], v[88:95], v0
CH_fast1_COMB:
    v_smfmac_f32_16x16x64_bf16 v[60:63], v[12:15], v[32:39], v0
    v_add_f32 v48, v48, v50
    v_add_f32 v49, v49, v51
    v_add_f32 v40, v40, v42
    v_add_f32 v41, v41, v43
    v_cvt_pk_bf16_f32 v20, v48, v49
    v_cvt_pk_bf16_f32 v21, v40, v41
    v_add_f32 v52, v52, v54
    v_add_f32 v53, v53, v55
    v_add_f32 v44, v44, v46
    v_add_f32 v45, v45, v47
    v_cvt_pk_bf16_f32 v22, v52, v53
    v_cvt_pk_bf16_f32 v23, v44, v45
    ds_write2_b64 v6, v[20:21], v[22:23] offset0:0 offset1:16
    ds_read_b128 v[32:35], v4 offset:19456
    ds_read_b128 v[36:39], v4 offset:20480
    v_cmp_u_f32 vcc, v48, v49
    v_pk_add_f32 v[56:57], v[56:57], v[58:59]
    v_pk_add_f32 v[60:61], v[60:61], v[62:63]
    v_mov_b32 v16, v20
    v_mov_b32 v17, v22
    v_cvt_pk_bf16_f32 v18, v56, v57
    v_cvt_pk_bf16_f32 v19, v60, v61
    s_cbranch_vccnz CH_fast1_REDO
CH_fast1_COMBOK:
    s_cmp_eq_u32 s70, 63
    s_cbranch_scc1 CH_fast_LAST
    s_waitcnt lgkmcnt(2)
    s_barrier
    ds_read_b64_tr_b16 v[40:41], v7 offset:0
    ds_read_b64_tr_b16 v[42:43], v7 offset:64
    ds_read_b64_tr_b16 v[44:45], v7 offset:256
    ds_read_b64_tr_b16 v[46:47], v7 offset:320
    ds_read_b64_tr_b16 v[48:49], v7 offset:512
    ds_read_b64_tr_b16 v[50:51], v7 offset:576
    ds_read_b64_tr_b16 v[52:53], v7 offset:768
    ds_read_b64_tr_b16 v[54:55], v7 offset:832
    buffer_load_dword v11, v11, s[44:47], s88 offen sc1
    s_waitcnt lgkmcnt(6)
    v_mfma_f32_16x16x32_bf16 v[56:59], v[24:27], v[40:43], 0
    ds_read_b128 v[24:27], v4 offset:21504
    v_mfma_f32_16x16x32_bf16 v[60:63], v[28:31], v[40:43], 0
    ds_read_b128 v[28:31], v4 offset:22528
    v_mfma_f32_16x16x32_bf16 v[12:15], v[40:43], v[40:43], 0
    s_waitcnt lgkmcnt(6)
    v_mfma_f32_16x16x32_bf16 v[56:59], v[32:35], v[44:47], v[56:59]
    ds_read_b128 v[32:35], v4 offset:23552
    v_mfma_f32_16x16x32_bf16 v[60:63], v[36:39], v[44:47], v[60:63]
    ds_read_b128 v[36:39], v4 offset:24576
    v_mfma_f32_16x16x32_bf16 v[12:15], v[44:47], v[44:47], v[12:15]
    s_waitcnt lgkmcnt(2)
    v_mfma_f32_16x16x32_bf16 v[56:59], v[24:27], v[48:51], v[56:59]
    buffer_store_dwordx4 v[16:19], v5, s[44:47], s76 offen sc1
    v_mfma_f32_16x16x32_bf16 v[60:63], v[28:31], v[48:51], v[60:63]
    v_mfma_f32_16x16x32_bf16 v[12:15], v[48:51], v[48:51], v[12:15]
    s_waitcnt lgkmcnt(0)
    v_mfma_f32_16x16x32_bf16 v[56:59], v[32:35], v[52:55], v[56:59]
    v_mov_b32 v45, 0
    v_mfma_f32_16x16x32_bf16 v[60:63], v[36:39], v[52:55], v[60:63]
    v_mov_b32 v46, 0
    v_mfma_f32_16x16x32_bf16 v[12:15], v[52:55], v[52:55], v[12:15]
    v_mov_b32 v32, 0x3f803f80
    v_mov_b32 v33, 0x3f803f80
    v_mov_b32 v34, 0x3f803f80
    v_mov_b32 v35, 0x3f803f80
    v_max3_f32 v24, v56, v57, v58
    s_nop 0
    v_max3_f32 v26, v60, v61, v62
    v_max3_f32 v24, v24, v59, v63
    v_max3_f32 v26, v26, v12, v13
    v_max_f32 v24, v24, v26
    v_mov_b32 v26, v24
    v_mov_b64 v[48:49], 0
    v_mov_b64 v[50:51], 0
    v_permlane32_swap_b32 v24, v26
    v_max_f32 v24, v24, v26
    v_mov_b32 v26, v24
    v_mov_b64 v[52:53], 0
    v_mov_b64 v[54:55], 0
    v_permlane16_swap_b32 v24, v26
    v_max_f32 v24, v24, v26
    v_mul_f32 v24, s84, v24
    v_pk_fma_f32 v[56:57], v[56:57], s[84:85], v[24:25] op_sel_hi:[1,1,0] neg_lo:[0,0,1] neg_hi:[0,0,1]
    v_pk_fma_f32 v[58:59], v[58:59], s[84:85], v[24:25] op_sel_hi:[1,1,0] neg_lo:[0,0,1] neg_hi:[0,0,1]
    v_pk_fma_f32 v[60:61], v[60:61], s[84:85], v[24:25] op_sel_hi:[1,1,0] neg_lo:[0,0,1] neg_hi:[0,0,1]
    v_pk_fma_f32 v[62:63], v[62:63], s[84:85], v[24:25] op_sel_hi:[1,1,0] neg_lo:[0,0,1] neg_hi:[0,0,1]
    v_pk_fma_f32 v[12:13], v[12:13], s[84:85], v[24:25] op_sel_hi:[1,1,0] neg_lo:[0,0,1] neg_hi:[0,0,1]
    v_exp_f32 v56, v56
    v_exp_f32 v57, v57
    v_exp_f32 v58, v58
    v_exp_f32 v59, v59
    v_exp_f32 v60, v60
    v_exp_f32 v61, v61
    v_exp_f32 v62, v62
    v_exp_f32 v63, v63
    v_cvt_pk_bf16_f32 v40, v56, v57
    v_cvt_pk_bf16_f32 v41, v58, v59
    v_cvt_pk_bf16_f32 v42, v60, v61
    v_cvt_pk_bf16_f32 v43, v62, v63
    v_exp_f32 v12, v12
    s_waitcnt vmcnt(5)
    v_mfma_f32_16x16x32_bf16 v[20:23], v[32:35], v[40:43], 0
    v_exp_f32 v13, v13
    v_mfma_f32_16x16x32_bf16 v[56:59], v[252:255], v[40:43], 0
    v_cvt_pk_bf16_f32 v44, v12, v13
    v_mfma_f32_16x16x32_bf16 v[60:63], v[248:251], v[40:43], 0
    v_cvt_pk_bf16_f32 v47, v12, v13
    v_mov_b64 v[36:37], 0
    v_mfma_f32_16x16x16_bf16 v[20:23], v[32:33], v[44:45], v[20:23]
    v_mov_b64 v[38:39], 0
    v_mfma_f32_16x16x16_bf16 v[56:59], v[18:19], v[44:45], v[56:59]
    v_mov_b64 v[40:41], 0
    v_mfma_f32_16x16x16_bf16 v[60:63], v[18:19], v[46:47], v[60:63]
    v_mov_b64 v[28:29], 0
    v_mov_b64 v[30:31], 0
    v_mov_b64 v[32:33], 0
    v_mov_b64 v[34:35], 0
    v_rcp_f32 v24, v20
    v_mov_b64 v[42:43], 0
    v_pk_mul_f32 v[56:57], v[56:57], v[24:25] op_sel_hi:[1,0]
    v_pk_mul_f32 v[58:59], v[58:59], v[24:25] op_sel_hi:[1,0]
    v_pk_mul_f32 v[60:61], v[60:61], v[24:25] op_sel_hi:[1,0]
    v_pk_mul_f32 v[62:63], v[62:63], v[24:25] op_sel_hi:[1,0]
    v_cvt_pk_bf16_f32 v16, v56, v57
    v_cvt_pk_bf16_f32 v17, v58, v59
    v_cvt_pk_bf16_f32 v18, v60, v61
    v_cvt_pk_bf16_f32 v19, v62, v63
    s_mov_b64 exec, s[94:95]
    ds_write_b128 v8, v[16:19]
    s_mov_b64 exec, -1
    v_mov_b64 v[44:45], 0
    v_mov_b64 v[46:47], 0
    v_mov_b64 v[56:57], 0
    v_mov_b64 v[58:59], 0
    v_mov_b64 v[60:61], 0
    v_mov_b64 v[62:63], 0
    v_mov_b32 v15, s59
    v_bfe_u32 v14, v4, 2, 8
    v_bfe_u32 v13, v4, 4, 2
    v_lshrrev_b32 v13, v13, 1
    s_waitcnt lgkmcnt(0)
    s_barrier
    ds_read_b128 v[20:23], v4 offset:29952
    ds_read_b128 v[24:27], v4 offset:30976
    s_add_u32 s76, s76, 4096
    s_add_u32 s92, s92, 16384
    s_cmp_ge_u32 s72, 32
    s_waitcnt lgkmcnt(1)
    v_smfmac_f32_16x16x64_bf16 v[28:31], v[20:23], a[0:7], v0
    s_waitcnt lgkmcnt(0)
    v_smfmac_f32_16x16x64_bf16 v[28:31], v[24:27], a[8:15], v0
    v_smfmac_f32_16x16x64_bf16 v[32:35], v[20:23], a[16:23], v0
    v_smfmac_f32_16x16x64_bf16 v[32:35], v[24:27], a[24:31], v0
    v_smfmac_f32_16x16x64_bf16 v[36:39], v[20:23], a[32:39], v0
    s_nop 4
    v_add_f32 v28, v28, v30
    v_add_f32 v29, v29, v31
    v_smfmac_f32_16x16x64_bf16 v[36:39], v[24:27], a[40:47], v0
    v_cvt_pk_bf16_f32 v28, v28, v29
    v_smfmac_f32_16x16x64_bf16 v[40:43], v[20:23], a[48:55], v0
    v_or_b32 v28, v13, v28
    v_add_f32 v32, v32, v34
    v_add_f32 v33, v33, v35
    v_smfmac_f32_16x16x64_bf16 v[40:43], v[24:27], a[56:63], v0
    buffer_store_dword v28, v14, s[44:47], s79 offen offset:0
    v_cvt_pk_bf16_f32 v32, v32, v33
    v_smfmac_f32_16x16x64_bf16 v[44:47], v[20:23], a[64:71], v0
    v_or_b32 v32, v13, v32
    v_add_f32 v36, v36, v38
    v_add_f32 v37, v37, v39
    v_smfmac_f32_16x16x64_bf16 v[44:47], v[24:27], a[72:79], v0
    buffer_store_dword v32, v14, s[44:47], s79 offen offset:256
    v_cvt_pk_bf16_f32 v36, v36, v37
    v_smfmac_f32_16x16x64_bf16 v[48:51], v[20:23], a[80:87], v0
    v_or_b32 v36, v13, v36
    v_add_f32 v40, v40, v42
    v_add_f32 v41, v41, v43
    v_smfmac_f32_16x16x64_bf16 v[48:51], v[24:27], a[88:95], v0
    buffer_store_dword v36, v14, s[44:47], s79 offen offset:512
    v_cvt_pk_bf16_f32 v40, v40, v41
    v_smfmac_f32_16x16x64_bf16 v[52:55], v[20:23], a[96:103], v0
    v_or_b32 v40, v13, v40
    v_add_f32 v44, v44, v46
    v_add_f32 v45, v45, v47
    v_smfmac_f32_16x16x64_bf16 v[52:55], v[24:27], a[104:111], v0
    buffer_store_dword v40, v14, s[44:47], s79 offen offset:768
    v_cvt_pk_bf16_f32 v44, v44, v45
    v_smfmac_f32_16x16x64_bf16 v[56:59], v[20:23], a[112:119], v0
    v_or_b32 v44, v13, v44
    v_add_f32 v48, v48, v50
    v_add_f32 v49, v49, v51
    v_smfmac_f32_16x16x64_bf16 v[56:59], v[24:27], a[120:127], v0
    buffer_store_dword v44, v14, s[44:47], s79 offen offset:1024
    v_cvt_pk_bf16_f32 v48, v48, v49
    v_smfmac_f32_16x16x64_bf16 v[60:63], v[20:23], a[128:135], v0
    v_or_b32 v48, v13, v48
    v_add_f32 v52, v52, v54
    v_add_f32 v53, v53, v55
    v_smfmac_f32_16x16x64_bf16 v[60:63], v[24:27], a[136:143], v0
    buffer_store_dword v48, v14, s[44:47], s79 offen offset:1280
    v_cvt_pk_bf16_f32 v52, v52, v53
    v_or_b32 v52, v13, v52
    v_add_f32 v56, v56, v58
    v_add_f32 v57, v57, v59
    buffer_store_dword v52, v14, s[44:47], s79 offen offset:1536
    v_cvt_pk_bf16_f32 v56, v56, v57
    v_or_b32 v56, v13, v56
    v_add_f32 v60, v60, v62
    v_add_f32 v61, v61, v63
    buffer_store_dword v56, v14, s[44:47], s79 offen offset:1792
    v_cvt_pk_bf16_f32 v60, v60, v61
    v_or_b32 v60, v13, v60
    buffer_store_dword v60, v14, s[44:47], s79 offen offset:2048
    s_cbranch_scc0 CH_fast1_RLOAD
    s_cmp_ge_u32 s57, 2
    s_cbranch_scc1 CH_fast1_IDLE
    s_nop 3
    s_nop 3
    s_nop 3
    s_nop 3
    s_nop 3
    s_nop 3
    s_nop 3
    s_nop 3
    s_nop 3
    s_nop 3
    s_nop 3
    s_nop 3
CH_fast1_RLOAD:
    buffer_load_dwordx4 v[32:35], v9, s[44:47], s80 offen sc1
    buffer_load_dwordx4 v[36:39], v9, s[44:47], s81 offen sc1
    buffer_load_dwordx4 v[248:251], v9, s[44:47], s82 offen sc1
    buffer_load_dwordx4 v[252:255], v9, s[44:47], s83 offen sc1
    ds_read_b128 v[20:23], v4 offset:0
    v_mov_b64 v[40:41], 0
    v_mov_b64 v[42:43], 0
    v_mov_b64 v[44:45], 0
    v_mov_b64 v[46:47], 0
    v_mov_b64 v[48:49], 0
    v_mov_b64 v[50:51], 0
    v_mov_b64 v[52:53], 0
    v_mov_b64 v[54:55], 0
    v_mov_b64 v[56:57], 0
    v_mov_b64 v[58:59], 0
    v_mov_b64 v[60:61], 0
    v_mov_b64 v[62:63], 0
    s_waitcnt lgkmcnt(0)
CH_fast1_RSUM:
    s_waitcnt vmcnt(3)
    v_mfma_f32_16x16x32_bf16 v[24:27], v[32:35], v[20:23], 0
    s_waitcnt vmcnt(2)
    v_mfma_f32_16x16x32_bf16 v[24:27], v[36:39], v[20:23], v[24:27]
    v_and_b32 v28, v32, v36
    s_waitcnt vmcnt(1)
    v_mfma_f32_16x16x32_bf16 v[24:27], v[248:251], v[20:23], v[24:27]
    v_and_b32 v28, v28, v248
    s_waitcnt vmcnt(0)
    v_and_b32 v28, v28, v252
    v_and_b32 v28, 1, v28
    v_cmp_ne_u32 vcc, 1, v28
    v_mfma_f32_16x16x32_bf16 v[24:27], v[252:255], v[20:23], v[24:27]
CH_fast1_RCHK:
    s_cbranch_vccnz CH_fast1_RRETRY
    buffer_store_byte v15, off, s[44:47], s52
    s_add_u32 s70, s70, 1
    s_mov_b32 s53, s59
    s_add_u32 s59, s59, 0x01010101
    s_sub_u32 s71, s73, 131072
    s_add_u32 s93, s71, 4096
    s_add_u32 s74, s71, 8192
    s_mov_b32 s87, 0
    v_permlane32_swap_b32 v24, v26
    v_permlane32_swap_b32 v25, v27
    v_pk_add_f32 v[24:25], v[24:25], v[26:27]
    v_cvt_pk_bf16_f32 v28, v24, v25
    v_min_u32 v28, -2, v28
    buffer_store_dword v28, v10, s[44:47], s73 offen
    s_add_u32 s73, s73, 9216
    s_branch CH_fast0_ENTER
CH_fast0_IDLE:
    v_mov_b64 v[40:41], 0
    v_mov_b64 v[42:43], 0
    v_mov_b64 v[44:45], 0
    v_mov_b64 v[46:47], 0
    v_mov_b64 v[48:49], 0
    v_mov_b64 v[50:51], 0
    v_mov_b64 v[52:53], 0
    v_mov_b64 v[54:55], 0
    v_mov_b64 v[56:57], 0
    v_mov_b64 v[58:59], 0
    v_mov_b64 v[60:61], 0
    v_mov_b64 v[62:63], 0
    s_add_u32 s70, s70, 1
    s_mov_b32 s53, s59
    s_add_u32 s59, s59, 0x01010101
    s_sub_u32 s71, s73, 131072
    s_add_u32 s93, s71, 4096
    s_add_u32 s74, s71, 8192
    s_add_u32 s73, s73, 9216
    s_mov_b32 s87, 0
    s_cmp_eq_u32 s57, 2
    s_cbranch_scc0 CH_fast0_KVCHK
    s_waitcnt vmcnt(0)
    s_branch CH_fast1_ENTER
CH_fast0_KVCHK:
    s_waitcnt vmcnt(9)
CH_fast0_KVCHK2:
    v_readfirstlane_b32 s99, v11
    s_min_u32 s98, s70, 62
    s_add_u32 s98, s98, 2
    s_cmp_ge_u32 s99, s98
    s_cbranch_scc1 CH_fast0_PUB0
    buffer_load_dword v11, off, s[44:47], s77 sc1
    s_add_u32 s100, s100, 1
    s_cmp_lt_u32 s100, 262144
    s_cbranch_scc1 spin_ok_21
    s_mov_b32 s98, 6
    s_branch FAIL
spin_ok_21:
    s_waitcnt vmcnt(0)
    s_branch CH_fast0_KVCHK2
CH_fast0_PUB0:
    s_mov_b64 exec, 255
    s_nop 15
    s_nop 15
    s_nop 15
    s_nop 15
    s_nop 15
CH_fast0_PUB0L:
    buffer_load_dword v1, v14, s[64:67], 0 offen sc1
    s_nop 1
    s_nop 1
    v_cmp_ne_u32 vcc, s53, v1
    s_cbranch_vccz CH_fast1_ENTER3
    buffer_load_dword v1, v14, s[64:67], 0 offen sc1
    s_nop 1
    s_nop 1
    v_cmp_ne_u32 vcc, s53, v1
    s_cbranch_vccz CH_fast1_ENTER3
    buffer_load_dword v1, v14, s[64:67], 0 offen sc1
    s_nop 1
    s_nop 1
    v_cmp_ne_u32 vcc, s53, v1
    s_cbranch_vccz CH_fast1_ENTER3
    s_add_u32 s100, s100, 1
    s_cmp_lt_u32 s100, 262144
    s_cbranch_scc1 CH_fast0_PUB0L
    s_branch CH_fast0_HFAIL
CH_fast0_HFAIL:
    s_mov_b32 s98, 5
    s_branch FAIL
CH_fast0_RRETRY:
    buffer_load_dwordx4 v[32:35], v9, s[44:47], s80 offen sc1
    buffer_load_dwordx4 v[36:39], v9, s[44:47], s81 offen sc1
    buffer_load_dwordx4 v[248:251], v9, s[44:47], s82 offen sc1
    buffer_load_dwordx4 v[252:255], v9, s[44:47], s83 offen sc1
    s_add_u32 s100, s100, 1
    s_cmp_lt_u32 s100, 262144
    s_cbranch_scc1 spin_ok_22
    s_mov_b32 s98, 4
    s_branch FAIL
spin_ok_22:
    s_branch CH_fast0_RSUM
CH_fast0_REDO:
    s_cmp_eq_u32 s87, 1
    s_cbranch_scc1 CH_fast0_COMBOK
    s_mov_b32 s87, 1
    s_nop 7
    s_waitcnt lgkmcnt(0)
CH_fast0_REDOP:
    v_mov_b32 v40, 0
    buffer_load_dwordx4 v[248:251], v4, s[44:47], s71 offen offset:0 sc1
    buffer_load_dwordx4 v[16:19], v4, s[44:47], s71 offen offset:1024 sc1
    buffer_load_dwordx4 v[20:23], v4, s[44:47], s71 offen offset:2048 sc1
    buffer_load_dwordx4 v[12:15], v4, s[44:47], s71 offen offset:3072 sc1
    buffer_load_dwordx4 v[252:255], v4, s[44:47], s93 offen offset:0 sc1
    s_waitcnt vmcnt(0)
    v_max3_u32 v40, v40, v248, v249
    v_max3_u32 v40, v40, v250, v251
    v_max3_u32 v40, v40, v16, v17
    v_max3_u32 v40, v40, v18, v19
    v_max3_u32 v40, v40, v20, v21
    v_max3_u32 v40, v40, v22, v23
    v_max3_u32 v40, v40, v12, v13
    v_max3_u32 v40, v40, v14, v15
    v_max3_u32 v40, v40, v252, v253
    v_max3_u32 v40, v40, v254, v255
    buffer_load_dwordx4 v[248:251], v4, s[44:47], s93 offen offset:1024 sc1
    buffer_load_dwordx4 v[16:19], v4, s[44:47], s93 offen offset:2048 sc1
    buffer_load_dwordx4 v[20:23], v4, s[44:47], s93 offen offset:3072 sc1
    buffer_load_dwordx4 v[12:15], v4, s[44:47], s74 offen offset:0 sc1
    s_waitcnt vmcnt(0)
    v_max3_u32 v40, v40, v248, v249
    v_max3_u32 v40, v40, v250, v251
    v_max3_u32 v40, v40, v16, v17
    v_max3_u32 v40, v40, v18, v19
    v_max3_u32 v40, v40, v20, v21
    v_max3_u32 v40, v40, v22, v23
    v_max3_u32 v40, v40, v12, v13
    v_max3_u32 v40, v40, v14, v15
    s_add_u32 s100, s100, 1
    s_cmp_lt_u32 s100, 262144
    s_cbranch_scc1 spin_ok_23
    s_mov_b32 s98, 3
    s_branch FAIL
spin_ok_23:
    v_cmp_eq_u32 vcc, -1, v40
    s_cbranch_vccnz CH_fast0_REDOP
    v_mov_b64 v[40:41], 0
    v_mov_b64 v[42:43], 0
    v_mov_b64 v[44:45], 0
    v_mov_b64 v[46:47], 0
    v_mov_b64 v[48:49], 0
    v_mov_b64 v[50:51], 0
    v_mov_b64 v[52:53], 0
    v_mov_b64 v[54:55], 0
    v_mov_b64 v[56:57], 0
    v_mov_b64 v[58:59], 0
    v_mov_b64 v[60:61], 0
    v_mov_b64 v[62:63], 0
    buffer_load_dwordx4 v[248:251], v4, s[44:47], s71 offen offset:0 sc1
    ds_read_b128 v[24:27], v2 offset:0
    ds_read_b128 v[28:31], v2 offset:1024
    ds_read_b128 v[32:35], v5 offset:1024
    ds_read_b128 v[36:39], v5 offset:5120
    buffer_load_dwordx4 v[16:19], v4, s[44:47], s71 offen offset:1024 sc1
    s_add_u32 s91, s92, 4096
    buffer_load_dwordx4 v[20:23], v4, s[44:47], s71 offen offset:2048 sc1
    s_waitcnt vmcnt(2)
    v_smfmac_f32_16x16x64_bf16 v[56:59], v[248:251], v[240:247], v0
    buffer_load_dwordx4 v[12:15], v4, s[44:47], s71 offen offset:3072 sc1
    v_smfmac_f32_16x16x64_bf16 v[40:43], v[248:251], a[144:151], v0
    v_smfmac_f32_16x16x64_bf16 v[44:47], v[248:251], a[152:159], v0
    s_waitcnt lgkmcnt(0)
    v_smfmac_f32_16x16x64_bf16 v[60:63], v[248:251], v[32:39], v0
    ds_read_b128 v[32:35], v2 offset:2048
    v_smfmac_f32_16x16x64_bf16 v[48:51], v[248:251], v[96:103], v0
    ds_read_b128 v[36:39], v2 offset:3072
    buffer_load_dwordx4 v[252:255], v4, s[44:47], s93 offen offset:0 sc1
    v_smfmac_f32_16x16x64_bf16 v[52:55], v[248:251], v[104:111], v0
    buffer_load_dwordx4 v[248:251], v4, s[44:47], s93 offen offset:1024 sc1
    s_waitcnt vmcnt(4)
    v_smfmac_f32_16x16x64_bf16 v[56:59], v[16:19], v[24:31], v0
    ds_read_b128 v[24:27], v2 offset:16384
    v_smfmac_f32_16x16x64_bf16 v[40:43], v[16:19], a[160:167], v0
    ds_read_b128 v[28:31], v2 offset:17408
    v_smfmac_f32_16x16x64_bf16 v[44:47], v[16:19], a[168:175], v0
    s_waitcnt lgkmcnt(2)
    v_smfmac_f32_16x16x64_bf16 v[60:63], v[16:19], v[32:39], v0
    ds_read_b128 v[32:35], v2 offset:18432
    v_smfmac_f32_16x16x64_bf16 v[48:51], v[16:19], v[112:119], v0
    ds_read_b128 v[36:39], v2 offset:19456
    v_smfmac_f32_16x16x64_bf16 v[52:55], v[16:19], v[120:127], v0
    buffer_load_dwordx4 v[16:19], v4, s[44:47], s93 offen offset:2048 sc1
    s_waitcnt vmcnt(4) lgkmcnt(2)
    v_smfmac_f32_16x16x64_bf16 v[56:59], v[20:23], v[24:31], v0
    ds_read_b128 v[24:27], v2 offset:32768
    v_smfmac_f32_16x16x64_bf16 v[40:43], v[20:23], a[176:183], v0
    ds_read_b128 v[28:31], v2 offset:33792
    v_smfmac_f32_16x16x64_bf16 v[44:47], v[20:23], a[184:191], v0
    s_waitcnt lgkmcnt(2)
    v_smfmac_f32_16x16x64_bf16 v[60:63], v[20:23], v[32:39], v0
    ds_read_b128 v[32:35], v2 offset:34816
    v_smfmac_f32_16x16x64_bf16 v[48:51], v[20:23], v[128:135], v0
    ds_read_b128 v[36:39], v2 offset:35840
    v_smfmac_f32_16x16x64_bf16 v[52:55], v[20:23], v[136:143], v0
    buffer_load_dwordx4 v[20:23], v4, s[44:47], s93 offen offset:3072 sc1
    s_waitcnt vmcnt(4) lgkmcnt(2)
    v_smfmac_f32_16x16x64_bf16 v[56:59], v[12:15], v[24:31], v0
    ds_read_b128 v[24:27], v2 offset:49152
    v_smfmac_f32_16x16x64_bf16 v[40:43], v[12:15], a[192:199], v0
    ds_read_b128 v[28:31], v2 offset:50176
    v_smfmac_f32_16x16x64_bf16 v[44:47], v[12:15], a[200:207], v0
    s_waitcnt lgkmcnt(2)
    v_smfmac_f32_16x16x64_bf16 v[60:63], v[12:15], v[32:39], v0
    ds_read_b128 v[32:35], v2 offset:51200
    v_smfmac_f32_16x16x64_bf16 v[48:51], v[12:15], v[144:151], v0
    ds_read_b128 v[36:39], v2 offset:52224
    v_smfmac_f32_16x16x64_bf16 v[52:55], v[12:15], v[152:159], v0
    buffer_load_dwordx4 v[12:15], v4, s[44:47], s74 offen offset:0 sc1
    s_waitcnt vmcnt(4) lgkmcnt(2)
    v_smfmac_f32_16x16x64_bf16 v[56:59], v[252:255], v[24:31], v0
    ds_read_b128 v[24:27], v3 offset:0
    v_smfmac_f32_16x16x64_bf16 v[40:43], v[252:255], a[208:215], v0
    ds_read_b128 v[28:31], v3 offset:1024
    v_smfmac_f32_16x16x64_bf16 v[44:47], v[252:255], a[216:223], v0
    s_waitcnt lgkmcnt(2)
    v_smfmac_f32_16x16x64_bf16 v[60:63], v[252:255], v[32:39], v0
    ds_read_b128 v[32:35], v3 offset:2048
    v_smfmac_f32_16x16x64_bf16 v[48:51], v[252:255], v[160:167], v0
    ds_read_b128 v[36:39], v3 offset:3072
    v_smfmac_f32_16x16x64_bf16 v[52:55], v[252:255], v[168:175], v0
    buffer_load_dwordx4 v[252:255], v5, s[44:47], s92 offen sc1
    s_waitcnt vmcnt(4) lgkmcnt(2)
    v_smfmac_f32_16x16x64_bf16 v[56:59], v[248:251], v[24:31], v0
    ds_read_b128 v[24:27], v3 offset:16384
    v_smfmac_f32_16x16x64_bf16 v[40:43], v[248:251], a[224:231], v0
    ds_read_b128 v[28:31], v3 offset:17408
    v_smfmac_f32_16x16x64_bf16 v[44:47], v[248:251], a[232:239], v0
    s_waitcnt lgkmcnt(2)
    v_smfmac_f32_16x16x64_bf16 v[60:63], v[248:251], v[32:39], v0
    ds_read_b128 v[32:35], v3 offset:18432
    v_smfmac_f32_16x16x64_bf16 v[48:51], v[248:251], v[176:183], v0
    ds_read_b128 v[36:39], v3 offset:19456
    v_smfmac_f32_16x16x64_bf16 v[52:55], v[248:251], v[184:191], v0
    buffer_load_dwordx4 v[248:251], v5, s[44:47], s91 offen sc1
    s_waitcnt vmcnt(4) lgkmcnt(2)
    v_smfmac_f32_16x16x64_bf16 v[56:59], v[16:19], v[24:31], v0
    ds_read_b128 v[24:27], v3 offset:32768
    v_smfmac_f32_16x16x64_bf16 v[40:43], v[16:19], a[240:247], v0
    ds_read_b128 v[28:31], v3 offset:33792
    v_smfmac_f32_16x16x64_bf16 v[44:47], v[16:19], a[248:255], v0
    s_waitcnt lgkmcnt(2)
    v_smfmac_f32_16x16x64_bf16 v[60:63], v[16:19], v[32:39], v0
    ds_read_b128 v[32:35], v3 offset:34816
    v_smfmac_f32_16x16x64_bf16 v[48:51], v[16:19], v[192:199], v0
    ds_read_b128 v[36:39], v3 offset:35840
    v_smfmac_f32_16x16x64_bf16 v[52:55], v[16:19], v[200:207], v0
    s_waitcnt vmcnt(3) lgkmcnt(2)
    v_smfmac_f32_16x16x64_bf16 v[56:59], v[20:23], v[24:31], v0
    ds_read_b128 v[24:27], v3 offset:49152
    v_smfmac_f32_16x16x64_bf16 v[40:43], v[20:23], v[64:71], v0
    ds_read_b128 v[28:31], v3 offset:50176
    v_smfmac_f32_16x16x64_bf16 v[44:47], v[20:23], v[72:79], v0
    s_waitcnt lgkmcnt(2)
    v_smfmac_f32_16x16x64_bf16 v[60:63], v[20:23], v[32:39], v0
    ds_read_b128 v[32:35], v3 offset:51200
    v_smfmac_f32_16x16x64_bf16 v[48:51], v[20:23], v[208:215], v0
    ds_read_b128 v[36:39], v3 offset:52224
    v_smfmac_f32_16x16x64_bf16 v[52:55], v[20:23], v[216:223], v0
    s_waitcnt vmcnt(2) lgkmcnt(2)
    v_smfmac_f32_16x16x64_bf16 v[48:51], v[12:15], v[224:231], v0
    v_smfmac_f32_16x16x64_bf16 v[40:43], v[12:15], v[80:87], v0
    v_smfmac_f32_16x16x64_bf16 v[56:59], v[12:15], v[24:31], v0
    ds_read_b128 v[24:27], v4 offset:9216
    ds_read_b128 v[28:31], v4 offset:10240
    v_smfmac_f32_16x16x64_bf16 v[52:55], v[12:15], v[232:239], v0
    s_waitcnt lgkmcnt(2)
    v_smfmac_f32_16x16x64_bf16 v[44:47], v[12:15], v[88:95], v0
    s_waitcnt vmcnt(0)
    s_nop 7
    s_branch CH_fast0_COMB
CH_fast1_IDLE:
    v_mov_b64 v[40:41], 0
    v_mov_b64 v[42:43], 0
    v_mov_b64 v[44:45], 0
    v_mov_b64 v[46:47], 0
    v_mov_b64 v[48:49], 0
    v_mov_b64 v[50:51], 0
    v_mov_b64 v[52:53], 0
    v_mov_b64 v[54:55], 0
    v_mov_b64 v[56:57], 0
    v_mov_b64 v[58:59], 0
    v_mov_b64 v[60:61], 0
    v_mov_b64 v[62:63], 0
    s_add_u32 s70, s70, 1
    s_mov_b32 s53, s59
    s_add_u32 s59, s59, 0x01010101
    s_sub_u32 s71, s73, 131072
    s_add_u32 s93, s71, 4096
    s_add_u32 s74, s71, 8192
    s_add_u32 s73, s73, 9216
    s_mov_b32 s87, 0
    s_cmp_eq_u32 s57, 2
    s_cbranch_scc0 CH_fast1_KVCHK
    s_waitcnt vmcnt(0)
    s_branch CH_fast0_ENTER
CH_fast1_KVCHK:
    s_waitcnt vmcnt(9)
CH_fast1_KVCHK2:
    v_readfirstlane_b32 s99, v11
    s_min_u32 s98, s70, 62
    s_add_u32 s98, s98, 2
    s_cmp_ge_u32 s99, s98
    s_cbranch_scc1 CH_fast1_PUB0
    buffer_load_dword v11, off, s[44:47], s77 sc1
    s_add_u32 s100, s100, 1
    s_cmp_lt_u32 s100, 262144
    s_cbranch_scc1 spin_ok_24
    s_mov_b32 s98, 6
    s_branch FAIL
spin_ok_24:
    s_waitcnt vmcnt(0)
    s_branch CH_fast1_KVCHK2
CH_fast1_PUB0:
    s_mov_b64 exec, 255
    s_nop 15
    s_nop 15
    s_nop 15
    s_nop 15
    s_nop 15
CH_fast1_PUB0L:
    buffer_load_dword v1, v14, s[64:67], 0 offen sc1
    s_nop 1
    s_nop 1
    v_cmp_ne_u32 vcc, s53, v1
    s_cbranch_vccz CH_fast0_ENTER3
    buffer_load_dword v1, v14, s[64:67], 0 offen sc1
    s_nop 1
    s_nop 1
    v_cmp_ne_u32 vcc, s53, v1
    s_cbranch_vccz CH_fast0_ENTER3
    buffer_load_dword v1, v14, s[64:67], 0 offen sc1
    s_nop 1
    s_nop 1
    v_cmp_ne_u32 vcc, s53, v1
    s_cbranch_vccz CH_fast0_ENTER3
    s_add_u32 s100, s100, 1
    s_cmp_lt_u32 s100, 262144
    s_cbranch_scc1 CH_fast1_PUB0L
    s_branch CH_fast1_HFAIL
CH_fast1_HFAIL:
    s_mov_b32 s98, 5
    s_branch FAIL
CH_fast1_RRETRY:
    buffer_load_dwordx4 v[32:35], v9, s[44:47], s80 offen sc1
    buffer_load_dwordx4 v[36:39], v9, s[44:47], s81 offen sc1
    buffer_load_dwordx4 v[248:251], v9, s[44:47], s82 offen sc1
    buffer_load_dwordx4 v[252:255], v9, s[44:47], s83 offen sc1
    s_add_u32 s100, s100, 1
    s_cmp_lt_u32 s100, 262144
    s_cbranch_scc1 spin_ok_25
    s_mov_b32 s98, 4
    s_branch FAIL
spin_ok_25:
    s_branch CH_fast1_RSUM
CH_fast1_REDO:
    s_cmp_eq_u32 s87, 1
    s_cbranch_scc1 CH_fast1_COMBOK
    s_mov_b32 s87, 1
    s_nop 7
    s_waitcnt lgkmcnt(0)
CH_fast1_REDOP:
    v_mov_b32 v40, 0
    buffer_load_dwordx4 v[248:251], v4, s[44:47], s71 offen offset:0 sc1
    buffer_load_dwordx4 v[16:19], v4, s[44:47], s71 offen offset:1024 sc1
    buffer_load_dwordx4 v[20:23], v4, s[44:47], s71 offen offset:2048 sc1
    buffer_load_dwordx4 v[12:15], v4, s[44:47], s71 offen offset:3072 sc1
    buffer_load_dwordx4 v[252:255], v4, s[44:47], s93 offen offset:0 sc1
    s_waitcnt vmcnt(0)
    v_max3_u32 v40, v40, v248, v249
    v_max3_u32 v40, v40, v250, v251
    v_max3_u32 v40, v40, v16, v17
    v_max3_u32 v40, v40, v18, v19
    v_max3_u32 v40, v40, v20, v21
    v_max3_u32 v40, v40, v22, v23
    v_max3_u32 v40, v40, v12, v13
    v_max3_u32 v40, v40, v14, v15
    v_max3_u32 v40, v40, v252, v253
    v_max3_u32 v40, v40, v254, v255
    buffer_load_dwordx4 v[248:251], v4, s[44:47], s93 offen offset:1024 sc1
    buffer_load_dwordx4 v[16:19], v4, s[44:47], s93 offen offset:2048 sc1
    buffer_load_dwordx4 v[20:23], v4, s[44:47], s93 offen offset:3072 sc1
    buffer_load_dwordx4 v[12:15], v4, s[44:47], s74 offen offset:0 sc1
    s_waitcnt vmcnt(0)
    v_max3_u32 v40, v40, v248, v249
    v_max3_u32 v40, v40, v250, v251
    v_max3_u32 v40, v40, v16, v17
    v_max3_u32 v40, v40, v18, v19
    v_max3_u32 v40, v40, v20, v21
    v_max3_u32 v40, v40, v22, v23
    v_max3_u32 v40, v40, v12, v13
    v_max3_u32 v40, v40, v14, v15
    s_add_u32 s100, s100, 1
    s_cmp_lt_u32 s100, 262144
    s_cbranch_scc1 spin_ok_26
    s_mov_b32 s98, 3
    s_branch FAIL
spin_ok_26:
    v_cmp_eq_u32 vcc, -1, v40
    s_cbranch_vccnz CH_fast1_REDOP
    v_mov_b64 v[40:41], 0
    v_mov_b64 v[42:43], 0
    v_mov_b64 v[44:45], 0
    v_mov_b64 v[46:47], 0
    v_mov_b64 v[48:49], 0
    v_mov_b64 v[50:51], 0
    v_mov_b64 v[52:53], 0
    v_mov_b64 v[54:55], 0
    v_mov_b64 v[56:57], 0
    v_mov_b64 v[58:59], 0
    v_mov_b64 v[60:61], 0
    v_mov_b64 v[62:63], 0
    buffer_load_dwordx4 v[248:251], v4, s[44:47], s71 offen offset:0 sc1
    ds_read_b128 v[24:27], v2 offset:0
    ds_read_b128 v[28:31], v2 offset:1024
    ds_read_b128 v[32:35], v5 offset:1024
    ds_read_b128 v[36:39], v5 offset:5120
    buffer_load_dwordx4 v[16:19], v4, s[44:47], s71 offen offset:1024 sc1
    s_add_u32 s91, s92, 4096
    buffer_load_dwordx4 v[20:23], v4, s[44:47], s71 offen offset:2048 sc1
    s_waitcnt vmcnt(2)
    v_smfmac_f32_16x16x64_bf16 v[56:59], v[248:251], v[240:247], v0
    buffer_load_dwordx4 v[12:15], v4, s[44:47], s71 offen offset:3072 sc1
    v_smfmac_f32_16x16x64_bf16 v[40:43], v[248:251], a[144:151], v0
    v_smfmac_f32_16x16x64_bf16 v[44:47], v[248:251], a[152:159], v0
    s_waitcnt lgkmcnt(0)
    v_smfmac_f32_16x16x64_bf16 v[60:63], v[248:251], v[32:39], v0
    ds_read_b128 v[32:35], v2 offset:2048
    v_smfmac_f32_16x16x64_bf16 v[48:51], v[248:251], v[96:103], v0
    ds_read_b128 v[36:39], v2 offset:3072
    buffer_load_dwordx4 v[252:255], v4, s[44:47], s93 offen offset:0 sc1
    v_smfmac_f32_16x16x64_bf16 v[52:55], v[248:251], v[104:111], v0
    buffer_load_dwordx4 v[248:251], v4, s[44:47], s93 offen offset:1024 sc1
    s_waitcnt vmcnt(4)
    v_smfmac_f32_16x16x64_bf16 v[56:59], v[16:19], v[24:31], v0
    ds_read_b128 v[24:27], v2 offset:16384
    v_smfmac_f32_16x16x64_bf16 v[40:43], v[16:19], a[160:167], v0
    ds_read_b128 v[28:31], v2 offset:17408
    v_smfmac_f32_16x16x64_bf16 v[44:47], v[16:19], a[168:175], v0
    s_waitcnt lgkmcnt(2)
    v_smfmac_f32_16x16x64_bf16 v[60:63], v[16:19], v[32:39], v0
    ds_read_b128 v[32:35], v2 offset:18432
    v_smfmac_f32_16x16x64_bf16 v[48:51], v[16:19], v[112:119], v0
    ds_read_b128 v[36:39], v2 offset:19456
    v_smfmac_f32_16x16x64_bf16 v[52:55], v[16:19], v[120:127], v0
    buffer_load_dwordx4 v[16:19], v4, s[44:47], s93 offen offset:2048 sc1
    s_waitcnt vmcnt(4) lgkmcnt(2)
    v_smfmac_f32_16x16x64_bf16 v[56:59], v[20:23], v[24:31], v0
    ds_read_b128 v[24:27], v2 offset:32768
    v_smfmac_f32_16x16x64_bf16 v[40:43], v[20:23], a[176:183], v0
    ds_read_b128 v[28:31], v2 offset:33792
    v_smfmac_f32_16x16x64_bf16 v[44:47], v[20:23], a[184:191], v0
    s_waitcnt lgkmcnt(2)
    v_smfmac_f32_16x16x64_bf16 v[60:63], v[20:23], v[32:39], v0
    ds_read_b128 v[32:35], v2 offset:34816
    v_smfmac_f32_16x16x64_bf16 v[48:51], v[20:23], v[128:135], v0
    ds_read_b128 v[36:39], v2 offset:35840
    v_smfmac_f32_16x16x64_bf16 v[52:55], v[20:23], v[136:143], v0
    buffer_load_dwordx4 v[20:23], v4, s[44:47], s93 offen offset:3072 sc1
    s_waitcnt vmcnt(4) lgkmcnt(2)
    v_smfmac_f32_16x16x64_bf16 v[56:59], v[12:15], v[24:31], v0
    ds_read_b128 v[24:27], v2 offset:49152
    v_smfmac_f32_16x16x64_bf16 v[40:43], v[12:15], a[192:199], v0
    ds_read_b128 v[28:31], v2 offset:50176
    v_smfmac_f32_16x16x64_bf16 v[44:47], v[12:15], a[200:207], v0
    s_waitcnt lgkmcnt(2)
    v_smfmac_f32_16x16x64_bf16 v[60:63], v[12:15], v[32:39], v0
    ds_read_b128 v[32:35], v2 offset:51200
    v_smfmac_f32_16x16x64_bf16 v[48:51], v[12:15], v[144:151], v0
    ds_read_b128 v[36:39], v2 offset:52224
    v_smfmac_f32_16x16x64_bf16 v[52:55], v[12:15], v[152:159], v0
    buffer_load_dwordx4 v[12:15], v4, s[44:47], s74 offen offset:0 sc1
    s_waitcnt vmcnt(4) lgkmcnt(2)
    v_smfmac_f32_16x16x64_bf16 v[56:59], v[252:255], v[24:31], v0
    ds_read_b128 v[24:27], v3 offset:0
    v_smfmac_f32_16x16x64_bf16 v[40:43], v[252:255], a[208:215], v0
    ds_read_b128 v[28:31], v3 offset:1024
    v_smfmac_f32_16x16x64_bf16 v[44:47], v[252:255], a[216:223], v0
    s_waitcnt lgkmcnt(2)
    v_smfmac_f32_16x16x64_bf16 v[60:63], v[252:255], v[32:39], v0
    ds_read_b128 v[32:35], v3 offset:2048
    v_smfmac_f32_16x16x64_bf16 v[48:51], v[252:255], v[160:167], v0
    ds_read_b128 v[36:39], v3 offset:3072
    v_smfmac_f32_16x16x64_bf16 v[52:55], v[252:255], v[168:175], v0
    buffer_load_dwordx4 v[252:255], v5, s[44:47], s92 offen sc1
    s_waitcnt vmcnt(4) lgkmcnt(2)
    v_smfmac_f32_16x16x64_bf16 v[56:59], v[248:251], v[24:31], v0
    ds_read_b128 v[24:27], v3 offset:16384
    v_smfmac_f32_16x16x64_bf16 v[40:43], v[248:251], a[224:231], v0
    ds_read_b128 v[28:31], v3 offset:17408
    v_smfmac_f32_16x16x64_bf16 v[44:47], v[248:251], a[232:239], v0
    s_waitcnt lgkmcnt(2)
    v_smfmac_f32_16x16x64_bf16 v[60:63], v[248:251], v[32:39], v0
    ds_read_b128 v[32:35], v3 offset:18432
    v_smfmac_f32_16x16x64_bf16 v[48:51], v[248:251], v[176:183], v0
    ds_read_b128 v[36:39], v3 offset:19456
    v_smfmac_f32_16x16x64_bf16 v[52:55], v[248:251], v[184:191], v0
    buffer_load_dwordx4 v[248:251], v5, s[44:47], s91 offen sc1
    s_waitcnt vmcnt(4) lgkmcnt(2)
    v_smfmac_f32_16x16x64_bf16 v[56:59], v[16:19], v[24:31], v0
    ds_read_b128 v[24:27], v3 offset:32768
    v_smfmac_f32_16x16x64_bf16 v[40:43], v[16:19], a[240:247], v0
    ds_read_b128 v[28:31], v3 offset:33792
    v_smfmac_f32_16x16x64_bf16 v[44:47], v[16:19], a[248:255], v0
    s_waitcnt lgkmcnt(2)
    v_smfmac_f32_16x16x64_bf16 v[60:63], v[16:19], v[32:39], v0
    ds_read_b128 v[32:35], v3 offset:34816
    v_smfmac_f32_16x16x64_bf16 v[48:51], v[16:19], v[192:199], v0
    ds_read_b128 v[36:39], v3 offset:35840
    v_smfmac_f32_16x16x64_bf16 v[52:55], v[16:19], v[200:207], v0
    s_waitcnt vmcnt(3) lgkmcnt(2)
    v_smfmac_f32_16x16x64_bf16 v[56:59], v[20:23], v[24:31], v0
    ds_read_b128 v[24:27], v3 offset:49152
    v_smfmac_f32_16x16x64_bf16 v[40:43], v[20:23], v[64:71], v0
    ds_read_b128 v[28:31], v3 offset:50176
    v_smfmac_f32_16x16x64_bf16 v[44:47], v[20:23], v[72:79], v0
    s_waitcnt lgkmcnt(2)
    v_smfmac_f32_16x16x64_bf16 v[60:63], v[20:23], v[32:39], v0
    ds_read_b128 v[32:35], v3 offset:51200
    v_smfmac_f32_16x16x64_bf16 v[48:51], v[20:23], v[208:215], v0
    ds_read_b128 v[36:39], v3 offset:52224
    v_smfmac_f32_16x16x64_bf16 v[52:55], v[20:23], v[216:223], v0
    s_waitcnt vmcnt(2) lgkmcnt(2)
    v_smfmac_f32_16x16x64_bf16 v[48:51], v[12:15], v[224:231], v0
    v_smfmac_f32_16x16x64_bf16 v[40:43], v[12:15], v[80:87], v0
    v_smfmac_f32_16x16x64_bf16 v[56:59], v[12:15], v[24:31], v0
    ds_read_b128 v[24:27], v4 offset:17408
    ds_read_b128 v[28:31], v4 offset:18432
    v_smfmac_f32_16x16x64_bf16 v[52:55], v[12:15], v[232:239], v0
    s_waitcnt lgkmcnt(2)
    v_smfmac_f32_16x16x64_bf16 v[44:47], v[12:15], v[88:95], v0
    s_waitcnt vmcnt(0)
    s_nop 7
    s_branch CH_fast1_COMB
CH_fast_LAST:
    buffer_store_dwordx4 v[16:19], v5, s[44:47], s76 offen sc1
    s_waitcnt vmcnt(0)
    s_barrier
    v_mov_b32 v1, 64
    buffer_store_dword v1, off, s[44:47], s78 sc1
    s_branch END
.p2align 6
CH_safe0_ENTER3:
CH_safe0_ENTER:
    s_barrier
    s_mov_b64 exec, -1
    buffer_load_dwordx4 v[248:251], v4, s[44:47], s71 offen offset:0
    ds_read_b128 v[24:27], v2 offset:0
    ds_read_b128 v[28:31], v2 offset:1024
    ds_read_b128 v[32:35], v5 offset:1024
    ds_read_b128 v[36:39], v5 offset:5120
    buffer_load_dwordx4 v[16:19], v4, s[44:47], s71 offen offset:1024
    s_add_u32 s91, s92, 4096
    s_add_u32 m0, s90, 8192
    s_add_u32 s75, s75, 16384
    s_add_u32 s88, s88, s86
    v_lshlrev_b32 v11, 2, v4
    v_and_b32 v11, s58, v11
    buffer_load_dwordx4 v[20:23], v4, s[44:47], s71 offen offset:2048
    s_waitcnt vmcnt(2)
    v_smfmac_f32_16x16x64_bf16 v[56:59], v[248:251], v[240:247], v0
    buffer_load_dwordx4 v[12:15], v4, s[44:47], s71 offen offset:3072
    v_smfmac_f32_16x16x64_bf16 v[40:43], v[248:251], a[144:151], v0
    v_smfmac_f32_16x16x64_bf16 v[44:47], v[248:251], a[152:159], v0
    s_waitcnt lgkmcnt(0)
    v_smfmac_f32_16x16x64_bf16 v[60:63], v[248:251], v[32:39], v0
    ds_read_b128 v[32:35], v2 offset:2048
    v_smfmac_f32_16x16x64_bf16 v[48:51], v[248:251], v[96:103], v0
    ds_read_b128 v[36:39], v2 offset:3072
    buffer_load_dwordx4 v[252:255], v4, s[44:47], s93 offen offset:0
    v_smfmac_f32_16x16x64_bf16 v[52:55], v[248:251], v[104:111], v0
    buffer_load_dwordx4 v[248:251], v4, s[44:47], s93 offen offset:1024
    s_waitcnt vmcnt(4)
    v_smfmac_f32_16x16x64_bf16 v[56:59], v[16:19], v[24:31], v0
    ds_read_b128 v[24:27], v2 offset:16384
    v_smfmac_f32_16x16x64_bf16 v[40:43], v[16:19], a[160:167], v0
    ds_read_b128 v[28:31], v2 offset:17408
    v_smfmac_f32_16x16x64_bf16 v[44:47], v[16:19], a[168:175], v0
    s_waitcnt lgkmcnt(2)
    v_smfmac_f32_16x16x64_bf16 v[60:63], v[16:19], v[32:39], v0
    ds_read_b128 v[32:35], v2 offset:18432
    v_smfmac_f32_16x16x64_bf16 v[48:51], v[16:19], v[112:119], v0
    ds_read_b128 v[36:39], v2 offset:19456
    v_smfmac_f32_16x16x64_bf16 v[52:55], v[16:19], v[120:127], v0
    buffer_load_dwordx4 v[16:19], v4, s[44:47], s93 offen offset:2048
    s_waitcnt vmcnt(4) lgkmcnt(2)
    v_smfmac_f32_16x16x64_bf16 v[56:59], v[20:23], v[24:31], v0
    ds_read_b128 v[24:27], v2 offset:32768
    v_smfmac_f32_16x16x64_bf16 v[40:43], v[20:23], a[176:183], v0
    ds_read_b128 v[28:31], v2 offset:33792
    v_smfmac_f32_16x16x64_bf16 v[44:47], v[20:23], a[184:191], v0
    s_waitcnt lgkmcnt(2)
    v_smfmac_f32_16x16x64_bf16 v[60:63], v[20:23], v[32:39], v0
    ds_read_b128 v[32:35], v2 offset:34816
    v_smfmac_f32_16x16x64_bf16 v[48:51], v[20:23], v[128:135], v0
    ds_read_b128 v[36:39], v2 offset:35840
    v_smfmac_f32_16x16x64_bf16 v[52:55], v[20:23], v[136:143], v0
    buffer_load_dwordx4 v[20:23], v4, s[44:47], s93 offen offset:3072
    s_waitcnt vmcnt(4) lgkmcnt(2)
    v_smfmac_f32_16x16x64_bf16 v[56:59], v[12:15], v[24:31], v0
    ds_read_b128 v[24:27], v2 offset:49152
    v_smfmac_f32_16x16x64_bf16 v[40:43], v[12:15], a[192:199], v0
    ds_read_b128 v[28:31], v2 offset:50176
    v_smfmac_f32_16x16x64_bf16 v[44:47], v[12:15], a[200:207], v0
    s_waitcnt lgkmcnt(2)
    v_smfmac_f32_16x16x64_bf16 v[60:63], v[12:15], v[32:39], v0
    ds_read_b128 v[32:35], v2 offset:51200
    v_smfmac_f32_16x16x64_bf16 v[48:51], v[12:15], v[144:151], v0
    ds_read_b128 v[36:39], v2 offset:52224
    v_smfmac_f32_16x16x64_bf16 v[52:55], v[12:15], v[152:159], v0
    buffer_load_dwordx4 v[12:15], v4, s[44:47], s74 offen offset:0
    s_waitcnt vmcnt(4) lgkmcnt(2)
    v_smfmac_f32_16x16x64_bf16 v[56:59], v[252:255], v[24:31], v0
    ds_read_b128 v[24:27], v3 offset:0
    v_smfmac_f32_16x16x64_bf16 v[40:43], v[252:255], a[208:215], v0
    ds_read_b128 v[28:31], v3 offset:1024
    v_smfmac_f32_16x16x64_bf16 v[44:47], v[252:255], a[216:223], v0
    s_waitcnt lgkmcnt(2)
    v_smfmac_f32_16x16x64_bf16 v[60:63], v[252:255], v[32:39], v0
    ds_read_b128 v[32:35], v3 offset:2048
    v_smfmac_f32_16x16x64_bf16 v[48:51], v[252:255], v[160:167], v0
    ds_read_b128 v[36:39], v3 offset:3072
    v_smfmac_f32_16x16x64_bf16 v[52:55], v[252:255], v[168:175], v0
    buffer_load_dwordx4 v[252:255], v5, s[44:47], s92 offen sc1
    s_waitcnt vmcnt(4) lgkmcnt(2)
    v_smfmac_f32_16x16x64_bf16 v[56:59], v[248:251], v[24:31], v0
    ds_read_b128 v[24:27], v3 offset:16384
    v_smfmac_f32_16x16x64_bf16 v[40:43], v[248:251], a[224:231], v0
    ds_read_b128 v[28:31], v3 offset:17408
    v_smfmac_f32_16x16x64_bf16 v[44:47], v[248:251], a[232:239], v0
    s_waitcnt lgkmcnt(2)
    v_smfmac_f32_16x16x64_bf16 v[60:63], v[248:251], v[32:39], v0
    ds_read_b128 v[32:35], v3 offset:18432
    v_smfmac_f32_16x16x64_bf16 v[48:51], v[248:251], v[176:183], v0
    ds_read_b128 v[36:39], v3 offset:19456
    v_smfmac_f32_16x16x64_bf16 v[52:55], v[248:251], v[184:191], v0
    buffer_load_dwordx4 v[248:251], v5, s[44:47], s91 offen sc1
    s_waitcnt vmcnt(4) lgkmcnt(2)
    v_smfmac_f32_16x16x64_bf16 v[56:59], v[16:19], v[24:31], v0
    ds_read_b128 v[24:27], v3 offset:32768
    v_smfmac_f32_16x16x64_bf16 v[40:43], v[16:19], a[240:247], v0
    ds_read_b128 v[28:31], v3 offset:33792
    v_smfmac_f32_16x16x64_bf16 v[44:47], v[16:19], a[248:255], v0
    s_waitcnt lgkmcnt(2)
    v_smfmac_f32_16x16x64_bf16 v[60:63], v[16:19], v[32:39], v0
    ds_read_b128 v[32:35], v3 offset:34816
    v_smfmac_f32_16x16x64_bf16 v[48:51], v[16:19], v[192:199], v0
    ds_read_b128 v[36:39], v3 offset:35840
    v_smfmac_f32_16x16x64_bf16 v[52:55], v[16:19], v[200:207], v0
    buffer_load_dwordx4 v4, s[44:47], s75 offen offset:0 sc1 lds
    s_waitcnt vmcnt(4) lgkmcnt(2)
    v_smfmac_f32_16x16x64_bf16 v[56:59], v[20:23], v[24:31], v0
    ds_read_b128 v[24:27], v3 offset:49152
    v_smfmac_f32_16x16x64_bf16 v[40:43], v[20:23], v[64:71], v0
    ds_read_b128 v[28:31], v3 offset:50176
    v_smfmac_f32_16x16x64_bf16 v[44:47], v[20:23], v[72:79], v0
    s_waitcnt lgkmcnt(2)
    v_smfmac_f32_16x16x64_bf16 v[60:63], v[20:23], v[32:39], v0
    ds_read_b128 v[32:35], v3 offset:51200
    v_smfmac_f32_16x16x64_bf16 v[48:51], v[20:23], v[208:215], v0
    ds_read_b128 v[36:39], v3 offset:52224
    v_smfmac_f32_16x16x64_bf16 v[52:55], v[20:23], v[216:223], v0
    buffer_load_dwordx4 v4, s[44:47], s75 offen offset:1024 sc1 lds
    s_waitcnt vmcnt(4) lgkmcnt(2)
    v_smfmac_f32_16x16x64_bf16 v[48:51], v[12:15], v[224:231], v0
    v_mov_b32 v1, s70
    v_smfmac_f32_16x16x64_bf16 v[40:43], v[12:15], v[80:87], v0
    buffer_store_dword v1, off, s[44:47], s78 sc1
    v_smfmac_f32_16x16x64_bf16 v[56:59], v[12:15], v[24:31], v0
    ds_read_b128 v[24:27], v4 offset:9216
    ds_read_b128 v[28:31], v4 offset:10240
    v_smfmac_f32_16x16x64_bf16 v[52:55], v[12:15], v[232:239], v0
    s_waitcnt lgkmcnt(2)
    v_smfmac_f32_16x16x64_bf16 v[44:47], v[12:15], v[88:95], v0
CH_safe0_COMB:
    v_smfmac_f32_16x16x64_bf16 v[60:63], v[12:15], v[32:39], v0
    v_add_f32 v48, v48, v50
    v_add_f32 v49, v49, v51
    v_add_f32 v40, v40, v42
    v_add_f32 v41, v41, v43
    v_cvt_pk_bf16_f32 v20, v48, v49
    v_cvt_pk_bf16_f32 v21, v40, v41
    v_add_f32 v52, v52, v54
    v_add_f32 v53, v53, v55
    v_add_f32 v44, v44, v46
    v_add_f32 v45, v45, v47
    v_cvt_pk_bf16_f32 v22, v52, v53
    v_cvt_pk_bf16_f32 v23, v44, v45
    ds_write2_b64 v6, v[20:21], v[22:23] offset0:0 offset1:16
    ds_read_b128 v[32:35], v4 offset:11264
    ds_read_b128 v[36:39], v4 offset:12288
    v_cmp_u_f32 vcc, v48, v49
    v_pk_add_f32 v[56:57], v[56:57], v[58:59]
    v_pk_add_f32 v[60:61], v[60:61], v[62:63]
    v_mov_b32 v16, v20
    v_mov_b32 v17, v22
    v_cvt_pk_bf16_f32 v18, v56, v57
    v_cvt_pk_bf16_f32 v19, v60, v61
    s_cbranch_vccnz CH_safe0_REDO
CH_safe0_COMBOK:
    s_waitcnt lgkmcnt(2)
    s_barrier
    ds_read_b64_tr_b16 v[40:41], v7 offset:0
    ds_read_b64_tr_b16 v[42:43], v7 offset:64
    ds_read_b64_tr_b16 v[44:45], v7 offset:256
    ds_read_b64_tr_b16 v[46:47], v7 offset:320
    ds_read_b64_tr_b16 v[48:49], v7 offset:512
    ds_read_b64_tr_b16 v[50:51], v7 offset:576
    ds_read_b64_tr_b16 v[52:53], v7 offset:768
    ds_read_b64_tr_b16 v[54:55], v7 offset:832
    buffer_load_dword v11, v11, s[44:47], s88 offen sc1
    s_waitcnt lgkmcnt(6)
    v_mfma_f32_16x16x32_bf16 v[56:59], v[24:27], v[40:43], 0
    ds_read_b128 v[24:27], v4 offset:13312
    v_mfma_f32_16x16x32_bf16 v[60:63], v[28:31], v[40:43], 0
    ds_read_b128 v[28:31], v4 offset:14336
    v_mfma_f32_16x16x32_bf16 v[12:15], v[40:43], v[40:43], 0
    s_waitcnt lgkmcnt(6)
    v_mfma_f32_16x16x32_bf16 v[56:59], v[32:35], v[44:47], v[56:59]
    ds_read_b128 v[32:35], v4 offset:15360
    v_mfma_f32_16x16x32_bf16 v[60:63], v[36:39], v[44:47], v[60:63]
    ds_read_b128 v[36:39], v4 offset:16384
    v_mfma_f32_16x16x32_bf16 v[12:15], v[44:47], v[44:47], v[12:15]
    s_waitcnt lgkmcnt(2)
    v_mfma_f32_16x16x32_bf16 v[56:59], v[24:27], v[48:51], v[56:59]
    buffer_store_dwordx4 v[16:19], v5, s[44:47], s76 offen sc1
    v_mfma_f32_16x16x32_bf16 v[60:63], v[28:31], v[48:51], v[60:63]
    v_mfma_f32_16x16x32_bf16 v[12:15], v[48:51], v[48:51], v[12:15]
    s_waitcnt lgkmcnt(0)
    v_mfma_f32_16x16x32_bf16 v[56:59], v[32:35], v[52:55], v[56:59]
    v_mov_b32 v45, 0
    v_mfma_f32_16x16x32_bf16 v[60:63], v[36:39], v[52:55], v[60:63]
    v_mov_b32 v46, 0
    v_mfma_f32_16x16x32_bf16 v[12:15], v[52:55], v[52:55], v[12:15]
    v_mov_b32 v32, 0x3f803f80
    v_mov_b32 v33, 0x3f803f80
    v_mov_b32 v34, 0x3f803f80
    v_mov_b32 v35, 0x3f803f80
    v_max3_f32 v24, v56, v57, v58
    s_nop 0
    v_max3_f32 v26, v60, v61, v62
    v_max3_f32 v24, v24, v59, v63
    v_max3_f32 v26, v26, v12, v13
    v_max_f32 v24, v24, v26
    v_mov_b32 v26, v24
    v_mov_b64 v[48:49], 0
    v_mov_b64 v[50:51], 0
    v_permlane32_swap_b32 v24, v26
    v_max_f32 v24, v24, v26
    v_mov_b32 v26, v24
    v_mov_b64 v[52:53], 0
    v_mov_b64 v[54:55], 0
    v_permlane16_swap_b32 v24, v26
    v_max_f32 v24, v24, v26
    v_mul_f32 v24, s84, v24
    v_pk_fma_f32 v[56:57], v[56:57], s[84:85], v[24:25] op_sel_hi:[1,1,0] neg_lo:[0,0,1] neg_hi:[0,0,1]
    v_pk_fma_f32 v[58:59], v[58:59], s[84:85], v[24:25] op_sel_hi:[1,1,0] neg_lo:[0,0,1] neg_hi:[0,0,1]
    v_pk_fma_f32 v[60:61], v[60:61], s[84:85], v[24:25] op_sel_hi:[1,1,0] neg_lo:[0,0,1] neg_hi:[0,0,1]
    v_pk_fma_f32 v[62:63], v[62:63], s[84:85], v[24:25] op_sel_hi:[1,1,0] neg_lo:[0,0,1] neg_hi:[0,0,1]
    v_pk_fma_f32 v[12:13], v[12:13], s[84:85], v[24:25] op_sel_hi:[1,1,0] neg_lo:[0,0,1] neg_hi:[0,0,1]
    v_exp_f32 v56, v56
    v_exp_f32 v57, v57
    v_exp_f32 v58, v58
    v_exp_f32 v59, v59
    v_exp_f32 v60, v60
    v_exp_f32 v61, v61
    v_exp_f32 v62, v62
    v_exp_f32 v63, v63
    v_cvt_pk_bf16_f32 v40, v56, v57
    v_cvt_pk_bf16_f32 v41, v58, v59
    v_cvt_pk_bf16_f32 v42, v60, v61
    v_cvt_pk_bf16_f32 v43, v62, v63
    v_exp_f32 v12, v12
    s_waitcnt vmcnt(5)
    v_mfma_f32_16x16x32_bf16 v[20:23], v[32:35], v[40:43], 0
    v_exp_f32 v13, v13
    v_mfma_f32_16x16x32_bf16 v[56:59], v[252:255], v[40:43], 0
    v_cvt_pk_bf16_f32 v44, v12, v13
    v_mfma_f32_16x16x32_bf16 v[60:63], v[248:251], v[40:43], 0
    v_cvt_pk_bf16_f32 v47, v12, v13
    v_mov_b64 v[36:37], 0
    v_mfma_f32_16x16x16_bf16 v[20:23], v[32:33], v[44:45], v[20:23]
    v_mov_b64 v[38:39], 0
    v_mfma_f32_16x16x16_bf16 v[56:59], v[18:19], v[44:45], v[56:59]
    v_mov_b64 v[40:41], 0
    v_mfma_f32_16x16x16_bf16 v[60:63], v[18:19], v[46:47], v[60:63]
    v_mov_b64 v[28:29], 0
    v_mov_b64 v[30:31], 0
    v_mov_b64 v[32:33], 0
    v_mov_b64 v[34:35], 0
    v_rcp_f32 v24, v20
    v_mov_b64 v[42:43], 0
    v_pk_mul_f32 v[56:57], v[56:57], v[24:25] op_sel_hi:[1,0]
    v_pk_mul_f32 v[58:59], v[58:59], v[24:25] op_sel_hi:[1,0]
    v_pk_mul_f32 v[60:61], v[60:61], v[24:25] op_sel_hi:[1,0]
    v_pk_mul_f32 v[62:63], v[62:63], v[24:25] op_sel_hi:[1,0]
    v_cvt_pk_bf16_f32 v16, v56, v57
    v_cvt_pk_bf16_f32 v17, v58, v59
    v_cvt_pk_bf16_f32 v18, v60, v61
    v_cvt_pk_bf16_f32 v19, v62, v63
    s_mov_b64 exec, s[94:95]
    ds_write_b128 v8, v[16:19]
    s_mov_b64 exec, -1
    v_mov_b64 v[44:45], 0
    v_mov_b64 v[46:47], 0
    v_mov_b64 v[56:57], 0
    v_mov_b64 v[58:59], 0
    v_mov_b64 v[60:61], 0
    v_mov_b64 v[62:63], 0
    v_mov_b32 v15, s59
    v_bfe_u32 v14, v4, 2, 8
    v_bfe_u32 v13, v4, 4, 2
    v_lshrrev_b32 v13, v13, 1
    v_not_b32 v13, v13
    s_waitcnt lgkmcnt(0)
    s_barrier
    ds_read_b128 v[20:23], v4 offset:29952
    ds_read_b128 v[24:27], v4 offset:30976
    s_add_u32 s76, s76, 4096
    s_add_u32 s92, s92, 16384
    s_cmp_ge_u32 s72, 32
    s_waitcnt lgkmcnt(1)
    v_smfmac_f32_16x16x64_bf16 v[28:31], v[20:23], a[0:7], v0
    s_waitcnt lgkmcnt(0)
    v_smfmac_f32_16x16x64_bf16 v[28:31], v[24:27], a[8:15], v0
    v_smfmac_f32_16x16x64_bf16 v[32:35], v[20:23], a[16:23], v0
    v_smfmac_f32_16x16x64_bf16 v[32:35], v[24:27], a[24:31], v0
    v_smfmac_f32_16x16x64_bf16 v[36:39], v[20:23], a[32:39], v0
    s_nop 4
    v_add_f32 v28, v28, v30
    v_add_f32 v29, v29, v31
    v_smfmac_f32_16x16x64_bf16 v[36:39], v[24:27], a[40:47], v0
    v_cvt_pk_bf16_f32 v28, v28, v29
    v_smfmac_f32_16x16x64_bf16 v[40:43], v[20:23], a[48:55], v0
    v_and_b32 v28, v13, v28
    v_add_f32 v32, v32, v34
    v_add_f32 v33, v33, v35
    v_smfmac_f32_16x16x64_bf16 v[40:43], v[24:27], a[56:63], v0
    buffer_store_dword v28, v14, s[44:47], s79 offen offset:0 sc1
    v_cvt_pk_bf16_f32 v32, v32, v33
    v_smfmac_f32_16x16x64_bf16 v[44:47], v[20:23], a[64:71], v0
    v_and_b32 v32, v13, v32
    v_add_f32 v36, v36, v38
    v_add_f32 v37, v37, v39
    v_smfmac_f32_16x16x64_bf16 v[44:47], v[24:27], a[72:79], v0
    buffer_store_dword v32, v14, s[44:47], s79 offen offset:256 sc1
    v_cvt_pk_bf16_f32 v36, v36, v37
    v_smfmac_f32_16x16x64_bf16 v[48:51], v[20:23], a[80:87], v0
    v_and_b32 v36, v13, v36
    v_add_f32 v40, v40, v42
    v_add_f32 v41, v41, v43
    v_smfmac_f32_16x16x64_bf16 v[48:51], v[24:27], a[88:95], v0
    buffer_store_dword v36, v14, s[44:47], s79 offen offset:512 sc1
    v_cvt_pk_bf16_f32 v40, v40, v41
    v_smfmac_f32_16x16x64_bf16 v[52:55], v[20:23], a[96:103], v0
    v_and_b32 v40, v13, v40
    v_add_f32 v44, v44, v46
    v_add_f32 v45, v45, v47
    v_smfmac_f32_16x16x64_bf16 v[52:55], v[24:27], a[104:111], v0
    buffer_store_dword v40, v14, s[44:47], s79 offen offset:768 sc1
    v_cvt_pk_bf16_f32 v44, v44, v45
    v_smfmac_f32_16x16x64_bf16 v[56:59], v[20:23], a[112:119], v0
    v_and_b32 v44, v13, v44
    v_add_f32 v48, v48, v50
    v_add_f32 v49, v49, v51
    v_smfmac_f32_16x16x64_bf16 v[56:59], v[24:27], a[120:127], v0
    buffer_store_dword v44, v14, s[44:47], s79 offen offset:1024 sc1
    v_cvt_pk_bf16_f32 v48, v48, v49
    v_smfmac_f32_16x16x64_bf16 v[60:63], v[20:23], a[128:135], v0
    v_and_b32 v48, v13, v48
    v_add_f32 v52, v52, v54
    v_add_f32 v53, v53, v55
    v_smfmac_f32_16x16x64_bf16 v[60:63], v[24:27], a[136:143], v0
    buffer_store_dword v48, v14, s[44:47], s79 offen offset:1280 sc1
    v_cvt_pk_bf16_f32 v52, v52, v53
    v_and_b32 v52, v13, v52
    v_add_f32 v56, v56, v58
    v_add_f32 v57, v57, v59
    buffer_store_dword v52, v14, s[44:47], s79 offen offset:1536 sc1
    v_cvt_pk_bf16_f32 v56, v56, v57
    v_and_b32 v56, v13, v56
    v_add_f32 v60, v60, v62
    v_add_f32 v61, v61, v63
    buffer_store_dword v56, v14, s[44:47], s79 offen offset:1792 sc1
    v_cvt_pk_bf16_f32 v60, v60, v61
    v_and_b32 v60, v13, v60
    buffer_store_dword v60, v14, s[44:47], s79 offen offset:2048 sc1
    s_cbranch_scc0 CH_safe0_RLOAD
    s_cmp_ge_u32 s57, 2
    s_cbranch_scc1 CH_safe0_IDLE
    s_nop 3
    s_nop 3
    s_nop 3
    s_nop 3
    s_nop 3
    s_nop 3
    s_nop 3
    s_nop 3
    s_nop 3
    s_nop 3
    s_nop 3
    s_nop 3
CH_safe0_RLOAD:
    buffer_load_dwordx4 v[32:35], v9, s[44:47], s80 offen sc1
    buffer_load_dwordx4 v[36:39], v9, s[44:47], s81 offen sc1
    buffer_load_dwordx4 v[248:251], v9, s[44:47], s82 offen sc1
    buffer_load_dwordx4 v[252:255], v9, s[44:47], s83 offen sc1
    ds_read_b128 v[20:23], v4 offset:0
    v_mov_b64 v[40:41], 0
    v_mov_b64 v[42:43], 0
    v_mov_b64 v[44:45], 0
    v_mov_b64 v[46:47], 0
    v_mov_b64 v[48:49], 0
    v_mov_b64 v[50:51], 0
    v_mov_b64 v[52:53], 0
    v_mov_b64 v[54:55], 0
    v_mov_b64 v[56:57], 0
    v_mov_b64 v[58:59], 0
    v_mov_b64 v[60:61], 0
    v_mov_b64 v[62:63], 0
    s_waitcnt lgkmcnt(0)
CH_safe0_RSUM:
    s_waitcnt vmcnt(3)
    v_mfma_f32_16x16x32_bf16 v[24:27], v[32:35], v[20:23], 0
    s_waitcnt vmcnt(2)
    v_mfma_f32_16x16x32_bf16 v[24:27], v[36:39], v[20:23], v[24:27]
    v_or_b32 v28, v32, v36
    s_waitcnt vmcnt(1)
    v_mfma_f32_16x16x32_bf16 v[24:27], v[248:251], v[20:23], v[24:27]
    v_or_b32 v28, v28, v248
    s_waitcnt vmcnt(0)
    v_or_b32 v28, v28, v252
    v_and_b32 v28, 1, v28
    v_cmp_ne_u32 vcc, 0, v28
    v_mfma_f32_16x16x32_bf16 v[24:27], v[252:255], v[20:23], v[24:27]
CH_safe0_RCHK:
    s_cbranch_vccnz CH_safe0_RRETRY
    buffer_store_byte v15, off, s[44:47], s52 sc1
    s_add_u32 s70, s70, 1
    s_mov_b32 s53, s59
    s_add_u32 s59, s59, 0x01010101
    s_sub_u32 s71, s73, 131072
    s_add_u32 s93, s71, 4096
    s_add_u32 s74, s71, 8192
    s_mov_b32 s87, 0
    v_permlane32_swap_b32 v24, v26
    v_permlane32_swap_b32 v25, v27
    v_pk_add_f32 v[24:25], v[24:25], v[26:27]
    v_cvt_pk_bf16_f32 v28, v24, v25
    v_min_u32 v28, -2, v28
    buffer_store_dword v28, v10, s[44:47], s73 offen sc1
    s_add_u32 s73, s73, 9216
CH_safe1_ENTER3:
CH_safe1_ENTER:
    s_barrier
    s_mov_b64 exec, -1
    buffer_load_dwordx4 v[248:251], v4, s[44:47], s71 offen offset:0
    ds_read_b128 v[24:27], v2 offset:0
    ds_read_b128 v[28:31], v2 offset:1024
    ds_read_b128 v[32:35], v5 offset:1024
    ds_read_b128 v[36:39], v5 offset:5120
    buffer_load_dwordx4 v[16:19], v4, s[44:47], s71 offen offset:1024
    s_add_u32 s91, s92, 4096
    s_add_u32 m0, s90, 0
    s_add_u32 s75, s75, 16384
    s_cmp_eq_u32 s70, 63
    s_cselect_b32 s75, 1073741824, s75
    s_add_u32 s88, s88, s86
    v_lshlrev_b32 v11, 2, v4
    v_and_b32 v11, s58, v11
    buffer_load_dwordx4 v[20:23], v4, s[44:47], s71 offen offset:2048
    s_waitcnt vmcnt(2)
    v_smfmac_f32_16x16x64_bf16 v[56:59], v[248:251], v[240:247], v0
    buffer_load_dwordx4 v[12:15], v4, s[44:47], s71 offen offset:3072
    v_smfmac_f32_16x16x64_bf16 v[40:43], v[248:251], a[144:151], v0
    v_smfmac_f32_16x16x64_bf16 v[44:47], v[248:251], a[152:159], v0
    s_waitcnt lgkmcnt(0)
    v_smfmac_f32_16x16x64_bf16 v[60:63], v[248:251], v[32:39], v0
    ds_read_b128 v[32:35], v2 offset:2048
    v_smfmac_f32_16x16x64_bf16 v[48:51], v[248:251], v[96:103], v0
    ds_read_b128 v[36:39], v2 offset:3072
    buffer_load_dwordx4 v[252:255], v4, s[44:47], s93 offen offset:0
    v_smfmac_f32_16x16x64_bf16 v[52:55], v[248:251], v[104:111], v0
    buffer_load_dwordx4 v[248:251], v4, s[44:47], s93 offen offset:1024
    s_waitcnt vmcnt(4)
    v_smfmac_f32_16x16x64_bf16 v[56:59], v[16:19], v[24:31], v0
    ds_read_b128 v[24:27], v2 offset:16384
    v_smfmac_f32_16x16x64_bf16 v[40:43], v[16:19], a[160:167], v0
    ds_read_b128 v[28:31], v2 offset:17408
    v_smfmac_f32_16x16x64_bf16 v[44:47], v[16:19], a[168:175], v0
    s_waitcnt lgkmcnt(2)
    v_smfmac_f32_16x16x64_bf16 v[60:63], v[16:19], v[32:39], v0
    ds_read_b128 v[32:35], v2 offset:18432
    v_smfmac_f32_16x16x64_bf16 v[48:51], v[16:19], v[112:119], v0
    ds_read_b128 v[36:39], v2 offset:19456
    v_smfmac_f32_16x16x64_bf16 v[52:55], v[16:19], v[120:127], v0
    buffer_load_dwordx4 v[16:19], v4, s[44:47], s93 offen offset:2048
    s_waitcnt vmcnt(4) lgkmcnt(2)
    v_smfmac_f32_16x16x64_bf16 v[56:59], v[20:23], v[24:31], v0
    ds_read_b128 v[24:27], v2 offset:32768
    v_smfmac_f32_16x16x64_bf16 v[40:43], v[20:23], a[176:183], v0
    ds_read_b128 v[28:31], v2 offset:33792
    v_smfmac_f32_16x16x64_bf16 v[44:47], v[20:23], a[184:191], v0
    s_waitcnt lgkmcnt(2)
    v_smfmac_f32_16x16x64_bf16 v[60:63], v[20:23], v[32:39], v0
    ds_read_b128 v[32:35], v2 offset:34816
    v_smfmac_f32_16x16x64_bf16 v[48:51], v[20:23], v[128:135], v0
    ds_read_b128 v[36:39], v2 offset:35840
    v_smfmac_f32_16x16x64_bf16 v[52:55], v[20:23], v[136:143], v0
    buffer_load_dwordx4 v[20:23], v4, s[44:47], s93 offen offset:3072
    s_waitcnt vmcnt(4) lgkmcnt(2)
    v_smfmac_f32_16x16x64_bf16 v[56:59], v[12:15], v[24:31], v0
    ds_read_b128 v[24:27], v2 offset:49152
    v_smfmac_f32_16x16x64_bf16 v[40:43], v[12:15], a[192:199], v0
    ds_read_b128 v[28:31], v2 offset:50176
    v_smfmac_f32_16x16x64_bf16 v[44:47], v[12:15], a[200:207], v0
    s_waitcnt lgkmcnt(2)
    v_smfmac_f32_16x16x64_bf16 v[60:63], v[12:15], v[32:39], v0
    ds_read_b128 v[32:35], v2 offset:51200
    v_smfmac_f32_16x16x64_bf16 v[48:51], v[12:15], v[144:151], v0
    ds_read_b128 v[36:39], v2 offset:52224
    v_smfmac_f32_16x16x64_bf16 v[52:55], v[12:15], v[152:159], v0
    buffer_load_dwordx4 v[12:15], v4, s[44:47], s74 offen offset:0
    s_waitcnt vmcnt(4) lgkmcnt(2)
    v_smfmac_f32_16x16x64_bf16 v[56:59], v[252:255], v[24:31], v0
    ds_read_b128 v[24:27], v3 offset:0
    v_smfmac_f32_16x16x64_bf16 v[40:43], v[252:255], a[208:215], v0
    ds_read_b128 v[28:31], v3 offset:1024
    v_smfmac_f32_16x16x64_bf16 v[44:47], v[252:255], a[216:223], v0
    s_waitcnt lgkmcnt(2)
    v_smfmac_f32_16x16x64_bf16 v[60:63], v[252:255], v[32:39], v0
    ds_read_b128 v[32:35], v3 offset:2048
    v_smfmac_f32_16x16x64_bf16 v[48:51], v[252:255], v[160:167], v0
    ds_read_b128 v[36:39], v3 offset:3072
    v_smfmac_f32_16x16x64_bf16 v[52:55], v[252:255], v[168:175], v0
    buffer_load_dwordx4 v[252:255], v5, s[44:47], s92 offen sc1
    s_waitcnt vmcnt(4) lgkmcnt(2)
    v_smfmac_f32_16x16x64_bf16 v[56:59], v[248:251], v[24:31], v0
    ds_read_b128 v[24:27], v3 offset:16384
    v_smfmac_f32_16x16x64_bf16 v[40:43], v[248:251], a[224:231], v0
    ds_read_b128 v[28:31], v3 offset:17408
    v_smfmac_f32_16x16x64_bf16 v[44:47], v[248:251], a[232:239], v0
    s_waitcnt lgkmcnt(2)
    v_smfmac_f32_16x16x64_bf16 v[60:63], v[248:251], v[32:39], v0
    ds_read_b128 v[32:35], v3 offset:18432
    v_smfmac_f32_16x16x64_bf16 v[48:51], v[248:251], v[176:183], v0
    ds_read_b128 v[36:39], v3 offset:19456
    v_smfmac_f32_16x16x64_bf16 v[52:55], v[248:251], v[184:191], v0
    buffer_load_dwordx4 v[248:251], v5, s[44:47], s91 offen sc1
    s_waitcnt vmcnt(4) lgkmcnt(2)
    v_smfmac_f32_16x16x64_bf16 v[56:59], v[16:19], v[24:31], v0
    ds_read_b128 v[24:27], v3 offset:32768
    v_smfmac_f32_16x16x64_bf16 v[40:43], v[16:19], a[240:247], v0
    ds_read_b128 v[28:31], v3 offset:33792
    v_smfmac_f32_16x16x64_bf16 v[44:47], v[16:19], a[248:255], v0
    s_waitcnt lgkmcnt(2)
    v_smfmac_f32_16x16x64_bf16 v[60:63], v[16:19], v[32:39], v0
    ds_read_b128 v[32:35], v3 offset:34816
    v_smfmac_f32_16x16x64_bf16 v[48:51], v[16:19], v[192:199], v0
    ds_read_b128 v[36:39], v3 offset:35840
    v_smfmac_f32_16x16x64_bf16 v[52:55], v[16:19], v[200:207], v0
    buffer_load_dwordx4 v4, s[44:47], s75 offen offset:0 sc1 lds
    s_waitcnt vmcnt(4) lgkmcnt(2)
    v_smfmac_f32_16x16x64_bf16 v[56:59], v[20:23], v[24:31], v0
    ds_read_b128 v[24:27], v3 offset:49152
    v_smfmac_f32_16x16x64_bf16 v[40:43], v[20:23], v[64:71], v0
    ds_read_b128 v[28:31], v3 offset:50176
    v_smfmac_f32_16x16x64_bf16 v[44:47], v[20:23], v[72:79], v0
    s_waitcnt lgkmcnt(2)
    v_smfmac_f32_16x16x64_bf16 v[60:63], v[20:23], v[32:39], v0
    ds_read_b128 v[32:35], v3 offset:51200
    v_smfmac_f32_16x16x64_bf16 v[48:51], v[20:23], v[208:215], v0
    ds_read_b128 v[36:39], v3 offset:52224
    v_smfmac_f32_16x16x64_bf16 v[52:55], v[20:23], v[216:223], v0
    buffer_load_dwordx4 v4, s[44:47], s75 offen offset:1024 sc1 lds
    s_waitcnt vmcnt(4) lgkmcnt(2)
    v_smfmac_f32_16x16x64_bf16 v[48:51], v[12:15], v[224:231], v0
    v_mov_b32 v1, s70
    v_smfmac_f32_16x16x64_bf16 v[40:43], v[12:15], v[80:87], v0
    buffer_store_dword v1, off, s[44:47], s78 sc1
    v_smfmac_f32_16x16x64_bf16 v[56:59], v[12:15], v[24:31], v0
    ds_read_b128 v[24:27], v4 offset:17408
    ds_read_b128 v[28:31], v4 offset:18432
    v_smfmac_f32_16x16x64_bf16 v[52:55], v[12:15], v[232:239], v0
    s_waitcnt lgkmcnt(2)
    v_smfmac_f32_16x16x64_bf16 v[44:47], v[12:15], v[88:95], v0
CH_safe1_COMB:
    v_smfmac_f32_16x16x64_bf16 v[60:63], v[12:15], v[32:39], v0
    v_add_f32 v48, v48, v50
    v_add_f32 v49, v49, v51
    v_add_f32 v40, v40, v42
    v_add_f32 v41, v41, v43
    v_cvt_pk_bf16_f32 v20, v48, v49
    v_cvt_pk_bf16_f32 v21, v40, v41
    v_add_f32 v52, v52, v54
    v_add_f32 v53, v53, v55
    v_add_f32 v44, v44, v46
    v_add_f32 v45, v45, v47
    v_cvt_pk_bf16_f32 v22, v52, v53
    v_cvt_pk_bf16_f32 v23, v44, v45
    ds_write2_b64 v6, v[20:21], v[22:23] offset0:0 offset1:16
    ds_read_b128 v[32:35], v4 offset:19456
    ds_read_b128 v[36:39], v4 offset:20480
    v_cmp_u_f32 vcc, v48, v49
    v_pk_add_f32 v[56:57], v[56:57], v[58:59]
    v_pk_add_f32 v[60:61], v[60:61], v[62:63]
    v_mov_b32 v16, v20
    v_mov_b32 v17, v22
    v_cvt_pk_bf16_f32 v18, v56, v57
    v_cvt_pk_bf16_f32 v19, v60, v61
    s_cbranch_vccnz CH_safe1_REDO
CH_safe1_COMBOK:
    s_cmp_eq_u32 s70, 63
    s_cbranch_scc1 CH_safe_LAST
    s_waitcnt lgkmcnt(2)
    s_barrier
    ds_read_b64_tr_b16 v[40:41], v7 offset:0
    ds_read_b64_tr_b16 v[42:43], v7 offset:64
    ds_read_b64_tr_b16 v[44:45], v7 offset:256
    ds_read_b64_tr_b16 v[46:47], v7 offset:320
    ds_read_b64_tr_b16 v[48:49], v7 offset:512
    ds_read_b64_tr_b16 v[50:51], v7 offset:576
    ds_read_b64_tr_b16 v[52:53], v7 offset:768
    ds_read_b64_tr_b16 v[54:55], v7 offset:832
    buffer_load_dword v11, v11, s[44:47], s88 offen sc1
    s_waitcnt lgkmcnt(6)
    v_mfma_f32_16x16x32_bf16 v[56:59], v[24:27], v[40:43], 0
    ds_read_b128 v[24:27], v4 offset:21504
    v_mfma_f32_16x16x32_bf16 v[60:63], v[28:31], v[40:43], 0
    ds_read_b128 v[28:31], v4 offset:22528
    v_mfma_f32_16x16x32_bf16 v[12:15], v[40:43], v[40:43], 0
    s_waitcnt lgkmcnt(6)
    v_mfma_f32_16x16x32_bf16 v[56:59], v[32:35], v[44:47], v[56:59]
    ds_read_b128 v[32:35], v4 offset:23552
    v_mfma_f32_16x16x32_bf16 v[60:63], v[36:39], v[44:47], v[60:63]
    ds_read_b128 v[36:39], v4 offset:24576
    v_mfma_f32_16x16x32_bf16 v[12:15], v[44:47], v[44:47], v[12:15]
    s_waitcnt lgkmcnt(2)
    v_mfma_f32_16x16x32_bf16 v[56:59], v[24:27], v[48:51], v[56:59]
    buffer_store_dwordx4 v[16:19], v5, s[44:47], s76 offen sc1
    v_mfma_f32_16x16x32_bf16 v[60:63], v[28:31], v[48:51], v[60:63]
    v_mfma_f32_16x16x32_bf16 v[12:15], v[48:51], v[48:51], v[12:15]
    s_waitcnt lgkmcnt(0)
    v_mfma_f32_16x16x32_bf16 v[56:59], v[32:35], v[52:55], v[56:59]
    v_mov_b32 v45, 0
    v_mfma_f32_16x16x32_bf16 v[60:63], v[36:39], v[52:55], v[60:63]
    v_mov_b32 v46, 0
    v_mfma_f32_16x16x32_bf16 v[12:15], v[52:55], v[52:55], v[12:15]
    v_mov_b32 v32, 0x3f803f80
    v_mov_b32 v33, 0x3f803f80
    v_mov_b32 v34, 0x3f803f80
    v_mov_b32 v35, 0x3f803f80
    v_max3_f32 v24, v56, v57, v58
    s_nop 0
    v_max3_f32 v26, v60, v61, v62
    v_max3_f32 v24, v24, v59, v63
    v_max3_f32 v26, v26, v12, v13
    v_max_f32 v24, v24, v26
    v_mov_b32 v26, v24
    v_mov_b64 v[48:49], 0
    v_mov_b64 v[50:51], 0
    v_permlane32_swap_b32 v24, v26
    v_max_f32 v24, v24, v26
    v_mov_b32 v26, v24
    v_mov_b64 v[52:53], 0
    v_mov_b64 v[54:55], 0
    v_permlane16_swap_b32 v24, v26
    v_max_f32 v24, v24, v26
    v_mul_f32 v24, s84, v24
    v_pk_fma_f32 v[56:57], v[56:57], s[84:85], v[24:25] op_sel_hi:[1,1,0] neg_lo:[0,0,1] neg_hi:[0,0,1]
    v_pk_fma_f32 v[58:59], v[58:59], s[84:85], v[24:25] op_sel_hi:[1,1,0] neg_lo:[0,0,1] neg_hi:[0,0,1]
    v_pk_fma_f32 v[60:61], v[60:61], s[84:85], v[24:25] op_sel_hi:[1,1,0] neg_lo:[0,0,1] neg_hi:[0,0,1]
    v_pk_fma_f32 v[62:63], v[62:63], s[84:85], v[24:25] op_sel_hi:[1,1,0] neg_lo:[0,0,1] neg_hi:[0,0,1]
    v_pk_fma_f32 v[12:13], v[12:13], s[84:85], v[24:25] op_sel_hi:[1,1,0] neg_lo:[0,0,1] neg_hi:[0,0,1]
    v_exp_f32 v56, v56
    v_exp_f32 v57, v57
    v_exp_f32 v58, v58
    v_exp_f32 v59, v59
    v_exp_f32 v60, v60
    v_exp_f32 v61, v61
    v_exp_f32 v62, v62
    v_exp_f32 v63, v63
    v_cvt_pk_bf16_f32 v40, v56, v57
    v_cvt_pk_bf16_f32 v41, v58, v59
    v_cvt_pk_bf16_f32 v42, v60, v61
    v_cvt_pk_bf16_f32 v43, v62, v63
    v_exp_f32 v12, v12
    s_waitcnt vmcnt(5)
    v_mfma_f32_16x16x32_bf16 v[20:23], v[32:35], v[40:43], 0
    v_exp_f32 v13, v13
    v_mfma_f32_16x16x32_bf16 v[56:59], v[252:255], v[40:43], 0
    v_cvt_pk_bf16_f32 v44, v12, v13
    v_mfma_f32_16x16x32_bf16 v[60:63], v[248:251], v[40:43], 0
    v_cvt_pk_bf16_f32 v47, v12, v13
    v_mov_b64 v[36:37], 0
    v_mfma_f32_16x16x16_bf16 v[20:23], v[32:33], v[44:45], v[20:23]
    v_mov_b64 v[38:39], 0
    v_mfma_f32_16x16x16_bf16 v[56:59], v[18:19], v[44:45], v[56:59]
    v_mov_b64 v[40:41], 0
    v_mfma_f32_16x16x16_bf16 v[60:63], v[18:19], v[46:47], v[60:63]
    v_mov_b64 v[28:29], 0
    v_mov_b64 v[30:31], 0
    v_mov_b64 v[32:33], 0
    v_mov_b64 v[34:35], 0
    v_rcp_f32 v24, v20
    v_mov_b64 v[42:43], 0
    v_pk_mul_f32 v[56:57], v[56:57], v[24:25] op_sel_hi:[1,0]
    v_pk_mul_f32 v[58:59], v[58:59], v[24:25] op_sel_hi:[1,0]
    v_pk_mul_f32 v[60:61], v[60:61], v[24:25] op_sel_hi:[1,0]
    v_pk_mul_f32 v[62:63], v[62:63], v[24:25] op_sel_hi:[1,0]
    v_cvt_pk_bf16_f32 v16, v56, v57
    v_cvt_pk_bf16_f32 v17, v58, v59
    v_cvt_pk_bf16_f32 v18, v60, v61
    v_cvt_pk_bf16_f32 v19, v62, v63
    s_mov_b64 exec, s[94:95]
    ds_write_b128 v8, v[16:19]
    s_mov_b64 exec, -1
    v_mov_b64 v[44:45], 0
    v_mov_b64 v[46:47], 0
    v_mov_b64 v[56:57], 0
    v_mov_b64 v[58:59], 0
    v_mov_b64 v[60:61], 0
    v_mov_b64 v[62:63], 0
    v_mov_b32 v15, s59
    v_bfe_u32 v14, v4, 2, 8
    v_bfe_u32 v13, v4, 4, 2
    v_lshrrev_b32 v13, v13, 1
    s_waitcnt lgkmcnt(0)
    s_barrier
    ds_read_b128 v[20:23], v4 offset:29952
    ds_read_b128 v[24:27], v4 offset:30976
    s_add_u32 s76, s76, 4096
    s_add_u32 s92, s92, 16384
    s_cmp_ge_u32 s72, 32
    s_waitcnt lgkmcnt(1)
    v_smfmac_f32_16x16x64_bf16 v[28:31], v[20:23], a[0:7], v0
    s_waitcnt lgkmcnt(0)
    v_smfmac_f32_16x16x64_bf16 v[28:31], v[24:27], a[8:15], v0
    v_smfmac_f32_16x16x64_bf16 v[32:35], v[20:23], a[16:23], v0
    v_smfmac_f32_16x16x64_bf16 v[32:35], v[24:27], a[24:31], v0
    v_smfmac_f32_16x16x64_bf16 v[36:39], v[20:23], a[32:39], v0
    s_nop 4
    v_add_f32 v28, v28, v30
    v_add_f32 v29, v29, v31
    v_smfmac_f32_16x16x64_bf16 v[36:39], v[24:27], a[40:47], v0
    v_cvt_pk_bf16_f32 v28, v28, v29
    v_smfmac_f32_16x16x64_bf16 v[40:43], v[20:23], a[48:55], v0
    v_or_b32 v28, v13, v28
    v_add_f32 v32, v32, v34
    v_add_f32 v33, v33, v35
    v_smfmac_f32_16x16x64_bf16 v[40:43], v[24:27], a[56:63], v0
    buffer_store_dword v28, v14, s[44:47], s79 offen offset:0 sc1
    v_cvt_pk_bf16_f32 v32, v32, v33
    v_smfmac_f32_16x16x64_bf16 v[44:47], v[20:23], a[64:71], v0
    v_or_b32 v32, v13, v32
    v_add_f32 v36, v36, v38
    v_add_f32 v37, v37, v39
    v_smfmac_f32_16x16x64_bf16 v[44:47], v[24:27], a[72:79], v0
    buffer_store_dword v32, v14, s[44:47], s79 offen offset:256 sc1
    v_cvt_pk_bf16_f32 v36, v36, v37
    v_smfmac_f32_16x16x64_bf16 v[48:51], v[20:23], a[80:87], v0
    v_or_b32 v36, v13, v36
    v_add_f32 v40, v40, v42
    v_add_f32 v41, v41, v43
    v_smfmac_f32_16x16x64_bf16 v[48:51], v[24:27], a[88:95], v0
    buffer_store_dword v36, v14, s[44:47], s79 offen offset:512 sc1
    v_cvt_pk_bf16_f32 v40, v40, v41
    v_smfmac_f32_16x16x64_bf16 v[52:55], v[20:23], a[96:103], v0
    v_or_b32 v40, v13, v40
    v_add_f32 v44, v44, v46
    v_add_f32 v45, v45, v47
    v_smfmac_f32_16x16x64_bf16 v[52:55], v[24:27], a[104:111], v0
    buffer_store_dword v40, v14, s[44:47], s79 offen offset:768 sc1
    v_cvt_pk_bf16_f32 v44, v44, v45
    v_smfmac_f32_16x16x64_bf16 v[56:59], v[20:23], a[112:119], v0
    v_or_b32 v44, v13, v44
    v_add_f32 v48, v48, v50
    v_add_f32 v49, v49, v51
    v_smfmac_f32_16x16x64_bf16 v[56:59], v[24:27], a[120:127], v0
    buffer_store_dword v44, v14, s[44:47], s79 offen offset:1024 sc1
    v_cvt_pk_bf16_f32 v48, v48, v49
    v_smfmac_f32_16x16x64_bf16 v[60:63], v[20:23], a[128:135], v0
    v_or_b32 v48, v13, v48
    v_add_f32 v52, v52, v54
    v_add_f32 v53, v53, v55
    v_smfmac_f32_16x16x64_bf16 v[60:63], v[24:27], a[136:143], v0
    buffer_store_dword v48, v14, s[44:47], s79 offen offset:1280 sc1
    v_cvt_pk_bf16_f32 v52, v52, v53
    v_or_b32 v52, v13, v52
    v_add_f32 v56, v56, v58
    v_add_f32 v57, v57, v59
    buffer_store_dword v52, v14, s[44:47], s79 offen offset:1536 sc1
    v_cvt_pk_bf16_f32 v56, v56, v57
    v_or_b32 v56, v13, v56
    v_add_f32 v60, v60, v62
    v_add_f32 v61, v61, v63
    buffer_store_dword v56, v14, s[44:47], s79 offen offset:1792 sc1
    v_cvt_pk_bf16_f32 v60, v60, v61
    v_or_b32 v60, v13, v60
    buffer_store_dword v60, v14, s[44:47], s79 offen offset:2048 sc1
    s_cbranch_scc0 CH_safe1_RLOAD
    s_cmp_ge_u32 s57, 2
    s_cbranch_scc1 CH_safe1_IDLE
    s_nop 3
    s_nop 3
    s_nop 3
    s_nop 3
    s_nop 3
    s_nop 3
    s_nop 3
    s_nop 3
    s_nop 3
    s_nop 3
    s_nop 3
    s_nop 3
CH_safe1_RLOAD:
    buffer_load_dwordx4 v[32:35], v9, s[44:47], s80 offen sc1
    buffer_load_dwordx4 v[36:39], v9, s[44:47], s81 offen sc1
    buffer_load_dwordx4 v[248:251], v9, s[44:47], s82 offen sc1
    buffer_load_dwordx4 v[252:255], v9, s[44:47], s83 offen sc1
    ds_read_b128 v[20:23], v4 offset:0
    v_mov_b64 v[40:41], 0
    v_mov_b64 v[42:43], 0
    v_mov_b64 v[44:45], 0
    v_mov_b64 v[46:47], 0
    v_mov_b64 v[48:49], 0
    v_mov_b64 v[50:51], 0
    v_mov_b64 v[52:53], 0
    v_mov_b64 v[54:55], 0
    v_mov_b64 v[56:57], 0
    v_mov_b64 v[58:59], 0
    v_mov_b64 v[60:61], 0
    v_mov_b64 v[62:63], 0
    s_waitcnt lgkmcnt(0)
CH_safe1_RSUM:
    s_waitcnt vmcnt(3)
    v_mfma_f32_16x16x32_bf16 v[24:27], v[32:35], v[20:23], 0
    s_waitcnt vmcnt(2)
    v_mfma_f32_16x16x32_bf16 v[24:27], v[36:39], v[20:23], v[24:27]
    v_and_b32 v28, v32, v36
    s_waitcnt vmcnt(1)
    v_mfma_f32_16x16x32_bf16 v[24:27], v[248:251], v[20:23], v[24:27]
    v_and_b32 v28, v28, v248
    s_waitcnt vmcnt(0)
    v_and_b32 v28, v28, v252
    v_and_b32 v28, 1, v28
    v_cmp_ne_u32 vcc, 1, v28
    v_mfma_f32_16x16x32_bf16 v[24:27], v[252:255], v[20:23], v[24:27]
CH_safe1_RCHK:
    s_cbranch_vccnz CH_safe1_RRETRY
    buffer_store_byte v15, off, s[44:47], s52 sc1
    s_add_u32 s70, s70, 1
    s_mov_b32 s53, s59
    s_add_u32 s59, s59, 0x01010101
    s_sub_u32 s71, s73, 131072
    s_add_u32 s93, s71, 4096
    s_add_u32 s74, s71, 8192
    s_mov_b32 s87, 0
    v_permlane32_swap_b32 v24, v26
    v_permlane32_swap_b32 v25, v27
    v_pk_add_f32 v[24:25], v[24:25], v[26:27]
    v_cvt_pk_bf16_f32 v28, v24, v25
    v_min_u32 v28, -2, v28
    buffer_store_dword v28, v10, s[44:47], s73 offen sc1
    s_add_u32 s73, s73, 9216
    s_branch CH_safe0_ENTER
CH_safe0_IDLE:
    v_mov_b64 v[40:41], 0
    v_mov_b64 v[42:43], 0
    v_mov_b64 v[44:45], 0
    v_mov_b64 v[46:47], 0
    v_mov_b64 v[48:49], 0
    v_mov_b64 v[50:51], 0
    v_mov_b64 v[52:53], 0
    v_mov_b64 v[54:55], 0
    v_mov_b64 v[56:57], 0
    v_mov_b64 v[58:59], 0
    v_mov_b64 v[60:61], 0
    v_mov_b64 v[62:63], 0
    s_add_u32 s70, s70, 1
    s_mov_b32 s53, s59
    s_add_u32 s59, s59, 0x01010101
    s_sub_u32 s71, s73, 131072
    s_add_u32 s93, s71, 4096
    s_add_u32 s74, s71, 8192
    s_add_u32 s73, s73, 9216
    s_mov_b32 s87, 0
    s_cmp_eq_u32 s57, 2
    s_cbranch_scc0 CH_safe0_KVCHK
    s_waitcnt vmcnt(0)
    s_branch CH_safe1_ENTER
CH_safe0_KVCHK:
    s_waitcnt vmcnt(9)
CH_safe0_KVCHK2:
    v_readfirstlane_b32 s99, v11
    s_min_u32 s98, s70, 62
    s_add_u32 s98, s98, 2
    s_cmp_ge_u32 s99, s98
    s_cbranch_scc1 CH_safe0_PUB0
    buffer_load_dword v11, off, s[44:47], s77 sc1
    s_add_u32 s100, s100, 1
    s_cmp_lt_u32 s100, 262144
    s_cbranch_scc1 spin_ok_27
    s_mov_b32 s98, 6
    s_branch FAIL
spin_ok_27:
    s_waitcnt vmcnt(0)
    s_branch CH_safe0_KVCHK2
CH_safe0_PUB0:
    s_mov_b64 exec, 255
    s_nop 15
    s_nop 15
    s_nop 15
    s_nop 15
    s_nop 15
CH_safe0_PUB0L:
    buffer_load_dword v1, v14, s[64:67], 0 offen sc1
    s_nop 1
    s_nop 1
    v_cmp_ne_u32 vcc, s53, v1
    s_cbranch_vccz CH_safe1_ENTER3
    buffer_load_dword v1, v14, s[64:67], 0 offen sc1
    s_nop 1
    s_nop 1
    v_cmp_ne_u32 vcc, s53, v1
    s_cbranch_vccz CH_safe1_ENTER3
    buffer_load_dword v1, v14, s[64:67], 0 offen sc1
    s_nop 1
    s_nop 1
    v_cmp_ne_u32 vcc, s53, v1
    s_cbranch_vccz CH_safe1_ENTER3
    s_add_u32 s100, s100, 1
    s_cmp_lt_u32 s100, 262144
    s_cbranch_scc1 CH_safe0_PUB0L
    s_branch CH_safe0_HFAIL
CH_safe0_HFAIL:
    s_mov_b32 s98, 5
    s_branch FAIL
CH_safe0_RRETRY:
    buffer_load_dwordx4 v[32:35], v9, s[44:47], s80 offen sc1
    buffer_load_dwordx4 v[36:39], v9, s[44:47], s81 offen sc1
    buffer_load_dwordx4 v[248:251], v9, s[44:47], s82 offen sc1
    buffer_load_dwordx4 v[252:255], v9, s[44:47], s83 offen sc1
    s_add_u32 s100, s100, 1
    s_cmp_lt_u32 s100, 262144
    s_cbranch_scc1 spin_ok_28
    s_mov_b32 s98, 4
    s_branch FAIL
spin_ok_28:
    s_branch CH_safe0_RSUM
CH_safe0_REDO:
    s_cmp_eq_u32 s87, 1
    s_cbranch_scc1 CH_safe0_COMBOK
    s_mov_b32 s87, 1
    s_nop 7
    s_waitcnt lgkmcnt(0)
CH_safe0_REDOP:
    v_mov_b32 v40, 0
    buffer_load_dwordx4 v[248:251], v4, s[44:47], s71 offen offset:0 sc1
    buffer_load_dwordx4 v[16:19], v4, s[44:47], s71 offen offset:1024 sc1
    buffer_load_dwordx4 v[20:23], v4, s[44:47], s71 offen offset:2048 sc1
    buffer_load_dwordx4 v[12:15], v4, s[44:47], s71 offen offset:3072 sc1
    buffer_load_dwordx4 v[252:255], v4, s[44:47], s93 offen offset:0 sc1
    s_waitcnt vmcnt(0)
    v_max3_u32 v40, v40, v248, v249
    v_max3_u32 v40, v40, v250, v251
    v_max3_u32 v40, v40, v16, v17
    v_max3_u32 v40, v40, v18, v19
    v_max3_u32 v40, v40, v20, v21
    v_max3_u32 v40, v40, v22, v23
    v_max3_u32 v40, v40, v12, v13
    v_max3_u32 v40, v40, v14, v15
    v_max3_u32 v40, v40, v252, v253
    v_max3_u32 v40, v40, v254, v255
    buffer_load_dwordx4 v[248:251], v4, s[44:47], s93 offen offset:1024 sc1
    buffer_load_dwordx4 v[16:19], v4, s[44:47], s93 offen offset:2048 sc1
    buffer_load_dwordx4 v[20:23], v4, s[44:47], s93 offen offset:3072 sc1
    buffer_load_dwordx4 v[12:15], v4, s[44:47], s74 offen offset:0 sc1
    s_waitcnt vmcnt(0)
    v_max3_u32 v40, v40, v248, v249
    v_max3_u32 v40, v40, v250, v251
    v_max3_u32 v40, v40, v16, v17
    v_max3_u32 v40, v40, v18, v19
    v_max3_u32 v40, v40, v20, v21
    v_max3_u32 v40, v40, v22, v23
    v_max3_u32 v40, v40, v12, v13
    v_max3_u32 v40, v40, v14, v15
    s_add_u32 s100, s100, 1
    s_cmp_lt_u32 s100, 262144
    s_cbranch_scc1 spin_ok_29
    s_mov_b32 s98, 3
    s_branch FAIL
spin_ok_29:
    v_cmp_eq_u32 vcc, -1, v40
    s_cbranch_vccnz CH_safe0_REDOP
    v_mov_b64 v[40:41], 0
    v_mov_b64 v[42:43], 0
    v_mov_b64 v[44:45], 0
    v_mov_b64 v[46:47], 0
    v_mov_b64 v[48:49], 0
    v_mov_b64 v[50:51], 0
    v_mov_b64 v[52:53], 0
    v_mov_b64 v[54:55], 0
    v_mov_b64 v[56:57], 0
    v_mov_b64 v[58:59], 0
    v_mov_b64 v[60:61], 0
    v_mov_b64 v[62:63], 0
    buffer_load_dwordx4 v[248:251], v4, s[44:47], s71 offen offset:0 sc1
    ds_read_b128 v[24:27], v2 offset:0
    ds_read_b128 v[28:31], v2 offset:1024
    ds_read_b128 v[32:35], v5 offset:1024
    ds_read_b128 v[36:39], v5 offset:5120
    buffer_load_dwordx4 v[16:19], v4, s[44:47], s71 offen offset:1024 sc1
    s_add_u32 s91, s92, 4096
    buffer_load_dwordx4 v[20:23], v4, s[44:47], s71 offen offset:2048 sc1
    s_waitcnt vmcnt(2)
    v_smfmac_f32_16x16x64_bf16 v[56:59], v[248:251], v[240:247], v0
    buffer_load_dwordx4 v[12:15], v4, s[44:47], s71 offen offset:3072 sc1
    v_smfmac_f32_16x16x64_bf16 v[40:43], v[248:251], a[144:151], v0
    v_smfmac_f32_16x16x64_bf16 v[44:47], v[248:251], a[152:159], v0
    s_waitcnt lgkmcnt(0)
    v_smfmac_f32_16x16x64_bf16 v[60:63], v[248:251], v[32:39], v0
    ds_read_b128 v[32:35], v2 offset:2048
    v_smfmac_f32_16x16x64_bf16 v[48:51], v[248:251], v[96:103], v0
    ds_read_b128 v[36:39], v2 offset:3072
    buffer_load_dwordx4 v[252:255], v4, s[44:47], s93 offen offset:0 sc1
    v_smfmac_f32_16x16x64_bf16 v[52:55], v[248:251], v[104:111], v0
    buffer_load_dwordx4 v[248:251], v4, s[44:47], s93 offen offset:1024 sc1
    s_waitcnt vmcnt(4)
    v_smfmac_f32_16x16x64_bf16 v[56:59], v[16:19], v[24:31], v0
    ds_read_b128 v[24:27], v2 offset:16384
    v_smfmac_f32_16x16x64_bf16 v[40:43], v[16:19], a[160:167], v0
    ds_read_b128 v[28:31], v2 offset:17408
    v_smfmac_f32_16x16x64_bf16 v[44:47], v[16:19], a[168:175], v0
    s_waitcnt lgkmcnt(2)
    v_smfmac_f32_16x16x64_bf16 v[60:63], v[16:19], v[32:39], v0
    ds_read_b128 v[32:35], v2 offset:18432
    v_smfmac_f32_16x16x64_bf16 v[48:51], v[16:19], v[112:119], v0
    ds_read_b128 v[36:39], v2 offset:19456
    v_smfmac_f32_16x16x64_bf16 v[52:55], v[16:19], v[120:127], v0
    buffer_load_dwordx4 v[16:19], v4, s[44:47], s93 offen offset:2048 sc1
    s_waitcnt vmcnt(4) lgkmcnt(2)
    v_smfmac_f32_16x16x64_bf16 v[56:59], v[20:23], v[24:31], v0
    ds_read_b128 v[24:27], v2 offset:32768
    v_smfmac_f32_16x16x64_bf16 v[40:43], v[20:23], a[176:183], v0
    ds_read_b128 v[28:31], v2 offset:33792
    v_smfmac_f32_16x16x64_bf16 v[44:47], v[20:23], a[184:191], v0
    s_waitcnt lgkmcnt(2)
    v_smfmac_f32_16x16x64_bf16 v[60:63], v[20:23], v[32:39], v0
    ds_read_b128 v[32:35], v2 offset:34816
    v_smfmac_f32_16x16x64_bf16 v[48:51], v[20:23], v[128:135], v0
    ds_read_b128 v[36:39], v2 offset:35840
    v_smfmac_f32_16x16x64_bf16 v[52:55], v[20:23], v[136:143], v0
    buffer_load_dwordx4 v[20:23], v4, s[44:47], s93 offen offset:3072 sc1
    s_waitcnt vmcnt(4) lgkmcnt(2)
    v_smfmac_f32_16x16x64_bf16 v[56:59], v[12:15], v[24:31], v0
    ds_read_b128 v[24:27], v2 offset:49152
    v_smfmac_f32_16x16x64_bf16 v[40:43], v[12:15], a[192:199], v0
    ds_read_b128 v[28:31], v2 offset:50176
    v_smfmac_f32_16x16x64_bf16 v[44:47], v[12:15], a[200:207], v0
    s_waitcnt lgkmcnt(2)
    v_smfmac_f32_16x16x64_bf16 v[60:63], v[12:15], v[32:39], v0
    ds_read_b128 v[32:35], v2 offset:51200
    v_smfmac_f32_16x16x64_bf16 v[48:51], v[12:15], v[144:151], v0
    ds_read_b128 v[36:39], v2 offset:52224
    v_smfmac_f32_16x16x64_bf16 v[52:55], v[12:15], v[152:159], v0
    buffer_load_dwordx4 v[12:15], v4, s[44:47], s74 offen offset:0 sc1
    s_waitcnt vmcnt(4) lgkmcnt(2)
    v_smfmac_f32_16x16x64_bf16 v[56:59], v[252:255], v[24:31], v0
    ds_read_b128 v[24:27], v3 offset:0
    v_smfmac_f32_16x16x64_bf16 v[40:43], v[252:255], a[208:215], v0
    ds_read_b128 v[28:31], v3 offset:1024
    v_smfmac_f32_16x16x64_bf16 v[44:47], v[252:255], a[216:223], v0
    s_waitcnt lgkmcnt(2)
    v_smfmac_f32_16x16x64_bf16 v[60:63], v[252:255], v[32:39], v0
    ds_read_b128 v[32:35], v3 offset:2048
    v_smfmac_f32_16x16x64_bf16 v[48:51], v[252:255], v[160:167], v0
    ds_read_b128 v[36:39], v3 offset:3072
    v_smfmac_f32_16x16x64_bf16 v[52:55], v[252:255], v[168:175], v0
    buffer_load_dwordx4 v[252:255], v5, s[44:47], s92 offen sc1
    s_waitcnt vmcnt(4) lgkmcnt(2)
    v_smfmac_f32_16x16x64_bf16 v[56:59], v[248:251], v[24:31], v0
    ds_read_b128 v[24:27], v3 offset:16384
    v_smfmac_f32_16x16x64_bf16 v[40:43], v[248:251], a[224:231], v0
    ds_read_b128 v[28:31], v3 offset:17408
    v_smfmac_f32_16x16x64_bf16 v[44:47], v[248:251], a[232:239], v0
    s_waitcnt lgkmcnt(2)
    v_smfmac_f32_16x16x64_bf16 v[60:63], v[248:251], v[32:39], v0
    ds_read_b128 v[32:35], v3 offset:18432
    v_smfmac_f32_16x16x64_bf16 v[48:51], v[248:251], v[176:183], v0
    ds_read_b128 v[36:39], v3 offset:19456
    v_smfmac_f32_16x16x64_bf16 v[52:55], v[248:251], v[184:191], v0
    buffer_load_dwordx4 v[248:251], v5, s[44:47], s91 offen sc1
    s_waitcnt vmcnt(4) lgkmcnt(2)
    v_smfmac_f32_16x16x64_bf16 v[56:59], v[16:19], v[24:31], v0
    ds_read_b128 v[24:27], v3 offset:32768
    v_smfmac_f32_16x16x64_bf16 v[40:43], v[16:19], a[240:247], v0
    ds_read_b128 v[28:31], v3 offset:33792
    v_smfmac_f32_16x16x64_bf16 v[44:47], v[16:19], a[248:255], v0
    s_waitcnt lgkmcnt(2)
    v_smfmac_f32_16x16x64_bf16 v[60:63], v[16:19], v[32:39], v0
    ds_read_b128 v[32:35], v3 offset:34816
    v_smfmac_f32_16x16x64_bf16 v[48:51], v[16:19], v[192:199], v0
    ds_read_b128 v[36:39], v3 offset:35840
    v_smfmac_f32_16x16x64_bf16 v[52:55], v[16:19], v[200:207], v0
    s_waitcnt vmcnt(3) lgkmcnt(2)
    v_smfmac_f32_16x16x64_bf16 v[56:59], v[20:23], v[24:31], v0
    ds_read_b128 v[24:27], v3 offset:49152
    v_smfmac_f32_16x16x64_bf16 v[40:43], v[20:23], v[64:71], v0
    ds_read_b128 v[28:31], v3 offset:50176
    v_smfmac_f32_16x16x64_bf16 v[44:47], v[20:23], v[72:79], v0
    s_waitcnt lgkmcnt(2)
    v_smfmac_f32_16x16x64_bf16 v[60:63], v[20:23], v[32:39], v0
    ds_read_b128 v[32:35], v3 offset:51200
    v_smfmac_f32_16x16x64_bf16 v[48:51], v[20:23], v[208:215], v0
    ds_read_b128 v[36:39], v3 offset:52224
    v_smfmac_f32_16x16x64_bf16 v[52:55], v[20:23], v[216:223], v0
    s_waitcnt vmcnt(2) lgkmcnt(2)
    v_smfmac_f32_16x16x64_bf16 v[48:51], v[12:15], v[224:231], v0
    v_smfmac_f32_16x16x64_bf16 v[40:43], v[12:15], v[80:87], v0
    v_smfmac_f32_16x16x64_bf16 v[56:59], v[12:15], v[24:31], v0
    ds_read_b128 v[24:27], v4 offset:9216
    ds_read_b128 v[28:31], v4 offset:10240
    v_smfmac_f32_16x16x64_bf16 v[52:55], v[12:15], v[232:239], v0
    s_waitcnt lgkmcnt(2)
    v_smfmac_f32_16x16x64_bf16 v[44:47], v[12:15], v[88:95], v0
    s_waitcnt vmcnt(0)
    s_nop 7
    s_branch CH_safe0_COMB
CH_safe1_IDLE:
    v_mov_b64 v[40:41], 0
    v_mov_b64 v[42:43], 0
    v_mov_b64 v[44:45], 0
    v_mov_b64 v[46:47], 0
    v_mov_b64 v[48:49], 0
    v_mov_b64 v[50:51], 0
    v_mov_b64 v[52:53], 0
    v_mov_b64 v[54:55], 0
    v_mov_b64 v[56:57], 0
    v_mov_b64 v[58:59], 0
    v_mov_b64 v[60:61], 0
    v_mov_b64 v[62:63], 0
    s_add_u32 s70, s70, 1
    s_mov_b32 s53, s59
    s_add_u32 s59, s59, 0x01010101
    s_sub_u32 s71, s73, 131072
    s_add_u32 s93, s71, 4096
    s_add_u32 s74, s71, 8192
    s_add_u32 s73, s73, 9216
    s_mov_b32 s87, 0
    s_cmp_eq_u32 s57, 2
    s_cbranch_scc0 CH_safe1_KVCHK
    s_waitcnt vmcnt(0)
    s_branch CH_safe0_ENTER
CH_safe1_KVCHK:
    s_waitcnt vmcnt(9)
CH_safe1_KVCHK2:
    v_readfirstlane_b32 s99, v11
    s_min_u32 s98, s70, 62
    s_add_u32 s98, s98, 2
    s_cmp_ge_u32 s99, s98
    s_cbranch_scc1 CH_safe1_PUB0
    buffer_load_dword v11, off, s[44:47], s77 sc1
    s_add_u32 s100, s100, 1
    s_cmp_lt_u32 s100, 262144
    s_cbranch_scc1 spin_ok_30
    s_mov_b32 s98, 6
    s_branch FAIL
spin_ok_30:
    s_waitcnt vmcnt(0)
    s_branch CH_safe1_KVCHK2
CH_safe1_PUB0:
    s_mov_b64 exec, 255
    s_nop 15
    s_nop 15
    s_nop 15
    s_nop 15
    s_nop 15
CH_safe1_PUB0L:
    buffer_load_dword v1, v14, s[64:67], 0 offen sc1
    s_nop 1
    s_nop 1
    v_cmp_ne_u32 vcc, s53, v1
    s_cbranch_vccz CH_safe0_ENTER3
    buffer_load_dword v1, v14, s[64:67], 0 offen sc1
    s_nop 1
    s_nop 1
    v_cmp_ne_u32 vcc, s53, v1
    s_cbranch_vccz CH_safe0_ENTER3
    buffer_load_dword v1, v14, s[64:67], 0 offen sc1
    s_nop 1
    s_nop 1
    v_cmp_ne_u32 vcc, s53, v1
    s_cbranch_vccz CH_safe0_ENTER3
    s_add_u32 s100, s100, 1
    s_cmp_lt_u32 s100, 262144
    s_cbranch_scc1 CH_safe1_PUB0L
    s_branch CH_safe1_HFAIL
CH_safe1_HFAIL:
    s_mov_b32 s98, 5
    s_branch FAIL
CH_safe1_RRETRY:
    buffer_load_dwordx4 v[32:35], v9, s[44:47], s80 offen sc1
    buffer_load_dwordx4 v[36:39], v9, s[44:47], s81 offen sc1
    buffer_load_dwordx4 v[248:251], v9, s[44:47], s82 offen sc1
    buffer_load_dwordx4 v[252:255], v9, s[44:47], s83 offen sc1
    s_add_u32 s100, s100, 1
    s_cmp_lt_u32 s100, 262144
    s_cbranch_scc1 spin_ok_31
    s_mov_b32 s98, 4
    s_branch FAIL
spin_ok_31:
    s_branch CH_safe1_RSUM
CH_safe1_REDO:
    s_cmp_eq_u32 s87, 1
    s_cbranch_scc1 CH_safe1_COMBOK
    s_mov_b32 s87, 1
    s_nop 7
    s_waitcnt lgkmcnt(0)
CH_safe1_REDOP:
    v_mov_b32 v40, 0
    buffer_load_dwordx4 v[248:251], v4, s[44:47], s71 offen offset:0 sc1
    buffer_load_dwordx4 v[16:19], v4, s[44:47], s71 offen offset:1024 sc1
    buffer_load_dwordx4 v[20:23], v4, s[44:47], s71 offen offset:2048 sc1
    buffer_load_dwordx4 v[12:15], v4, s[44:47], s71 offen offset:3072 sc1
    buffer_load_dwordx4 v[252:255], v4, s[44:47], s93 offen offset:0 sc1
    s_waitcnt vmcnt(0)
    v_max3_u32 v40, v40, v248, v249
    v_max3_u32 v40, v40, v250, v251
    v_max3_u32 v40, v40, v16, v17
    v_max3_u32 v40, v40, v18, v19
    v_max3_u32 v40, v40, v20, v21
    v_max3_u32 v40, v40, v22, v23
    v_max3_u32 v40, v40, v12, v13
    v_max3_u32 v40, v40, v14, v15
    v_max3_u32 v40, v40, v252, v253
    v_max3_u32 v40, v40, v254, v255
    buffer_load_dwordx4 v[248:251], v4, s[44:47], s93 offen offset:1024 sc1
    buffer_load_dwordx4 v[16:19], v4, s[44:47], s93 offen offset:2048 sc1
    buffer_load_dwordx4 v[20:23], v4, s[44:47], s93 offen offset:3072 sc1
    buffer_load_dwordx4 v[12:15], v4, s[44:47], s74 offen offset:0 sc1
    s_waitcnt vmcnt(0)
    v_max3_u32 v40, v40, v248, v249
    v_max3_u32 v40, v40, v250, v251
    v_max3_u32 v40, v40, v16, v17
    v_max3_u32 v40, v40, v18, v19
    v_max3_u32 v40, v40, v20, v21
    v_max3_u32 v40, v40, v22, v23
    v_max3_u32 v40, v40, v12, v13
    v_max3_u32 v40, v40, v14, v15
    s_add_u32 s100, s100, 1
    s_cmp_lt_u32 s100, 262144
    s_cbranch_scc1 spin_ok_32
    s_mov_b32 s98, 3
    s_branch FAIL
spin_ok_32:
    v_cmp_eq_u32 vcc, -1, v40
    s_cbranch_vccnz CH_safe1_REDOP
    v_mov_b64 v[40:41], 0
    v_mov_b64 v[42:43], 0
    v_mov_b64 v[44:45], 0
    v_mov_b64 v[46:47], 0
    v_mov_b64 v[48:49], 0
    v_mov_b64 v[50:51], 0
    v_mov_b64 v[52:53], 0
    v_mov_b64 v[54:55], 0
    v_mov_b64 v[56:57], 0
    v_mov_b64 v[58:59], 0
    v_mov_b64 v[60:61], 0
    v_mov_b64 v[62:63], 0
    buffer_load_dwordx4 v[248:251], v4, s[44:47], s71 offen offset:0 sc1
    ds_read_b128 v[24:27], v2 offset:0
    ds_read_b128 v[28:31], v2 offset:1024
    ds_read_b128 v[32:35], v5 offset:1024
    ds_read_b128 v[36:39], v5 offset:5120
    buffer_load_dwordx4 v[16:19], v4, s[44:47], s71 offen offset:1024 sc1
    s_add_u32 s91, s92, 4096
    buffer_load_dwordx4 v[20:23], v4, s[44:47], s71 offen offset:2048 sc1
    s_waitcnt vmcnt(2)
    v_smfmac_f32_16x16x64_bf16 v[56:59], v[248:251], v[240:247], v0
    buffer_load_dwordx4 v[12:15], v4, s[44:47], s71 offen offset:3072 sc1
    v_smfmac_f32_16x16x64_bf16 v[40:43], v[248:251], a[144:151], v0
    v_smfmac_f32_16x16x64_bf16 v[44:47], v[248:251], a[152:159], v0
    s_waitcnt lgkmcnt(0)
    v_smfmac_f32_16x16x64_bf16 v[60:63], v[248:251], v[32:39], v0
    ds_read_b128 v[32:35], v2 offset:2048
    v_smfmac_f32_16x16x64_bf16 v[48:51], v[248:251], v[96:103], v0
    ds_read_b128 v[36:39], v2 offset:3072
    buffer_load_dwordx4 v[252:255], v4, s[44:47], s93 offen offset:0 sc1
    v_smfmac_f32_16x16x64_bf16 v[52:55], v[248:251], v[104:111], v0
    buffer_load_dwordx4 v[248:251], v4, s[44:47], s93 offen offset:1024 sc1
    s_waitcnt vmcnt(4)
    v_smfmac_f32_16x16x64_bf16 v[56:59], v[16:19], v[24:31], v0
    ds_read_b128 v[24:27], v2 offset:16384
    v_smfmac_f32_16x16x64_bf16 v[40:43], v[16:19], a[160:167], v0
    ds_read_b128 v[28:31], v2 offset:17408
    v_smfmac_f32_16x16x64_bf16 v[44:47], v[16:19], a[168:175], v0
    s_waitcnt lgkmcnt(2)
    v_smfmac_f32_16x16x64_bf16 v[60:63], v[16:19], v[32:39], v0
    ds_read_b128 v[32:35], v2 offset:18432
    v_smfmac_f32_16x16x64_bf16 v[48:51], v[16:19], v[112:119], v0
    ds_read_b128 v[36:39], v2 offset:19456
    v_smfmac_f32_16x16x64_bf16 v[52:55], v[16:19], v[120:127], v0
    buffer_load_dwordx4 v[16:19], v4, s[44:47], s93 offen offset:2048 sc1
    s_waitcnt vmcnt(4) lgkmcnt(2)
    v_smfmac_f32_16x16x64_bf16 v[56:59], v[20:23], v[24:31], v0
    ds_read_b128 v[24:27], v2 offset:32768
    v_smfmac_f32_16x16x64_bf16 v[40:43], v[20:23], a[176:183], v0
    ds_read_b128 v[28:31], v2 offset:33792
    v_smfmac_f32_16x16x64_bf16 v[44:47], v[20:23], a[184:191], v0
    s_waitcnt lgkmcnt(2)
    v_smfmac_f32_16x16x64_bf16 v[60:63], v[20:23], v[32:39], v0
    ds_read_b128 v[32:35], v2 offset:34816
    v_smfmac_f32_16x16x64_bf16 v[48:51], v[20:23], v[128:135], v0
    ds_read_b128 v[36:39], v2 offset:35840
    v_smfmac_f32_16x16x64_bf16 v[52:55], v[20:23], v[136:143], v0
    buffer_load_dwordx4 v[20:23], v4, s[44:47], s93 offen offset:3072 sc1
    s_waitcnt vmcnt(4) lgkmcnt(2)
    v_smfmac_f32_16x16x64_bf16 v[56:59], v[12:15], v[24:31], v0
    ds_read_b128 v[24:27], v2 offset:49152
    v_smfmac_f32_16x16x64_bf16 v[40:43], v[12:15], a[192:199], v0
    ds_read_b128 v[28:31], v2 offset:50176
    v_smfmac_f32_16x16x64_bf16 v[44:47], v[12:15], a[200:207], v0
    s_waitcnt lgkmcnt(2)
    v_smfmac_f32_16x16x64_bf16 v[60:63], v[12:15], v[32:39], v0
    ds_read_b128 v[32:35], v2 offset:51200
    v_smfmac_f32_16x16x64_bf16 v[48:51], v[12:15], v[144:151], v0
    ds_read_b128 v[36:39], v2 offset:52224
    v_smfmac_f32_16x16x64_bf16 v[52:55], v[12:15], v[152:159], v0
    buffer_load_dwordx4 v[12:15], v4, s[44:47], s74 offen offset:0 sc1
    s_waitcnt vmcnt(4) lgkmcnt(2)
    v_smfmac_f32_16x16x64_bf16 v[56:59], v[252:255], v[24:31], v0
    ds_read_b128 v[24:27], v3 offset:0
    v_smfmac_f32_16x16x64_bf16 v[40:43], v[252:255], a[208:215], v0
    ds_read_b128 v[28:31], v3 offset:1024
    v_smfmac_f32_16x16x64_bf16 v[44:47], v[252:255], a[216:223], v0
    s_waitcnt lgkmcnt(2)
    v_smfmac_f32_16x16x64_bf16 v[60:63], v[252:255], v[32:39], v0
    ds_read_b128 v[32:35], v3 offset:2048
    v_smfmac_f32_16x16x64_bf16 v[48:51], v[252:255], v[160:167], v0
    ds_read_b128 v[36:39], v3 offset:3072
    v_smfmac_f32_16x16x64_bf16 v[52:55], v[252:255], v[168:175], v0
    buffer_load_dwordx4 v[252:255], v5, s[44:47], s92 offen sc1
    s_waitcnt vmcnt(4) lgkmcnt(2)
    v_smfmac_f32_16x16x64_bf16 v[56:59], v[248:251], v[24:31], v0
    ds_read_b128 v[24:27], v3 offset:16384
    v_smfmac_f32_16x16x64_bf16 v[40:43], v[248:251], a[224:231], v0
    ds_read_b128 v[28:31], v3 offset:17408
    v_smfmac_f32_16x16x64_bf16 v[44:47], v[248:251], a[232:239], v0
    s_waitcnt lgkmcnt(2)
    v_smfmac_f32_16x16x64_bf16 v[60:63], v[248:251], v[32:39], v0
    ds_read_b128 v[32:35], v3 offset:18432
    v_smfmac_f32_16x16x64_bf16 v[48:51], v[248:251], v[176:183], v0
    ds_read_b128 v[36:39], v3 offset:19456
    v_smfmac_f32_16x16x64_bf16 v[52:55], v[248:251], v[184:191], v0
    buffer_load_dwordx4 v[248:251], v5, s[44:47], s91 offen sc1
    s_waitcnt vmcnt(4) lgkmcnt(2)
    v_smfmac_f32_16x16x64_bf16 v[56:59], v[16:19], v[24:31], v0
    ds_read_b128 v[24:27], v3 offset:32768
    v_smfmac_f32_16x16x64_bf16 v[40:43], v[16:19], a[240:247], v0
    ds_read_b128 v[28:31], v3 offset:33792
    v_smfmac_f32_16x16x64_bf16 v[44:47], v[16:19], a[248:255], v0
    s_waitcnt lgkmcnt(2)
    v_smfmac_f32_16x16x64_bf16 v[60:63], v[16:19], v[32:39], v0
    ds_read_b128 v[32:35], v3 offset:34816
    v_smfmac_f32_16x16x64_bf16 v[48:51], v[16:19], v[192:199], v0
    ds_read_b128 v[36:39], v3 offset:35840
    v_smfmac_f32_16x16x64_bf16 v[52:55], v[16:19], v[200:207], v0
    s_waitcnt vmcnt(3) lgkmcnt(2)
    v_smfmac_f32_16x16x64_bf16 v[56:59], v[20:23], v[24:31], v0
    ds_read_b128 v[24:27], v3 offset:49152
    v_smfmac_f32_16x16x64_bf16 v[40:43], v[20:23], v[64:71], v0
    ds_read_b128 v[28:31], v3 offset:50176
    v_smfmac_f32_16x16x64_bf16 v[44:47], v[20:23], v[72:79], v0
    s_waitcnt lgkmcnt(2)
    v_smfmac_f32_16x16x64_bf16 v[60:63], v[20:23], v[32:39], v0
    ds_read_b128 v[32:35], v3 offset:51200
    v_smfmac_f32_16x16x64_bf16 v[48:51], v[20:23], v[208:215], v0
    ds_read_b128 v[36:39], v3 offset:52224
    v_smfmac_f32_16x16x64_bf16 v[52:55], v[20:23], v[216:223], v0
    s_waitcnt vmcnt(2) lgkmcnt(2)
    v_smfmac_f32_16x16x64_bf16 v[48:51], v[12:15], v[224:231], v0
    v_smfmac_f32_16x16x64_bf16 v[40:43], v[12:15], v[80:87], v0
    v_smfmac_f32_16x16x64_bf16 v[56:59], v[12:15], v[24:31], v0
    ds_read_b128 v[24:27], v4 offset:17408
    ds_read_b128 v[28:31], v4 offset:18432
    v_smfmac_f32_16x16x64_bf16 v[52:55], v[12:15], v[232:239], v0
    s_waitcnt lgkmcnt(2)
    v_smfmac_f32_16x16x64_bf16 v[44:47], v[12:15], v[88:95], v0
    s_waitcnt vmcnt(0)
    s_nop 7
    s_branch CH_safe1_COMB
CH_safe_LAST:
    buffer_store_dwordx4 v[16:19], v5, s[44:47], s76 offen sc1
    s_waitcnt vmcnt(0)
    s_barrier
    v_mov_b32 v1, 64
    buffer_store_dword v1, off, s[44:47], s78 sc1
    s_branch END
.p2align 6
ROLE_S1:
    s_mul_i32 s98, s5, 256
    s_add_u32 s52, s14, s98
    s_addc_u32 s53, s15, 0
    s_and_b32 s53, s53, 0xffff
    s_sub_u32 s54, 4718592, s98
    s_mov_b32 s55, 0x20000
    s_mul_i32 s98, s5, 256
    s_add_u32 s56, s16, s98
    s_addc_u32 s57, s17, 0
    s_and_b32 s57, s57, 0xffff
    s_sub_u32 s58, 4718592, s98
    s_mov_b32 s59, 0x20000
    s_mov_b32 s60, s8
    s_and_b32 s61, s9, 0xffff
    s_mov_b32 s62, 2359296
    s_mov_b32 s63, 0x20000
    s_lshl_b32 s69, s3, 10
    v_lshrrev_b32 v16, 4, v0
    v_and_b32 v17, 15, v0
    v_lshlrev_b32 v18, 2, v16
    v_xor_b32 v18, v18, v17
    v_lshlrev_b32 v18, 4, v18
    s_lshl_b32 s98, s3, 2
    v_add_u32 v19, s98, v16
    v_lshl_add_u32 v1, v19, 13, v18
    v_bfe_u32 v17, v0, 2, 2
    v_lshrrev_b32 v18, 5, v0
    v_lshl_add_u32 v18, v18, 3, v17
    v_lshlrev_b32 v2, 8, v18
    v_bfe_u32 v18, v0, 4, 1
    v_lshlrev_b32 v18, 1, v18
    v_bfe_u32 v19, v0, 1, 1
    v_add3_u32 v18, v18, v19, s98
    v_lshlrev_b32 v17, 2, v17
    v_xor_b32 v18, v18, v17
    v_lshl_add_u32 v2, v18, 4, v2
    v_and_b32 v18, 1, v0
    v_lshl_add_u32 v2, v18, 3, v2
    s_add_u32 m0, s69, 0
    s_mov_b32 s68, 0
    buffer_load_dwordx4 v1, s[52:55], s68 offen nt lds
    s_add_u32 m0, s69, 4096
    s_mov_b32 s68, 131072
    buffer_load_dwordx4 v1, s[52:55], s68 offen nt lds
    s_add_u32 m0, s69, 8192
    s_mov_b32 s68, 262144
    buffer_load_dwordx4 v1, s[52:55], s68 offen nt lds
    s_add_u32 m0, s69, 12288
    s_mov_b32 s68, 393216
    buffer_load_dwordx4 v1, s[52:55], s68 offen nt lds
    s_add_u32 m0, s69, 16384
    s_mov_b32 s68, 524288
    buffer_load_dwordx4 v1, s[52:55], s68 offen nt lds
    s_add_u32 m0, s69, 20480
    s_mov_b32 s68, 655360
    buffer_load_dwordx4 v1, s[52:55], s68 offen nt lds
    s_add_u32 m0, s69, 24576
    s_mov_b32 s68, 786432
    buffer_load_dwordx4 v1, s[52:55], s68 offen nt lds
    s_add_u32 m0, s69, 28672
    s_mov_b32 s68, 917504
    buffer_load_dwordx4 v1, s[52:55], s68 offen nt lds
    s_add_u32 m0, s69, 32768
    s_mov_b32 s68, 1048576
    buffer_load_dwordx4 v1, s[52:55], s68 offen nt lds
    s_add_u32 m0, s69, 36864
    s_mov_b32 s68, 1179648
    buffer_load_dwordx4 v1, s[52:55], s68 offen nt lds
    s_add_u32 m0, s69, 40960
    s_mov_b32 s68, 1310720
    buffer_load_dwordx4 v1, s[52:55], s68 offen nt lds
    s_add_u32 m0, s69, 45056
    s_mov_b32 s68, 1441792
    buffer_load_dwordx4 v1, s[52:55], s68 offen nt lds
    s_add_u32 m0, s69, 49152
    s_mov_b32 s68, 1572864
    buffer_load_dwordx4 v1, s[52:55], s68 offen nt lds
    s_add_u32 m0, s69, 53248
    s_mov_b32 s68, 1703936
    buffer_load_dwordx4 v1, s[52:55], s68 offen nt lds
    s_add_u32 m0, s69, 57344
    s_mov_b32 s68, 1835008
    buffer_load_dwordx4 v1, s[52:55], s68 offen nt lds
    s_add_u32 m0, s69, 61440
    s_mov_b32 s68, 1966080
    buffer_load_dwordx4 v1, s[52:55], s68 offen nt lds
    s_add_u32 m0, s69, 65536
    s_mov_b32 s68, 2097152
    buffer_load_dwordx4 v1, s[52:55], s68 offen nt lds
    s_add_u32 m0, s69, 69632
    s_mov_b32 s68, 2228224
    buffer_load_dwordx4 v1, s[52:55], s68 offen nt lds
    s_add_u32 m0, s69, 73728
    s_mov_b32 s68, 2359296
    buffer_load_dwordx4 v1, s[52:55], s68 offen nt lds
    s_add_u32 m0, s69, 77824
    s_mov_b32 s68, 2490368
    buffer_load_dwordx4 v1, s[52:55], s68 offen nt lds
    s_add_u32 m0, s69, 81920
    s_mov_b32 s68, 2621440
    buffer_load_dwordx4 v1, s[52:55], s68 offen nt lds
    s_add_u32 m0, s69, 86016
    s_mov_b32 s68, 2752512
    buffer_load_dwordx4 v1, s[52:55], s68 offen nt lds
    s_add_u32 m0, s69, 90112
    s_mov_b32 s68, 2883584
    buffer_load_dwordx4 v1, s[52:55], s68 offen nt lds
    s_add_u32 m0, s69, 94208
    s_mov_b32 s68, 3014656
    buffer_load_dwordx4 v1, s[52:55], s68 offen nt lds
    s_add_u32 m0, s69, 98304
    s_mov_b32 s68, 3145728
    buffer_load_dwordx4 v1, s[52:55], s68 offen nt lds
    s_add_u32 m0, s69, 102400
    s_mov_b32 s68, 3276800
    buffer_load_dwordx4 v1, s[52:55], s68 offen nt lds
    s_add_u32 m0, s69, 106496
    s_mov_b32 s68, 3407872
    buffer_load_dwordx4 v1, s[52:55], s68 offen nt lds
    s_add_u32 m0, s69, 110592
    s_mov_b32 s68, 3538944
    buffer_load_dwordx4 v1, s[52:55], s68 offen nt lds
    s_add_u32 m0, s69, 114688
    s_mov_b32 s68, 3670016
    buffer_load_dwordx4 v1, s[52:55], s68 offen nt lds
    s_add_u32 m0, s69, 118784
    s_mov_b32 s68, 3801088
    buffer_load_dwordx4 v1, s[52:55], s68 offen nt lds
    s_add_u32 m0, s69, 122880
    s_mov_b32 s68, 3932160
    buffer_load_dwordx4 v1, s[52:55], s68 offen nt lds
    s_add_u32 m0, s69, 126976
    s_mov_b32 s68, 4063232
    buffer_load_dwordx4 v1, s[52:55], s68 offen nt lds
    s_add_u32 m0, s69, 131072
    s_mov_b32 s68, 4194304
    buffer_load_dwordx4 v1, s[52:55], s68 offen nt lds
    s_add_u32 m0, s69, 135168
    s_mov_b32 s68, 4325376
    buffer_load_dwordx4 v1, s[52:55], s68 offen nt lds
    s_add_u32 m0, s69, 139264
    s_mov_b32 s68, 4456448
    buffer_load_dwordx4 v1, s[52:55], s68 offen nt lds
    s_add_u32 m0, s69, 143360
    s_mov_b32 s68, 4587520
    buffer_load_dwordx4 v1, s[52:55], s68 offen nt lds
    v_lshrrev_b32 v16, 3, v0
    s_lshl_b32 s98, s3, 3
    v_add_u32 v16, s98, v16
    v_bfe_u32 v17, v16, 1, 3
    v_and_b32 v18, 7, v0
    v_xor_b32 v17, v17, v18
    v_mul_u32_u24 v16, 1152, v16
    v_lshl_add_u32 v4, v17, 4, v16
    v_and_b32 v16, 31, v0
    v_lshrrev_b32 v17, 5, v0
    v_bfe_u32 v18, v16, 1, 3
    v_lshlrev_b32 v19, 7, v16
    v_add_u32 v20, 0, v17
    v_xor_b32 v20, v20, v18
    v_lshl_add_u32 v8, v20, 4, v19
    v_add_u32 v20, 2, v17
    v_xor_b32 v20, v20, v18
    v_lshl_add_u32 v9, v20, 4, v19
    v_add_u32 v20, 4, v17
    v_xor_b32 v20, v20, v18
    v_lshl_add_u32 v10, v20, 4, v19
    v_add_u32 v20, 6, v17
    v_xor_b32 v20, v20, v18
    v_lshl_add_u32 v11, v20, 4, v19
    v_bfe_u32 v20, v16, 3, 1
    v_lshlrev_b32 v20, 10, v20
    v_lshl_add_u32 v20, v17, 8, v20
    v_lshrrev_b32 v21, 4, v16
    v_lshl_add_u32 v20, v21, 7, v20
    v_and_b32 v22, 7, v16
    v_lshl_add_u32 v20, v22, 4, v20
    s_lshl_b32 s98, s3, 11
    v_add_u32 v5, s98, v20
    v_lshlrev_b32 v20, 12, v21
    v_lshl_add_u32 v20, v17, 8, v20
    v_and_b32 v22, 15, v16
    v_lshl_add_u32 v20, v22, 4, v20
    s_add_u32 s98, s69, 8192
    v_add_u32 v6, s98, v20
    s_lshl_b32 s98, s6, 5
    s_add_u32 s98, s98, s5
    s_mul_i32 s98, s98, 65
    s_lshl_b32 s72, s98, 14
    s_add_u32 s72, s72, 16777216
    s_lshl_b32 s98, s6, 5
    s_add_u32 s98, s98, s5
    s_lshl_b32 s73, s98, 7
    s_add_u32 s77, s73, 8192
    s_add_u32 s73, s73, 0
    s_cmp_eq_u32 s3, 0
    s_cselect_b32 s73, s73, 1073741824
    s_waitcnt vmcnt(16)
    s_barrier
    v_add_u32 v3, 0, v2
    ds_read_b64_tr_b16 a[0:1], v3 offset:0
    ds_read_b64_tr_b16 a[2:3], v3 offset:1024
    ds_read_b64_tr_b16 a[4:5], v3 offset:4096
    ds_read_b64_tr_b16 a[6:7], v3 offset:5120
    ds_read_b64_tr_b16 a[8:9], v3 offset:8192
    ds_read_b64_tr_b16 a[10:11], v3 offset:9216
    ds_read_b64_tr_b16 a[12:13], v3 offset:12288
    ds_read_b64_tr_b16 a[14:15], v3 offset:13312
    v_add_u32 v3, 16384, v2
    ds_read_b64_tr_b16 a[16:17], v3 offset:0
    ds_read_b64_tr_b16 a[18:19], v3 offset:1024
    ds_read_b64_tr_b16 a[20:21], v3 offset:4096
    ds_read_b64_tr_b16 a[22:23], v3 offset:5120
    ds_read_b64_tr_b16 a[24:25], v3 offset:8192
    ds_read_b64_tr_b16 a[26:27], v3 offset:9216
    ds_read_b64_tr_b16 a[28:29], v3 offset:12288
    ds_read_b64_tr_b16 a[30:31], v3 offset:13312
    v_add_u32 v3, 32768, v2
    ds_read_b64_tr_b16 a[32:33], v3 offset:0
    ds_read_b64_tr_b16 a[34:35], v3 offset:1024
    ds_read_b64_tr_b16 a[36:37], v3 offset:4096
    ds_read_b64_tr_b16 a[38:39], v3 offset:5120
    ds_read_b64_tr_b16 a[40:41], v3 offset:8192
    ds_read_b64_tr_b16 a[42:43], v3 offset:9216
    ds_read_b64_tr_b16 a[44:45], v3 offset:12288
    ds_read_b64_tr_b16 a[46:47], v3 offset:13312
    v_add_u32 v3, 49152, v2
    ds_read_b64_tr_b16 a[48:49], v3 offset:0
    ds_read_b64_tr_b16 a[50:51], v3 offset:1024
    ds_read_b64_tr_b16 a[52:53], v3 offset:4096
    ds_read_b64_tr_b16 a[54:55], v3 offset:5120
    ds_read_b64_tr_b16 a[56:57], v3 offset:8192
    ds_read_b64_tr_b16 a[58:59], v3 offset:9216
    ds_read_b64_tr_b16 a[60:61], v3 offset:12288
    ds_read_b64_tr_b16 a[62:63], v3 offset:13312
    v_add_u32 v3, 65536, v2
    ds_read_b64_tr_b16 a[64:65], v3 offset:0
    ds_read_b64_tr_b16 a[66:67], v3 offset:1024
    ds_read_b64_tr_b16 a[68:69], v3 offset:4096
    ds_read_b64_tr_b16 a[70:71], v3 offset:5120
    ds_read_b64_tr_b16 a[72:73], v3 offset:8192
    ds_read_b64_tr_b16 a[74:75], v3 offset:9216
    ds_read_b64_tr_b16 a[76:77], v3 offset:12288
    ds_read_b64_tr_b16 a[78:79], v3 offset:13312
    s_waitcnt lgkmcnt(0)
    s_barrier
    s_add_u32 m0, s69, 0
    s_mov_b32 s68, 0
    buffer_load_dwordx4 v1, s[56:59], s68 offen nt lds
    s_add_u32 m0, s69, 4096
    s_mov_b32 s68, 131072
    buffer_load_dwordx4 v1, s[56:59], s68 offen nt lds
    s_add_u32 m0, s69, 8192
    s_mov_b32 s68, 262144
    buffer_load_dwordx4 v1, s[56:59], s68 offen nt lds
    s_add_u32 m0, s69, 12288
    s_mov_b32 s68, 393216
    buffer_load_dwordx4 v1, s[56:59], s68 offen nt lds
    s_add_u32 m0, s69, 16384
    s_mov_b32 s68, 524288
    buffer_load_dwordx4 v1, s[56:59], s68 offen nt lds
    s_add_u32 m0, s69, 20480
    s_mov_b32 s68, 655360
    buffer_load_dwordx4 v1, s[56:59], s68 offen nt lds
    s_add_u32 m0, s69, 24576
    s_mov_b32 s68, 786432
    buffer_load_dwordx4 v1, s[56:59], s68 offen nt lds
    s_add_u32 m0, s69, 28672
    s_mov_b32 s68, 917504
    buffer_load_dwordx4 v1, s[56:59], s68 offen nt lds
    s_add_u32 m0, s69, 32768
    s_mov_b32 s68, 1048576
    buffer_load_dwordx4 v1, s[56:59], s68 offen nt lds
    s_add_u32 m0, s69, 36864
    s_mov_b32 s68, 1179648
    buffer_load_dwordx4 v1, s[56:59], s68 offen nt lds
    s_add_u32 m0, s69, 40960
    s_mov_b32 s68, 1310720
    buffer_load_dwordx4 v1, s[56:59], s68 offen nt lds
    s_add_u32 m0, s69, 45056
    s_mov_b32 s68, 1441792
    buffer_load_dwordx4 v1, s[56:59], s68 offen nt lds
    s_add_u32 m0, s69, 49152
    s_mov_b32 s68, 1572864
    buffer_load_dwordx4 v1, s[56:59], s68 offen nt lds
    s_add_u32 m0, s69, 53248
    s_mov_b32 s68, 1703936
    buffer_load_dwordx4 v1, s[56:59], s68 offen nt lds
    s_add_u32 m0, s69, 57344
    s_mov_b32 s68, 1835008
    buffer_load_dwordx4 v1, s[56:59], s68 offen nt lds
    s_add_u32 m0, s69, 61440
    s_mov_b32 s68, 1966080
    buffer_load_dwordx4 v1, s[56:59], s68 offen nt lds
    s_add_u32 m0, s69, 65536
    s_mov_b32 s68, 2097152
    buffer_load_dwordx4 v1, s[56:59], s68 offen nt lds
    s_add_u32 m0, s69, 69632
    s_mov_b32 s68, 2228224
    buffer_load_dwordx4 v1, s[56:59], s68 offen nt lds
    s_add_u32 m0, s69, 73728
    s_mov_b32 s68, 2359296
    buffer_load_dwordx4 v1, s[56:59], s68 offen nt lds
    s_add_u32 m0, s69, 77824
    s_mov_b32 s68, 2490368
    buffer_load_dwordx4 v1, s[56:59], s68 offen nt lds
    s_waitcnt vmcnt(20)
    s_barrier
    v_add_u32 v3, 81920, v2
    ds_read_b64_tr_b16 a[80:81], v3 offset:0
    ds_read_b64_tr_b16 a[82:83], v3 offset:1024
    ds_read_b64_tr_b16 a[84:85], v3 offset:4096
    ds_read_b64_tr_b16 a[86:87], v3 offset:5120
    ds_read_b64_tr_b16 a[88:89], v3 offset:8192
    ds_read_b64_tr_b16 a[90:91], v3 offset:9216
    ds_read_b64_tr_b16 a[92:93], v3 offset:12288
    ds_read_b64_tr_b16 a[94:95], v3 offset:13312
    v_add_u32 v3, 98304, v2
    ds_read_b64_tr_b16 a[96:97], v3 offset:0
    ds_read_b64_tr_b16 a[98:99], v3 offset:1024
    ds_read_b64_tr_b16 a[100:101], v3 offset:4096
    ds_read_b64_tr_b16 a[102:103], v3 offset:5120
    ds_read_b64_tr_b16 a[104:105], v3 offset:8192
    ds_read_b64_tr_b16 a[106:107], v3 offset:9216
    ds_read_b64_tr_b16 a[108:109], v3 offset:12288
    ds_read_b64_tr_b16 a[110:111], v3 offset:13312
    v_add_u32 v3, 114688, v2
    ds_read_b64_tr_b16 a[112:113], v3 offset:0
    ds_read_b64_tr_b16 a[114:115], v3 offset:1024
    ds_read_b64_tr_b16 a[116:117], v3 offset:4096
    ds_read_b64_tr_b16 a[118:119], v3 offset:5120
    ds_read_b64_tr_b16 a[120:121], v3 offset:8192
    ds_read_b64_tr_b16 a[122:123], v3 offset:9216
    ds_read_b64_tr_b16 a[124:125], v3 offset:12288
    ds_read_b64_tr_b16 a[126:127], v3 offset:13312
    v_add_u32 v3, 131072, v2
    ds_read_b64_tr_b16 a[128:129], v3 offset:0
    ds_read_b64_tr_b16 a[130:131], v3 offset:1024
    ds_read_b64_tr_b16 a[132:133], v3 offset:4096
    ds_read_b64_tr_b16 a[134:135], v3 offset:5120
    ds_read_b64_tr_b16 a[136:137], v3 offset:8192
    ds_read_b64_tr_b16 a[138:139], v3 offset:9216
    ds_read_b64_tr_b16 a[140:141], v3 offset:12288
    ds_read_b64_tr_b16 a[142:143], v3 offset:13312
    s_waitcnt lgkmcnt(0)
    s_barrier
    s_add_u32 m0, s69, 81920
    s_mov_b32 s68, 2621440
    buffer_load_dwordx4 v1, s[56:59], s68 offen nt lds
    s_add_u32 m0, s69, 86016
    s_mov_b32 s68, 2752512
    buffer_load_dwordx4 v1, s[56:59], s68 offen nt lds
    s_add_u32 m0, s69, 90112
    s_mov_b32 s68, 2883584
    buffer_load_dwordx4 v1, s[56:59], s68 offen nt lds
    s_add_u32 m0, s69, 94208
    s_mov_b32 s68, 3014656
    buffer_load_dwordx4 v1, s[56:59], s68 offen nt lds
    s_add_u32 m0, s69, 98304
    s_mov_b32 s68, 3145728
    buffer_load_dwordx4 v1, s[56:59], s68 offen nt lds
    s_add_u32 m0, s69, 102400
    s_mov_b32 s68, 3276800
    buffer_load_dwordx4 v1, s[56:59], s68 offen nt lds
    s_add_u32 m0, s69, 106496
    s_mov_b32 s68, 3407872
    buffer_load_dwordx4 v1, s[56:59], s68 offen nt lds
    s_add_u32 m0, s69, 110592
    s_mov_b32 s68, 3538944
    buffer_load_dwordx4 v1, s[56:59], s68 offen nt lds
    s_add_u32 m0, s69, 114688
    s_mov_b32 s68, 3670016
    buffer_load_dwordx4 v1, s[56:59], s68 offen nt lds
    s_add_u32 m0, s69, 118784
    s_mov_b32 s68, 3801088
    buffer_load_dwordx4 v1, s[56:59], s68 offen nt lds
    s_add_u32 m0, s69, 122880
    s_mov_b32 s68, 3932160
    buffer_load_dwordx4 v1, s[56:59], s68 offen nt lds
    s_add_u32 m0, s69, 126976
    s_mov_b32 s68, 4063232
    buffer_load_dwordx4 v1, s[56:59], s68 offen nt lds
    s_add_u32 m0, s69, 131072
    s_mov_b32 s68, 4194304
    buffer_load_dwordx4 v1, s[56:59], s68 offen nt lds
    s_add_u32 m0, s69, 135168
    s_mov_b32 s68, 4325376
    buffer_load_dwordx4 v1, s[56:59], s68 offen nt lds
    s_add_u32 m0, s69, 139264
    s_mov_b32 s68, 4456448
    buffer_load_dwordx4 v1, s[56:59], s68 offen nt lds
    s_add_u32 m0, s69, 143360
    s_mov_b32 s68, 4587520
    buffer_load_dwordx4 v1, s[56:59], s68 offen nt lds
    s_waitcnt vmcnt(16)
    s_barrier
    v_add_u32 v3, 0, v2
    ds_read_b64_tr_b16 a[144:145], v3 offset:0
    ds_read_b64_tr_b16 a[146:147], v3 offset:1024
    ds_read_b64_tr_b16 a[148:149], v3 offset:4096
    ds_read_b64_tr_b16 a[150:151], v3 offset:5120
    ds_read_b64_tr_b16 a[152:153], v3 offset:8192
    ds_read_b64_tr_b16 a[154:155], v3 offset:9216
    ds_read_b64_tr_b16 a[156:157], v3 offset:12288
    ds_read_b64_tr_b16 a[158:159], v3 offset:13312
    v_add_u32 v3, 16384, v2
    ds_read_b64_tr_b16 a[160:161], v3 offset:0
    ds_read_b64_tr_b16 a[162:163], v3 offset:1024
    ds_read_b64_tr_b16 a[164:165], v3 offset:4096
    ds_read_b64_tr_b16 a[166:167], v3 offset:5120
    ds_read_b64_tr_b16 a[168:169], v3 offset:8192
    ds_read_b64_tr_b16 a[170:171], v3 offset:9216
    ds_read_b64_tr_b16 a[172:173], v3 offset:12288
    ds_read_b64_tr_b16 a[174:175], v3 offset:13312
    v_add_u32 v3, 32768, v2
    ds_read_b64_tr_b16 a[176:177], v3 offset:0
    ds_read_b64_tr_b16 a[178:179], v3 offset:1024
    ds_read_b64_tr_b16 a[180:181], v3 offset:4096
    ds_read_b64_tr_b16 a[182:183], v3 offset:5120
    ds_read_b64_tr_b16 a[184:185], v3 offset:8192
    ds_read_b64_tr_b16 a[186:187], v3 offset:9216
    ds_read_b64_tr_b16 a[188:189], v3 offset:12288
    ds_read_b64_tr_b16 a[190:191], v3 offset:13312
    v_add_u32 v3, 49152, v2
    ds_read_b64_tr_b16 a[192:193], v3 offset:0
    ds_read_b64_tr_b16 a[194:195], v3 offset:1024
    ds_read_b64_tr_b16 a[196:197], v3 offset:4096
    ds_read_b64_tr_b16 a[198:199], v3 offset:5120
    ds_read_b64_tr_b16 a[200:201], v3 offset:8192
    ds_read_b64_tr_b16 a[202:203], v3 offset:9216
    ds_read_b64_tr_b16 a[204:205], v3 offset:12288
    ds_read_b64_tr_b16 a[206:207], v3 offset:13312
    v_add_u32 v3, 65536, v2
    ds_read_b64_tr_b16 a[208:209], v3 offset:0
    ds_read_b64_tr_b16 a[210:211], v3 offset:1024
    ds_read_b64_tr_b16 a[212:213], v3 offset:4096
    ds_read_b64_tr_b16 a[214:215], v3 offset:5120
    ds_read_b64_tr_b16 a[216:217], v3 offset:8192
    ds_read_b64_tr_b16 a[218:219], v3 offset:9216
    ds_read_b64_tr_b16 a[220:221], v3 offset:12288
    ds_read_b64_tr_b16 a[222:223], v3 offset:13312
    s_waitcnt lgkmcnt(0)
    s_barrier
    s_add_u32 s75, s69, 0
    s_mov_b32 s71, 0
    s_add_u32 m0, s75, 0
    s_nop 0
    buffer_load_dwordx4 v4, s[60:63], s71 offen offset:0 lds
    s_add_u32 m0, s75, 3968
    s_nop 0
    buffer_load_dwordx4 v4, s[60:63], s71 offen offset:128 lds
    s_add_u32 m0, s75, 7936
    s_nop 0
    buffer_load_dwordx4 v4, s[60:63], s71 offen offset:256 lds
    s_add_u32 m0, s75, 11904
    s_nop 0
    buffer_load_dwordx4 v4, s[60:63], s71 offen offset:384 lds
    s_add_u32 m0, s75, 15872
    s_nop 0
    buffer_load_dwordx4 v4, s[60:63], s71 offen offset:512 lds
    s_add_u32 m0, s75, 19840
    s_nop 0
    buffer_load_dwordx4 v4, s[60:63], s71 offen offset:640 lds
    s_add_u32 m0, s75, 23808
    s_nop 0
    buffer_load_dwordx4 v4, s[60:63], s71 offen offset:768 lds
    s_add_u32 m0, s75, 27776
    s_nop 0
    buffer_load_dwordx4 v4, s[60:63], s71 offen offset:896 lds
    s_add_u32 m0, s75, 31744
    s_nop 0
    buffer_load_dwordx4 v4, s[60:63], s71 offen offset:1024 lds
    s_add_u32 s75, s69, 36864
    s_mov_b32 s71, 36864
    s_add_u32 m0, s75, 0
    s_nop 0
    buffer_load_dwordx4 v4, s[60:63], s71 offen offset:0 lds
    s_add_u32 m0, s75, 3968
    s_nop 0
    buffer_load_dwordx4 v4, s[60:63], s71 offen offset:128 lds
    s_add_u32 m0, s75, 7936
    s_nop 0
    buffer_load_dwordx4 v4, s[60:63], s71 offen offset:256 lds
    s_add_u32 m0, s75, 11904
    s_nop 0
    buffer_load_dwordx4 v4, s[60:63], s71 offen offset:384 lds
    s_add_u32 m0, s75, 15872
    s_nop 0
    buffer_load_dwordx4 v4, s[60:63], s71 offen offset:512 lds
    s_add_u32 m0, s75, 19840
    s_nop 0
    buffer_load_dwordx4 v4, s[60:63], s71 offen offset:640 lds
    s_add_u32 m0, s75, 23808
    s_nop 0
    buffer_load_dwordx4 v4, s[60:63], s71 offen offset:768 lds
    s_add_u32 m0, s75, 27776
    s_nop 0
    buffer_load_dwordx4 v4, s[60:63], s71 offen offset:896 lds
    s_add_u32 m0, s75, 31744
    s_nop 0
    buffer_load_dwordx4 v4, s[60:63], s71 offen offset:1024 lds
    s_waitcnt vmcnt(18)
    s_barrier
    v_add_u32 v3, 81920, v2
    ds_read_b64_tr_b16 a[224:225], v3 offset:0
    ds_read_b64_tr_b16 a[226:227], v3 offset:1024
    ds_read_b64_tr_b16 a[228:229], v3 offset:4096
    ds_read_b64_tr_b16 a[230:231], v3 offset:5120
    ds_read_b64_tr_b16 a[232:233], v3 offset:8192
    ds_read_b64_tr_b16 a[234:235], v3 offset:9216
    ds_read_b64_tr_b16 a[236:237], v3 offset:12288
    ds_read_b64_tr_b16 a[238:239], v3 offset:13312
    v_add_u32 v3, 98304, v2
    ds_read_b64_tr_b16 a[240:241], v3 offset:0
    ds_read_b64_tr_b16 a[242:243], v3 offset:1024
    ds_read_b64_tr_b16 a[244:245], v3 offset:4096
    ds_read_b64_tr_b16 a[246:247], v3 offset:5120
    ds_read_b64_tr_b16 a[248:249], v3 offset:8192
    ds_read_b64_tr_b16 a[250:251], v3 offset:9216
    ds_read_b64_tr_b16 a[252:253], v3 offset:12288
    ds_read_b64_tr_b16 a[254:255], v3 offset:13312
    v_add_u32 v3, 114688, v2
    ds_read_b64_tr_b16 v[192:193], v3 offset:0
    ds_read_b64_tr_b16 v[194:195], v3 offset:1024
    ds_read_b64_tr_b16 v[196:197], v3 offset:4096
    ds_read_b64_tr_b16 v[198:199], v3 offset:5120
    ds_read_b64_tr_b16 v[200:201], v3 offset:8192
    ds_read_b64_tr_b16 v[202:203], v3 offset:9216
    ds_read_b64_tr_b16 v[204:205], v3 offset:12288
    ds_read_b64_tr_b16 v[206:207], v3 offset:13312
    v_add_u32 v3, 131072, v2
    ds_read_b64_tr_b16 v[208:209], v3 offset:0
    ds_read_b64_tr_b16 v[210:211], v3 offset:1024
    ds_read_b64_tr_b16 v[212:213], v3 offset:4096
    ds_read_b64_tr_b16 v[214:215], v3 offset:5120
    ds_read_b64_tr_b16 v[216:217], v3 offset:8192
    ds_read_b64_tr_b16 v[218:219], v3 offset:9216
    ds_read_b64_tr_b16 v[220:221], v3 offset:12288
    ds_read_b64_tr_b16 v[222:223], v3 offset:13312
    s_waitcnt lgkmcnt(0)
    s_barrier
    s_add_u32 s75, s69, 73728
    s_mov_b32 s71, 73728
    s_add_u32 m0, s75, 0
    s_nop 0
    buffer_load_dwordx4 v4, s[60:63], s71 offen offset:0 lds
    s_add_u32 m0, s75, 3968
    s_nop 0
    buffer_load_dwordx4 v4, s[60:63], s71 offen offset:128 lds
    s_add_u32 m0, s75, 7936
    s_nop 0
    buffer_load_dwordx4 v4, s[60:63], s71 offen offset:256 lds
    s_add_u32 m0, s75, 11904
    s_nop 0
    buffer_load_dwordx4 v4, s[60:63], s71 offen offset:384 lds
    s_add_u32 m0, s75, 15872
    s_nop 0
    buffer_load_dwordx4 v4, s[60:63], s71 offen offset:512 lds
    s_add_u32 m0, s75, 19840
    s_nop 0
    buffer_load_dwordx4 v4, s[60:63], s71 offen offset:640 lds
    s_add_u32 m0, s75, 23808
    s_nop 0
    buffer_load_dwordx4 v4, s[60:63], s71 offen offset:768 lds
    s_add_u32 m0, s75, 27776
    s_nop 0
    buffer_load_dwordx4 v4, s[60:63], s71 offen offset:896 lds
    s_add_u32 m0, s75, 31744
    s_nop 0
    buffer_load_dwordx4 v4, s[60:63], s71 offen offset:1024 lds
    v_lshlrev_b32 v16, 2, v0
waitd_33:
    buffer_load_dword v17, v16, s[48:51], 0 offen sc1
    s_waitcnt vmcnt(0)
    v_readlane_b32 s98, v17, 51
    s_cmp_ge_u32 s98, 128
    s_cbranch_scc1 waitd_done_34
dno_35:
    s_sleep 8
    s_add_u32 s100, s100, 1
    s_cmp_lt_u32 s100, 262144
    s_cbranch_scc1 spin_ok_36
    s_mov_b32 s98, 1
    s_branch FAIL
spin_ok_36:
    s_branch waitd_33
waitd_done_34:
    v_mov_b32 v7, 1
    buffer_store_dword v7, off, s[44:47], s73 offset:64 sc1
    s_mov_b32 s70, 0
    s_mov_b32 s74, 0
    s_mov_b32 s71, 110592
    s_mov_b32 s76, 1073741824
    s_barrier
    v_mov_b32 v12, v8
    v_mov_b32 v13, v9
    v_mov_b32 v14, v10
    v_mov_b32 v15, v11
    ds_read_b128 v[16:19], v12 offset:0
    ds_read_b128 v[20:23], v13 offset:0
    ds_read_b128 v[24:27], v14 offset:0
S1_LOOP0:
    v_add_u32 v15, s74, v11
    ds_read_b128 v[28:31], v15 offset:0
    s_waitcnt lgkmcnt(3)
    v_mfma_f32_32x32x16_bf16 v[32:47], a[0:3], v[16:19], 0
    v_mfma_f32_32x32x16_bf16 v[48:63], v[16:19], a[144:147], 0
    ds_read_b128 v[16:19], v12 offset:4096
    s_waitcnt lgkmcnt(3)
    v_mfma_f32_32x32x16_bf16 v[32:47], a[4:7], v[20:23], v[32:47]
    v_mfma_f32_32x32x16_bf16 v[48:63], v[20:23], a[148:151], v[48:63]
    ds_read_b128 v[20:23], v13 offset:4096
    s_waitcnt lgkmcnt(3)
    v_mfma_f32_32x32x16_bf16 v[32:47], a[8:11], v[24:27], v[32:47]
    v_cvt_pk_bf16_f32 v64, v96, v97
    v_cvt_pk_bf16_f32 v65, v98, v99
    v_mfma_f32_32x32x16_bf16 v[48:63], v[24:27], a[152:155], v[48:63]
    v_cvt_pk_bf16_f32 v66, v100, v101
    v_cvt_pk_bf16_f32 v67, v102, v103
    ds_read_b128 v[24:27], v14 offset:4096
    s_waitcnt lgkmcnt(3)
    v_mfma_f32_32x32x16_bf16 v[32:47], a[12:15], v[28:31], v[32:47]
    buffer_store_dwordx4 v[64:67], v5, s[44:47], s76 offen offset:0 sc1
    v_cvt_pk_bf16_f32 v68, v104, v105
    v_mfma_f32_32x32x16_bf16 v[48:63], v[28:31], a[156:159], v[48:63]
    v_cvt_pk_bf16_f32 v69, v106, v107
    v_cvt_pk_bf16_f32 v70, v108, v109
    ds_read_b128 v[28:31], v15 offset:4096
    s_waitcnt lgkmcnt(3)
    v_mfma_f32_32x32x16_bf16 v[32:47], a[16:19], v[16:19], v[32:47]
    v_cvt_pk_bf16_f32 v71, v110, v111
    buffer_store_dwordx4 v[68:71], v5, s[44:47], s76 offen offset:512 sc1
    v_mfma_f32_32x32x16_bf16 v[48:63], v[16:19], a[160:163], v[48:63]
    v_cvt_pk_bf16_f32 v72, v112, v113
    v_cvt_pk_bf16_f32 v73, v114, v115
    ds_read_b128 v[16:19], v12 offset:8192
    s_waitcnt lgkmcnt(3)
    v_mfma_f32_32x32x16_bf16 v[32:47], a[20:23], v[20:23], v[32:47]
    v_cvt_pk_bf16_f32 v74, v116, v117
    v_cvt_pk_bf16_f32 v75, v118, v119
    v_mfma_f32_32x32x16_bf16 v[48:63], v[20:23], a[164:167], v[48:63]
    buffer_store_dwordx4 v[72:75], v6, s[44:47], s76 offen offset:0 sc1
    v_cvt_pk_bf16_f32 v76, v120, v121
    ds_read_b128 v[20:23], v13 offset:8192
    s_waitcnt lgkmcnt(3)
    v_mfma_f32_32x32x16_bf16 v[32:47], a[24:27], v[24:27], v[32:47]
    v_cvt_pk_bf16_f32 v77, v122, v123
    v_cvt_pk_bf16_f32 v78, v124, v125
    v_mfma_f32_32x32x16_bf16 v[48:63], v[24:27], a[168:171], v[48:63]
    v_cvt_pk_bf16_f32 v79, v126, v127
    buffer_store_dwordx4 v[76:79], v6, s[44:47], s76 offen offset:512 sc1
    ds_read_b128 v[24:27], v14 offset:8192
    s_waitcnt lgkmcnt(3)
    v_mfma_f32_32x32x16_bf16 v[32:47], a[28:31], v[28:31], v[32:47]
    v_mfma_f32_32x32x16_bf16 v[48:63], v[28:31], a[172:175], v[48:63]
    ds_read_b128 v[28:31], v15 offset:8192
    s_waitcnt lgkmcnt(3)
    v_mfma_f32_32x32x16_bf16 v[32:47], a[32:35], v[16:19], v[32:47]
    v_mfma_f32_32x32x16_bf16 v[48:63], v[16:19], a[176:179], v[48:63]
    ds_read_b128 v[16:19], v12 offset:12288
    s_waitcnt lgkmcnt(3)
    v_mfma_f32_32x32x16_bf16 v[32:47], a[36:39], v[20:23], v[32:47]
    v_mfma_f32_32x32x16_bf16 v[48:63], v[20:23], a[180:183], v[48:63]
    ds_read_b128 v[20:23], v13 offset:12288
    s_waitcnt lgkmcnt(3)
    v_mfma_f32_32x32x16_bf16 v[32:47], a[40:43], v[24:27], v[32:47]
    v_mfma_f32_32x32x16_bf16 v[48:63], v[24:27], a[184:187], v[48:63]
    ds_read_b128 v[24:27], v14 offset:12288
    s_waitcnt lgkmcnt(3)
    v_mfma_f32_32x32x16_bf16 v[32:47], a[44:47], v[28:31], v[32:47]
    v_mfma_f32_32x32x16_bf16 v[48:63], v[28:31], a[188:191], v[48:63]
    ds_read_b128 v[28:31], v15 offset:12288
    s_waitcnt lgkmcnt(3)
    v_mfma_f32_32x32x16_bf16 v[32:47], a[48:51], v[16:19], v[32:47]
    v_mfma_f32_32x32x16_bf16 v[48:63], v[16:19], a[192:195], v[48:63]
    ds_read_b128 v[16:19], v12 offset:16384
    s_waitcnt lgkmcnt(3)
    v_mfma_f32_32x32x16_bf16 v[32:47], a[52:55], v[20:23], v[32:47]
    v_mfma_f32_32x32x16_bf16 v[48:63], v[20:23], a[196:199], v[48:63]
    ds_read_b128 v[20:23], v13 offset:16384
    s_waitcnt lgkmcnt(3)
    v_mfma_f32_32x32x16_bf16 v[32:47], a[56:59], v[24:27], v[32:47]
    v_mfma_f32_32x32x16_bf16 v[48:63], v[24:27], a[200:203], v[48:63]
    ds_read_b128 v[24:27], v14 offset:16384
    s_waitcnt lgkmcnt(3)
    v_mfma_f32_32x32x16_bf16 v[32:47], a[60:63], v[28:31], v[32:47]
    v_mfma_f32_32x32x16_bf16 v[48:63], v[28:31], a[204:207], v[48:63]
    ds_read_b128 v[28:31], v15 offset:16384
    s_waitcnt lgkmcnt(3)
    v_mfma_f32_32x32x16_bf16 v[32:47], a[64:67], v[16:19], v[32:47]
    v_mfma_f32_32x32x16_bf16 v[48:63], v[16:19], a[208:211], v[48:63]
    ds_read_b128 v[16:19], v12 offset:20480
    s_waitcnt lgkmcnt(3)
    v_mfma_f32_32x32x16_bf16 v[32:47], a[68:71], v[20:23], v[32:47]
    v_mfma_f32_32x32x16_bf16 v[48:63], v[20:23], a[212:215], v[48:63]
    ds_read_b128 v[20:23], v13 offset:20480
    s_waitcnt lgkmcnt(3)
    v_mfma_f32_32x32x16_bf16 v[32:47], a[72:75], v[24:27], v[32:47]
    v_mfma_f32_32x32x16_bf16 v[48:63], v[24:27], a[216:219], v[48:63]
    ds_read_b128 v[24:27], v14 offset:20480
    s_waitcnt lgkmcnt(3)
    v_mfma_f32_32x32x16_bf16 v[32:47], a[76:79], v[28:31], v[32:47]
    v_mfma_f32_32x32x16_bf16 v[48:63], v[28:31], a[220:223], v[48:63]
    ds_read_b128 v[28:31], v15 offset:20480
    s_waitcnt lgkmcnt(3)
    v_mfma_f32_32x32x16_bf16 v[32:47], a[80:83], v[16:19], v[32:47]
    v_mfma_f32_32x32x16_bf16 v[48:63], v[16:19], a[224:227], v[48:63]
    ds_read_b128 v[16:19], v12 offset:24576
    s_waitcnt lgkmcnt(3)
    v_mfma_f32_32x32x16_bf16 v[32:47], a[84:87], v[20:23], v[32:47]
    v_mfma_f32_32x32x16_bf16 v[48:63], v[20:23], a[228:231], v[48:63]
    ds_read_b128 v[20:23], v13 offset:24576
    s_waitcnt lgkmcnt(3)
    v_mfma_f32_32x32x16_bf16 v[32:47], a[88:91], v[24:27], v[32:47]
    v_mfma_f32_32x32x16_bf16 v[48:63], v[24:27], a[232:235], v[48:63]
    ds_read_b128 v[24:27], v14 offset:24576
    s_waitcnt lgkmcnt(3)
    v_mfma_f32_32x32x16_bf16 v[32:47], a[92:95], v[28:31], v[32:47]
    v_mfma_f32_32x32x16_bf16 v[48:63], v[28:31], a[236:239], v[48:63]
    ds_read_b128 v[28:31], v15 offset:24576
    s_waitcnt lgkmcnt(3)
    v_mfma_f32_32x32x16_bf16 v[32:47], a[96:99], v[16:19], v[32:47]
    v_mfma_f32_32x32x16_bf16 v[48:63], v[16:19], a[240:243], v[48:63]
    ds_read_b128 v[16:19], v12 offset:28672
    s_waitcnt lgkmcnt(3)
    v_mfma_f32_32x32x16_bf16 v[32:47], a[100:103], v[20:23], v[32:47]
    s_sub_u32 s75, s74, 36864
    s_cmp_eq_u32 s74, 0
    s_cselect_b32 s75, 110592, s75
    s_add_u32 s75, s75, s69
    v_mov_b32 v7, s70
    v_mfma_f32_32x32x16_bf16 v[48:63], v[20:23], a[244:247], v[48:63]
    ds_read_b128 v[20:23], v13 offset:28672
    s_waitcnt lgkmcnt(3)
    v_mfma_f32_32x32x16_bf16 v[32:47], a[104:107], v[24:27], v[32:47]
    v_mfma_f32_32x32x16_bf16 v[48:63], v[24:27], a[248:251], v[48:63]
    s_waitcnt vmcnt(0)
    s_barrier
    buffer_store_dword v7, off, s[44:47], s73 sc1
    ds_read_b128 v[24:27], v14 offset:28672
    s_waitcnt lgkmcnt(3)
    v_mfma_f32_32x32x16_bf16 v[32:47], a[108:111], v[28:31], v[32:47]
    s_add_u32 m0, s75, 0
    v_mfma_f32_32x32x16_bf16 v[48:63], v[28:31], a[252:255], v[48:63]
    buffer_load_dwordx4 v4, s[60:63], s71 offen offset:0 lds
    ds_read_b128 v[28:31], v15 offset:28672
    s_waitcnt lgkmcnt(3)
    v_mfma_f32_32x32x16_bf16 v[32:47], a[112:115], v[16:19], v[32:47]
    s_add_u32 m0, s75, 3968
    v_mfma_f32_32x32x16_bf16 v[48:63], v[16:19], v[192:195], v[48:63]
    buffer_load_dwordx4 v4, s[60:63], s71 offen offset:128 lds
    ds_read_b128 v[16:19], v12 offset:32768
    s_waitcnt lgkmcnt(3)
    v_mfma_f32_32x32x16_bf16 v[32:47], a[116:119], v[20:23], v[32:47]
    s_add_u32 m0, s75, 7936
    v_mfma_f32_32x32x16_bf16 v[48:63], v[20:23], v[196:199], v[48:63]
    buffer_load_dwordx4 v4, s[60:63], s71 offen offset:256 lds
    ds_read_b128 v[20:23], v13 offset:32768
    s_waitcnt lgkmcnt(3)
    v_mfma_f32_32x32x16_bf16 v[32:47], a[120:123], v[24:27], v[32:47]
    s_add_u32 m0, s75, 11904
    v_mfma_f32_32x32x16_bf16 v[48:63], v[24:27], v[200:203], v[48:63]
    buffer_load_dwordx4 v4, s[60:63], s71 offen offset:384 lds
    ds_read_b128 v[24:27], v14 offset:32768
    s_waitcnt lgkmcnt(3)
    v_mfma_f32_32x32x16_bf16 v[32:47], a[124:127], v[28:31], v[32:47]
    s_add_u32 m0, s75, 15872
    v_mfma_f32_32x32x16_bf16 v[48:63], v[28:31], v[204:207], v[48:63]
    buffer_load_dwordx4 v4, s[60:63], s71 offen offset:512 lds
    ds_read_b128 v[28:31], v15 offset:32768
    s_waitcnt lgkmcnt(3)
    v_mfma_f32_32x32x16_bf16 v[32:47], a[128:131], v[16:19], v[32:47]
    s_add_u32 m0, s75, 19840
    v_mfma_f32_32x32x16_bf16 v[48:63], v[16:19], v[208:211], v[48:63]
    buffer_load_dwordx4 v4, s[60:63], s71 offen offset:640 lds
    s_add_u32 s74, s74, 36864
    s_cmp_eq_u32 s74, 147456
    s_cselect_b32 s74, 0, s74
    v_add_u32 v12, s74, v8
    ds_read_b128 v[16:19], v12 offset:0
    s_waitcnt lgkmcnt(3)
    v_mfma_f32_32x32x16_bf16 v[32:47], a[132:135], v[20:23], v[32:47]
    s_add_u32 m0, s75, 23808
    v_mfma_f32_32x32x16_bf16 v[48:63], v[20:23], v[212:215], v[48:63]
    buffer_load_dwordx4 v4, s[60:63], s71 offen offset:768 lds
    v_add_u32 v13, s74, v9
    ds_read_b128 v[20:23], v13 offset:0
    s_waitcnt lgkmcnt(3)
    v_mfma_f32_32x32x16_bf16 v[32:47], a[136:139], v[24:27], v[32:47]
    s_add_u32 m0, s75, 27776
    v_mfma_f32_32x32x16_bf16 v[48:63], v[24:27], v[216:219], v[48:63]
    buffer_load_dwordx4 v4, s[60:63], s71 offen offset:896 lds
    v_add_u32 v14, s74, v10
    ds_read_b128 v[24:27], v14 offset:0
    s_waitcnt lgkmcnt(3)
    v_mfma_f32_32x32x16_bf16 v[32:47], a[140:143], v[28:31], v[32:47]
    s_add_u32 m0, s75, 31744
    v_mfma_f32_32x32x16_bf16 v[48:63], v[28:31], v[220:223], v[48:63]
    buffer_load_dwordx4 v4, s[60:63], s71 offen offset:1024 lds
    s_add_u32 s71, s71, 36864
    s_mov_b32 s76, s72
    s_add_u32 s72, s72, 16384
    s_add_u32 s70, s70, 1
S1_LOOP1:
    v_add_u32 v15, s74, v11
    ds_read_b128 v[28:31], v15 offset:0
    s_waitcnt lgkmcnt(3)
    v_mfma_f32_32x32x16_bf16 v[96:111], a[0:3], v[16:19], 0
    v_mfma_f32_32x32x16_bf16 v[112:127], v[16:19], a[144:147], 0
    ds_read_b128 v[16:19], v12 offset:4096
    s_waitcnt lgkmcnt(3)
    v_mfma_f32_32x32x16_bf16 v[96:111], a[4:7], v[20:23], v[96:111]
    v_mfma_f32_32x32x16_bf16 v[112:127], v[20:23], a[148:151], v[112:127]
    ds_read_b128 v[20:23], v13 offset:4096
    s_waitcnt lgkmcnt(3)
    v_mfma_f32_32x32x16_bf16 v[96:111], a[8:11], v[24:27], v[96:111]
    v_cvt_pk_bf16_f32 v64, v32, v33
    v_cvt_pk_bf16_f32 v65, v34, v35
    v_mfma_f32_32x32x16_bf16 v[112:127], v[24:27], a[152:155], v[112:127]
    v_cvt_pk_bf16_f32 v66, v36, v37
    v_cvt_pk_bf16_f32 v67, v38, v39
    ds_read_b128 v[24:27], v14 offset:4096
    s_waitcnt lgkmcnt(3)
    v_mfma_f32_32x32x16_bf16 v[96:111], a[12:15], v[28:31], v[96:111]
    buffer_store_dwordx4 v[64:67], v5, s[44:47], s76 offen offset:0 sc1
    v_cvt_pk_bf16_f32 v68, v40, v41
    v_mfma_f32_32x32x16_bf16 v[112:127], v[28:31], a[156:159], v[112:127]
    v_cvt_pk_bf16_f32 v69, v42, v43
    v_cvt_pk_bf16_f32 v70, v44, v45
    ds_read_b128 v[28:31], v15 offset:4096
    s_waitcnt lgkmcnt(3)
    v_mfma_f32_32x32x16_bf16 v[96:111], a[16:19], v[16:19], v[96:111]
    v_cvt_pk_bf16_f32 v71, v46, v47
    buffer_store_dwordx4 v[68:71], v5, s[44:47], s76 offen offset:512 sc1
    v_mfma_f32_32x32x16_bf16 v[112:127], v[16:19], a[160:163], v[112:127]
    v_cvt_pk_bf16_f32 v72, v48, v49
    v_cvt_pk_bf16_f32 v73, v50, v51
    ds_read_b128 v[16:19], v12 offset:8192
    s_waitcnt lgkmcnt(3)
    v_mfma_f32_32x32x16_bf16 v[96:111], a[20:23], v[20:23], v[96:111]
    v_cvt_pk_bf16_f32 v74, v52, v53
    v_cvt_pk_bf16_f32 v75, v54, v55
    v_mfma_f32_32x32x16_bf16 v[112:127], v[20:23], a[164:167], v[112:127]
    buffer_store_dwordx4 v[72:75], v6, s[44:47], s76 offen offset:0 sc1
    v_cvt_pk_bf16_f32 v76, v56, v57
    ds_read_b128 v[20:23], v13 offset:8192
    s_waitcnt lgkmcnt(3)
    v_mfma_f32_32x32x16_bf16 v[96:111], a[24:27], v[24:27], v[96:111]
    v_cvt_pk_bf16_f32 v77, v58, v59
    v_cvt_pk_bf16_f32 v78, v60, v61
    v_mfma_f32_32x32x16_bf16 v[112:127], v[24:27], a[168:171], v[112:127]
    v_cvt_pk_bf16_f32 v79, v62, v63
    buffer_store_dwordx4 v[76:79], v6, s[44:47], s76 offen offset:512 sc1
    ds_read_b128 v[24:27], v14 offset:8192
    s_waitcnt lgkmcnt(3)
    v_mfma_f32_32x32x16_bf16 v[96:111], a[28:31], v[28:31], v[96:111]
    v_mfma_f32_32x32x16_bf16 v[112:127], v[28:31], a[172:175], v[112:127]
    ds_read_b128 v[28:31], v15 offset:8192
    s_waitcnt lgkmcnt(3)
    v_mfma_f32_32x32x16_bf16 v[96:111], a[32:35], v[16:19], v[96:111]
    v_mfma_f32_32x32x16_bf16 v[112:127], v[16:19], a[176:179], v[112:127]
    ds_read_b128 v[16:19], v12 offset:12288
    s_waitcnt lgkmcnt(3)
    v_mfma_f32_32x32x16_bf16 v[96:111], a[36:39], v[20:23], v[96:111]
    v_mfma_f32_32x32x16_bf16 v[112:127], v[20:23], a[180:183], v[112:127]
    ds_read_b128 v[20:23], v13 offset:12288
    s_waitcnt lgkmcnt(3)
    v_mfma_f32_32x32x16_bf16 v[96:111], a[40:43], v[24:27], v[96:111]
    v_mfma_f32_32x32x16_bf16 v[112:127], v[24:27], a[184:187], v[112:127]
    ds_read_b128 v[24:27], v14 offset:12288
    s_waitcnt lgkmcnt(3)
    v_mfma_f32_32x32x16_bf16 v[96:111], a[44:47], v[28:31], v[96:111]
    v_mfma_f32_32x32x16_bf16 v[112:127], v[28:31], a[188:191], v[112:127]
    ds_read_b128 v[28:31], v15 offset:12288
    s_waitcnt lgkmcnt(3)
    v_mfma_f32_32x32x16_bf16 v[96:111], a[48:51], v[16:19], v[96:111]
    v_mfma_f32_32x32x16_bf16 v[112:127], v[16:19], a[192:195], v[112:127]
    ds_read_b128 v[16:19], v12 offset:16384
    s_waitcnt lgkmcnt(3)
    v_mfma_f32_32x32x16_bf16 v[96:111], a[52:55], v[20:23], v[96:111]
    v_mfma_f32_32x32x16_bf16 v[112:127], v[20:23], a[196:199], v[112:127]
    ds_read_b128 v[20:23], v13 offset:16384
    s_waitcnt lgkmcnt(3)
    v_mfma_f32_32x32x16_bf16 v[96:111], a[56:59], v[24:27], v[96:111]
    v_mfma_f32_32x32x16_bf16 v[112:127], v[24:27], a[200:203], v[112:127]
    ds_read_b128 v[24:27], v14 offset:16384
    s_waitcnt lgkmcnt(3)
    v_mfma_f32_32x32x16_bf16 v[96:111], a[60:63], v[28:31], v[96:111]
    v_mfma_f32_32x32x16_bf16 v[112:127], v[28:31], a[204:207], v[112:127]
    ds_read_b128 v[28:31], v15 offset:16384
    s_waitcnt lgkmcnt(3)
    v_mfma_f32_32x32x16_bf16 v[96:111], a[64:67], v[16:19], v[96:111]
    v_mfma_f32_32x32x16_bf16 v[112:127], v[16:19], a[208:211], v[112:127]
    ds_read_b128 v[16:19], v12 offset:20480
    s_waitcnt lgkmcnt(3)
    v_mfma_f32_32x32x16_bf16 v[96:111], a[68:71], v[20:23], v[96:111]
    v_mfma_f32_32x32x16_bf16 v[112:127], v[20:23], a[212:215], v[112:127]
    ds_read_b128 v[20:23], v13 offset:20480
    s_waitcnt lgkmcnt(3)
    v_mfma_f32_32x32x16_bf16 v[96:111], a[72:75], v[24:27], v[96:111]
    v_mfma_f32_32x32x16_bf16 v[112:127], v[24:27], a[216:219], v[112:127]
    ds_read_b128 v[24:27], v14 offset:20480
    s_waitcnt lgkmcnt(3)
    v_mfma_f32_32x32x16_bf16 v[96:111], a[76:79], v[28:31], v[96:111]
    v_mfma_f32_32x32x16_bf16 v[112:127], v[28:31], a[220:223], v[112:127]
    ds_read_b128 v[28:31], v15 offset:20480
    s_waitcnt lgkmcnt(3)
    v_mfma_f32_32x32x16_bf16 v[96:111], a[80:83], v[16:19], v[96:111]
    v_mfma_f32_32x32x16_bf16 v[112:127], v[16:19], a[224:227], v[112:127]
    ds_read_b128 v[16:19], v12 offset:24576
    s_waitcnt lgkmcnt(3)
    v_mfma_f32_32x32x16_bf16 v[96:111], a[84:87], v[20:23], v[96:111]
    v_mfma_f32_32x32x16_bf16 v[112:127], v[20:23], a[228:231], v[112:127]
    ds_read_b128 v[20:23], v13 offset:24576
    s_waitcnt lgkmcnt(3)
    v_mfma_f32_32x32x16_bf16 v[96:111], a[88:91], v[24:27], v[96:111]
    v_mfma_f32_32x32x16_bf16 v[112:127], v[24:27], a[232:235], v[112:127]
    ds_read_b128 v[24:27], v14 offset:24576
    s_waitcnt lgkmcnt(3)
    v_mfma_f32_32x32x16_bf16 v[96:111], a[92:95], v[28:31], v[96:111]
    v_mfma_f32_32x32x16_bf16 v[112:127], v[28:31], a[236:239], v[112:127]
    ds_read_b128 v[28:31], v15 offset:24576
    s_waitcnt lgkmcnt(3)
    v_mfma_f32_32x32x16_bf16 v[96:111], a[96:99], v[16:19], v[96:111]
    v_mfma_f32_32x32x16_bf16 v[112:127], v[16:19], a[240:243], v[112:127]
    ds_read_b128 v[16:19], v12 offset:28672
    s_waitcnt lgkmcnt(3)
    v_mfma_f32_32x32x16_bf16 v[96:111], a[100:103], v[20:23], v[96:111]
    s_sub_u32 s75, s74, 36864
    s_cmp_eq_u32 s74, 0
    s_cselect_b32 s75, 110592, s75
    s_add_u32 s75, s75, s69
    v_mov_b32 v7, s70
    v_mfma_f32_32x32x16_bf16 v[112:127], v[20:23], a[244:247], v[112:127]
    ds_read_b128 v[20:23], v13 offset:28672
    s_waitcnt lgkmcnt(3)
    v_mfma_f32_32x32x16_bf16 v[96:111], a[104:107], v[24:27], v[96:111]
    v_mfma_f32_32x32x16_bf16 v[112:127], v[24:27], a[248:251], v[112:127]
    s_waitcnt vmcnt(0)
    s_barrier
    buffer_store_dword v7, off, s[44:47], s73 sc1
    ds_read_b128 v[24:27], v14 offset:28672
    s_waitcnt lgkmcnt(3)
    v_mfma_f32_32x32x16_bf16 v[96:111], a[108:111], v[28:31], v[96:111]
    s_add_u32 m0, s75, 0
    v_mfma_f32_32x32x16_bf16 v[112:127], v[28:31], a[252:255], v[112:127]
    buffer_load_dwordx4 v4, s[60:63], s71 offen offset:0 lds
    ds_read_b128 v[28:31], v15 offset:28672
    s_waitcnt lgkmcnt(3)
    v_mfma_f32_32x32x16_bf16 v[96:111], a[112:115], v[16:19], v[96:111]
    s_add_u32 m0, s75, 3968
    v_mfma_f32_32x32x16_bf16 v[112:127], v[16:19], v[192:195], v[112:127]
    buffer_load_dwordx4 v4, s[60:63], s71 offen offset:128 lds
    ds_read_b128 v[16:19], v12 offset:32768
    s_waitcnt lgkmcnt(3)
    v_mfma_f32_32x32x16_bf16 v[96:111], a[116:119], v[20:23], v[96:111]
    s_add_u32 m0, s75, 7936
    v_mfma_f32_32x32x16_bf16 v[112:127], v[20:23], v[196:199], v[112:127]
    buffer_load_dwordx4 v4, s[60:63], s71 offen offset:256 lds
    ds_read_b128 v[20:23], v13 offset:32768
    s_waitcnt lgkmcnt(3)
    v_mfma_f32_32x32x16_bf16 v[96:111], a[120:123], v[24:27], v[96:111]
    s_add_u32 m0, s75, 11904
    v_mfma_f32_32x32x16_bf16 v[112:127], v[24:27], v[200:203], v[112:127]
    buffer_load_dwordx4 v4, s[60:63], s71 offen offset:384 lds
    ds_read_b128 v[24:27], v14 offset:32768
    s_waitcnt lgkmcnt(3)
    v_mfma_f32_32x32x16_bf16 v[96:111], a[124:127], v[28:31], v[96:111]
    s_add_u32 m0, s75, 15872
    v_mfma_f32_32x32x16_bf16 v[112:127], v[28:31], v[204:207], v[112:127]
    buffer_load_dwordx4 v4, s[60:63], s71 offen offset:512 lds
    ds_read_b128 v[28:31], v15 offset:32768
    s_waitcnt lgkmcnt(3)
    v_mfma_f32_32x32x16_bf16 v[96:111], a[128:131], v[16:19], v[96:111]
    s_add_u32 m0, s75, 19840
    v_mfma_f32_32x32x16_bf16 v[112:127], v[16:19], v[208:211], v[112:127]
    buffer_load_dwordx4 v4, s[60:63], s71 offen offset:640 lds
    s_add_u32 s74, s74, 36864
    s_cmp_eq_u32 s74, 147456
    s_cselect_b32 s74, 0, s74
    v_add_u32 v12, s74, v8
    ds_read_b128 v[16:19], v12 offset:0
    s_waitcnt lgkmcnt(3)
    v_mfma_f32_32x32x16_bf16 v[96:111], a[132:135], v[20:23], v[96:111]
    s_add_u32 m0, s75, 23808
    v_mfma_f32_32x32x16_bf16 v[112:127], v[20:23], v[212:215], v[112:127]
    buffer_load_dwordx4 v4, s[60:63], s71 offen offset:768 lds
    v_add_u32 v13, s74, v9
    ds_read_b128 v[20:23], v13 offset:0
    s_waitcnt lgkmcnt(3)
    v_mfma_f32_32x32x16_bf16 v[96:111], a[136:139], v[24:27], v[96:111]
    s_add_u32 m0, s75, 27776
    v_mfma_f32_32x32x16_bf16 v[112:127], v[24:27], v[216:219], v[112:127]
    buffer_load_dwordx4 v4, s[60:63], s71 offen offset:896 lds
    v_add_u32 v14, s74, v10
    ds_read_b128 v[24:27], v14 offset:0
    s_waitcnt lgkmcnt(3)
    v_mfma_f32_32x32x16_bf16 v[96:111], a[140:143], v[28:31], v[96:111]
    s_add_u32 m0, s75, 31744
    v_mfma_f32_32x32x16_bf16 v[112:127], v[28:31], v[220:223], v[112:127]
    buffer_load_dwordx4 v4, s[60:63], s71 offen offset:1024 lds
    s_add_u32 s71, s71, 36864
    s_mov_b32 s76, s72
    s_add_u32 s72, s72, 16384
    s_add_u32 s70, s70, 1
    s_cmp_lt_u32 s70, 64
    s_cbranch_scc1 S1_LOOP0
    s_nop 7
    v_cvt_pk_bf16_f32 v64, v96, v97
    v_cvt_pk_bf16_f32 v65, v98, v99
    v_cvt_pk_bf16_f32 v66, v100, v101
    v_cvt_pk_bf16_f32 v67, v102, v103
    buffer_store_dwordx4 v[64:67], v5, s[44:47], s76 offen offset:0 sc1
    v_cvt_pk_bf16_f32 v68, v104, v105
    v_cvt_pk_bf16_f32 v69, v106, v107
    v_cvt_pk_bf16_f32 v70, v108, v109
    v_cvt_pk_bf16_f32 v71, v110, v111
    buffer_store_dwordx4 v[68:71], v5, s[44:47], s76 offen offset:512 sc1
    v_cvt_pk_bf16_f32 v72, v112, v113
    v_cvt_pk_bf16_f32 v73, v114, v115
    v_cvt_pk_bf16_f32 v74, v116, v117
    v_cvt_pk_bf16_f32 v75, v118, v119
    buffer_store_dwordx4 v[72:75], v6, s[44:47], s76 offen offset:0 sc1
    v_cvt_pk_bf16_f32 v76, v120, v121
    v_cvt_pk_bf16_f32 v77, v122, v123
    v_cvt_pk_bf16_f32 v78, v124, v125
    v_cvt_pk_bf16_f32 v79, v126, v127
    buffer_store_dwordx4 v[76:79], v6, s[44:47], s76 offen offset:512 sc1
    s_waitcnt vmcnt(0)
    s_barrier
    v_mov_b32 v7, 64
    buffer_store_dword v7, off, s[44:47], s73 sc1
    s_mov_b32 s7, 1
    s_waitcnt lgkmcnt(0)
    s_cmp_lt_u32 s5, 24
    s_cbranch_scc1 TO_S3
    s_branch END
.p2align 6
ROLE_S2:
    v_lshlrev_b32 v16, 2, v0
waitd_37:
    buffer_load_dword v17, v16, s[48:51], 0 offen sc1
    s_waitcnt vmcnt(0)
    v_readlane_b32 s98, v17, 51
    s_cmp_ge_u32 s98, 128
    s_cbranch_scc1 waitd_done_38
dno_39:
    s_sleep 8
    s_add_u32 s100, s100, 1
    s_cmp_lt_u32 s100, 262144
    s_cbranch_scc1 spin_ok_40
    s_mov_b32 s98, 1
    s_branch FAIL
spin_ok_40:
    s_branch waitd_37
waitd_done_38:
    s_lshl_b32 s97, s6, 5
    s_add_u32 s97, s97, s5
    s_lshl_b32 s97, s97, 7
    s_add_u32 s97, s97, 8192
hold_41:
    buffer_load_dword v17, off, s[44:47], s97 offset:64 sc1
    s_waitcnt vmcnt(0)
    v_readfirstlane_b32 s99, v17
    s_cmp_ge_u32 s99, 1
    s_cbranch_scc1 hold_41_ok
    s_sleep 16
    s_add_u32 s100, s100, 1
    s_cmp_lt_u32 s100, 262144
    s_cbranch_scc1 spin_ok_42
    s_mov_b32 s98, 13
    s_branch FAIL
spin_ok_42:
    s_branch hold_41
hold_41_ok:
    s_mul_i32 s98, s5, 256
    s_add_u32 s52, s12, s98
    s_addc_u32 s53, s13, 0
    s_and_b32 s53, s53, 0xffff
    s_sub_u32 s54, 4718592, s98
    s_mov_b32 s55, 0x20000
    s_mov_b32 s60, s8
    s_and_b32 s61, s9, 0xffff
    s_mov_b32 s62, 2359296
    s_mov_b32 s63, 0x20000
    s_lshl_b32 s69, s3, 10
    v_lshrrev_b32 v16, 4, v0
    v_and_b32 v17, 15, v0
    v_lshlrev_b32 v18, 2, v16
    v_xor_b32 v18, v18, v17
    v_lshlrev_b32 v18, 4, v18
    s_lshl_b32 s98, s3, 2
    v_add_u32 v19, s98, v16
    v_lshl_add_u32 v1, v19, 13, v18
    v_bfe_u32 v17, v0, 2, 2
    v_lshrrev_b32 v18, 5, v0
    v_lshl_add_u32 v18, v18, 3, v17
    v_lshlrev_b32 v2, 8, v18
    v_bfe_u32 v18, v0, 4, 1
    v_lshlrev_b32 v18, 1, v18
    v_bfe_u32 v19, v0, 1, 1
    v_add3_u32 v18, v18, v19, s98
    v_lshlrev_b32 v17, 2, v17
    v_xor_b32 v18, v18, v17
    v_lshl_add_u32 v2, v18, 4, v2
    v_and_b32 v18, 1, v0
    v_lshl_add_u32 v2, v18, 3, v2
    s_add_u32 m0, s69, 0
    s_mov_b32 s68, 0
    buffer_load_dwordx4 v1, s[52:55], s68 offen nt lds
    s_add_u32 m0, s69, 4096
    s_mov_b32 s68, 131072
    buffer_load_dwordx4 v1, s[52:55], s68 offen nt lds
    s_add_u32 m0, s69, 8192
    s_mov_b32 s68, 262144
    buffer_load_dwordx4 v1, s[52:55], s68 offen nt lds
    s_add_u32 m0, s69, 12288
    s_mov_b32 s68, 393216
    buffer_load_dwordx4 v1, s[52:55], s68 offen nt lds
    s_add_u32 m0, s69, 16384
    s_mov_b32 s68, 524288
    buffer_load_dwordx4 v1, s[52:55], s68 offen nt lds
    s_add_u32 m0, s69, 20480
    s_mov_b32 s68, 655360
    buffer_load_dwordx4 v1, s[52:55], s68 offen nt lds
    s_add_u32 m0, s69, 24576
    s_mov_b32 s68, 786432
    buffer_load_dwordx4 v1, s[52:55], s68 offen nt lds
    s_add_u32 m0, s69, 28672
    s_mov_b32 s68, 917504
    buffer_load_dwordx4 v1, s[52:55], s68 offen nt lds
    s_add_u32 m0, s69, 32768
    s_mov_b32 s68, 1048576
    buffer_load_dwordx4 v1, s[52:55], s68 offen nt lds
    s_add_u32 m0, s69, 36864
    s_mov_b32 s68, 1179648
    buffer_load_dwordx4 v1, s[52:55], s68 offen nt lds
    s_add_u32 m0, s69, 40960
    s_mov_b32 s68, 1310720
    buffer_load_dwordx4 v1, s[52:55], s68 offen nt lds
    s_add_u32 m0, s69, 45056
    s_mov_b32 s68, 1441792
    buffer_load_dwordx4 v1, s[52:55], s68 offen nt lds
    s_add_u32 m0, s69, 49152
    s_mov_b32 s68, 1572864
    buffer_load_dwordx4 v1, s[52:55], s68 offen nt lds
    s_add_u32 m0, s69, 53248
    s_mov_b32 s68, 1703936
    buffer_load_dwordx4 v1, s[52:55], s68 offen nt lds
    s_add_u32 m0, s69, 57344
    s_mov_b32 s68, 1835008
    buffer_load_dwordx4 v1, s[52:55], s68 offen nt lds
    s_add_u32 m0, s69, 61440
    s_mov_b32 s68, 1966080
    buffer_load_dwordx4 v1, s[52:55], s68 offen nt lds
    s_add_u32 m0, s69, 65536
    s_mov_b32 s68, 2097152
    buffer_load_dwordx4 v1, s[52:55], s68 offen nt lds
    s_add_u32 m0, s69, 69632
    s_mov_b32 s68, 2228224
    buffer_load_dwordx4 v1, s[52:55], s68 offen nt lds
    s_add_u32 m0, s69, 73728
    s_mov_b32 s68, 2359296
    buffer_load_dwordx4 v1, s[52:55], s68 offen nt lds
    s_add_u32 m0, s69, 77824
    s_mov_b32 s68, 2490368
    buffer_load_dwordx4 v1, s[52:55], s68 offen nt lds
    s_add_u32 m0, s69, 81920
    s_mov_b32 s68, 2621440
    buffer_load_dwordx4 v1, s[52:55], s68 offen nt lds
    s_add_u32 m0, s69, 86016
    s_mov_b32 s68, 2752512
    buffer_load_dwordx4 v1, s[52:55], s68 offen nt lds
    s_add_u32 m0, s69, 90112
    s_mov_b32 s68, 2883584
    buffer_load_dwordx4 v1, s[52:55], s68 offen nt lds
    s_add_u32 m0, s69, 94208
    s_mov_b32 s68, 3014656
    buffer_load_dwordx4 v1, s[52:55], s68 offen nt lds
    s_add_u32 m0, s69, 98304
    s_mov_b32 s68, 3145728
    buffer_load_dwordx4 v1, s[52:55], s68 offen nt lds
    s_add_u32 m0, s69, 102400
    s_mov_b32 s68, 3276800
    buffer_load_dwordx4 v1, s[52:55], s68 offen nt lds
    s_add_u32 m0, s69, 106496
    s_mov_b32 s68, 3407872
    buffer_load_dwordx4 v1, s[52:55], s68 offen nt lds
    s_add_u32 m0, s69, 110592
    s_mov_b32 s68, 3538944
    buffer_load_dwordx4 v1, s[52:55], s68 offen nt lds
    s_add_u32 m0, s69, 114688
    s_mov_b32 s68, 3670016
    buffer_load_dwordx4 v1, s[52:55], s68 offen nt lds
    s_add_u32 m0, s69, 118784
    s_mov_b32 s68, 3801088
    buffer_load_dwordx4 v1, s[52:55], s68 offen nt lds
    s_add_u32 m0, s69, 122880
    s_mov_b32 s68, 3932160
    buffer_load_dwordx4 v1, s[52:55], s68 offen nt lds
    s_add_u32 m0, s69, 126976
    s_mov_b32 s68, 4063232
    buffer_load_dwordx4 v1, s[52:55], s68 offen nt lds
    s_add_u32 m0, s69, 131072
    s_mov_b32 s68, 4194304
    buffer_load_dwordx4 v1, s[52:55], s68 offen nt lds
    s_add_u32 m0, s69, 135168
    s_mov_b32 s68, 4325376
    buffer_load_dwordx4 v1, s[52:55], s68 offen nt lds
    s_add_u32 m0, s69, 139264
    s_mov_b32 s68, 4456448
    buffer_load_dwordx4 v1, s[52:55], s68 offen nt lds
    s_add_u32 m0, s69, 143360
    s_mov_b32 s68, 4587520
    buffer_load_dwordx4 v1, s[52:55], s68 offen nt lds
    v_and_b32 v16, 31, v0
    v_lshrrev_b32 v17, 5, v0
    v_lshlrev_b32 v7, 4, v0
    v_mul_u32_u24 v18, 1152, v16
    v_lshl_add_u32 v4, v17, 4, v18
    v_bfe_u32 v20, v16, 3, 1
    v_lshlrev_b32 v20, 10, v20
    v_lshl_add_u32 v20, v17, 8, v20
    v_lshrrev_b32 v21, 4, v16
    v_lshl_add_u32 v20, v21, 7, v20
    v_and_b32 v22, 7, v16
    v_lshl_add_u32 v5, v22, 4, v20
    v_lshlrev_b32 v20, 12, v21
    v_lshl_add_u32 v20, v17, 8, v20
    v_and_b32 v22, 15, v16
    v_lshl_add_u32 v20, v22, 4, v20
    v_add_u32 v6, 8192, v20
    s_lshl_b32 s98, s3, 12
    s_add_u32 s98, s98, 147456
    v_and_b32 v20, 15, v0
    v_lshlrev_b32 v20, 4, v20
    v_lshrrev_b32 v23, 4, v0
    v_lshl_add_u32 v20, v23, 2, v20
    v_add_u32 v9, s98, v20
    v_add_u32 v13, 1024, v9
    v_add_u32 v14, 2048, v9
    v_add_u32 v15, 3072, v9
    v_lshlrev_b32 v20, 4, v16
    v_lshl_add_u32 v20, v17, 3, v20
    v_add_u32 v20, s98, v20
    v_add_u32 v8, 2048, v20
    v_bfe_u32 v20, v0, 2, 2
    v_lshl_add_u32 v20, v17, 2, v20
    v_lshlrev_b32 v20, 4, v20
    v_and_b32 v23, 1, v0
    v_lshl_add_u32 v20, v23, 3, v20
    v_add_u32 v10, s98, v20
    v_lshlrev_b32 v20, 2, v17
    v_sub_u32 v11, v16, v20
    v_mov_b32 v12, 3492320863
    s_lshl_b32 s98, s6, 5
    s_add_u32 s98, s98, s5
    s_mul_i32 s98, s98, 65
    s_add_u32 s98, s98, s3
    s_lshl_b32 s72, s98, 14
    s_add_u32 s72, s72, 16777216
    s_lshl_b32 s76, s98, 12
    s_add_u32 s76, s76, 85983232
    s_lshl_b32 s77, s98, 13
    s_add_u32 s77, s77, 104857600
    s_lshl_b32 s98, s6, 5
    s_add_u32 s98, s98, s5
    s_lshl_b32 s98, s98, 7
    s_add_u32 s73, s98, 0
    s_add_u32 s74, s98, 8192
    s_lshl_b32 s99, s3, 2
    s_add_u32 s75, s98, s99
    s_add_u32 s75, s75, 16384
    s_mul_i32 s71, s3, 36864
    s_mov_b32 s70, s3
    s_mov_b32 s78, 0
    s_mov_b32 s80, 0
    s_mov_b32 s79, 1040356334
    s_waitcnt vmcnt(0)
    s_barrier
    v_add_u32 v3, 0, v2
    ds_read_b64_tr_b16 v[64:65], v3 offset:0
    ds_read_b64_tr_b16 v[66:67], v3 offset:1024
    ds_read_b64_tr_b16 v[68:69], v3 offset:4096
    ds_read_b64_tr_b16 v[70:71], v3 offset:5120
    ds_read_b64_tr_b16 v[72:73], v3 offset:8192
    ds_read_b64_tr_b16 v[74:75], v3 offset:9216
    ds_read_b64_tr_b16 v[76:77], v3 offset:12288
    ds_read_b64_tr_b16 v[78:79], v3 offset:13312
    v_add_u32 v3, 16384, v2
    ds_read_b64_tr_b16 v[80:81], v3 offset:0
    ds_read_b64_tr_b16 v[82:83], v3 offset:1024
    ds_read_b64_tr_b16 v[84:85], v3 offset:4096
    ds_read_b64_tr_b16 v[86:87], v3 offset:5120
    ds_read_b64_tr_b16 v[88:89], v3 offset:8192
    ds_read_b64_tr_b16 v[90:91], v3 offset:9216
    ds_read_b64_tr_b16 v[92:93], v3 offset:12288
    ds_read_b64_tr_b16 v[94:95], v3 offset:13312
    v_add_u32 v3, 32768, v2
    ds_read_b64_tr_b16 v[96:97], v3 offset:0
    ds_read_b64_tr_b16 v[98:99], v3 offset:1024
    ds_read_b64_tr_b16 v[100:101], v3 offset:4096
    ds_read_b64_tr_b16 v[102:103], v3 offset:5120
    ds_read_b64_tr_b16 v[104:105], v3 offset:8192
    ds_read_b64_tr_b16 v[106:107], v3 offset:9216
    ds_read_b64_tr_b16 v[108:109], v3 offset:12288
    ds_read_b64_tr_b16 v[110:111], v3 offset:13312
    v_add_u32 v3, 49152, v2
    ds_read_b64_tr_b16 v[112:113], v3 offset:0
    ds_read_b64_tr_b16 v[114:115], v3 offset:1024
    ds_read_b64_tr_b16 v[116:117], v3 offset:4096
    ds_read_b64_tr_b16 v[118:119], v3 offset:5120
    ds_read_b64_tr_b16 v[120:121], v3 offset:8192
    ds_read_b64_tr_b16 v[122:123], v3 offset:9216
    ds_read_b64_tr_b16 v[124:125], v3 offset:12288
    ds_read_b64_tr_b16 v[126:127], v3 offset:13312
    v_add_u32 v3, 65536, v2
    ds_read_b64_tr_b16 v[128:129], v3 offset:0
    ds_read_b64_tr_b16 v[130:131], v3 offset:1024
    ds_read_b64_tr_b16 v[132:133], v3 offset:4096
    ds_read_b64_tr_b16 v[134:135], v3 offset:5120
    ds_read_b64_tr_b16 v[136:137], v3 offset:8192
    ds_read_b64_tr_b16 v[138:139], v3 offset:9216
    ds_read_b64_tr_b16 v[140:141], v3 offset:12288
    ds_read_b64_tr_b16 v[142:143], v3 offset:13312
    v_add_u32 v3, 81920, v2
    ds_read_b64_tr_b16 v[144:145], v3 offset:0
    ds_read_b64_tr_b16 v[146:147], v3 offset:1024
    ds_read_b64_tr_b16 v[148:149], v3 offset:4096
    ds_read_b64_tr_b16 v[150:151], v3 offset:5120
    ds_read_b64_tr_b16 v[152:153], v3 offset:8192
    ds_read_b64_tr_b16 v[154:155], v3 offset:9216
    ds_read_b64_tr_b16 v[156:157], v3 offset:12288
    ds_read_b64_tr_b16 v[158:159], v3 offset:13312
    v_add_u32 v3, 98304, v2
    ds_read_b64_tr_b16 v[160:161], v3 offset:0
    ds_read_b64_tr_b16 v[162:163], v3 offset:1024
    ds_read_b64_tr_b16 v[164:165], v3 offset:4096
    ds_read_b64_tr_b16 v[166:167], v3 offset:5120
    ds_read_b64_tr_b16 v[168:169], v3 offset:8192
    ds_read_b64_tr_b16 v[170:171], v3 offset:9216
    ds_read_b64_tr_b16 v[172:173], v3 offset:12288
    ds_read_b64_tr_b16 v[174:175], v3 offset:13312
    v_add_u32 v3, 114688, v2
    ds_read_b64_tr_b16 v[176:177], v3 offset:0
    ds_read_b64_tr_b16 v[178:179], v3 offset:1024
    ds_read_b64_tr_b16 v[180:181], v3 offset:4096
    ds_read_b64_tr_b16 v[182:183], v3 offset:5120
    ds_read_b64_tr_b16 v[184:185], v3 offset:8192
    ds_read_b64_tr_b16 v[186:187], v3 offset:9216
    ds_read_b64_tr_b16 v[188:189], v3 offset:12288
    ds_read_b64_tr_b16 v[190:191], v3 offset:13312
    v_add_u32 v3, 131072, v2
    ds_read_b64_tr_b16 v[192:193], v3 offset:0
    ds_read_b64_tr_b16 v[194:195], v3 offset:1024
    ds_read_b64_tr_b16 v[196:197], v3 offset:4096
    ds_read_b64_tr_b16 v[198:199], v3 offset:5120
    ds_read_b64_tr_b16 v[200:201], v3 offset:8192
    ds_read_b64_tr_b16 v[202:203], v3 offset:9216
    ds_read_b64_tr_b16 v[204:205], v3 offset:12288
    ds_read_b64_tr_b16 v[206:207], v3 offset:13312
    s_waitcnt lgkmcnt(0)
    s_barrier
    v_mov_b32 v1, v7
    v_add_u32 v2, 0x10000, v7
    v_add_u32 v3, 0x20000, v7
    v_add_u32 v16, s69, v1
    v_add_u32 v17, s69, v2
    v_add_u32 v18, s69, v3
    ds_write_b128 v16, v[64:67] offset:0
    ds_write_b128 v16, v[68:71] offset:4096
    ds_write_b128 v16, v[72:75] offset:8192
    ds_write_b128 v16, v[76:79] offset:12288
    ds_write_b128 v16, v[80:83] offset:16384
    ds_write_b128 v16, v[84:87] offset:20480
    ds_write_b128 v16, v[88:91] offset:24576
    ds_write_b128 v16, v[92:95] offset:28672
    ds_write_b128 v16, v[96:99] offset:32768
    ds_write_b128 v16, v[100:103] offset:36864
    ds_write_b128 v16, v[104:107] offset:40960
    ds_write_b128 v16, v[108:111] offset:45056
    ds_write_b128 v16, v[112:115] offset:49152
    ds_write_b128 v16, v[116:119] offset:53248
    ds_write_b128 v16, v[120:123] offset:57344
    ds_write_b128 v16, v[124:127] offset:61440
    ds_write_b128 v17, v[128:131] offset:0
    ds_write_b128 v17, v[132:135] offset:4096
    ds_write_b128 v17, v[136:139] offset:8192
    ds_write_b128 v17, v[140:143] offset:12288
    ds_write_b128 v17, v[144:147] offset:16384
    ds_write_b128 v17, v[148:151] offset:20480
    ds_write_b128 v17, v[152:155] offset:24576
    ds_write_b128 v17, v[156:159] offset:28672
    ds_write_b128 v17, v[160:163] offset:32768
    ds_write_b128 v17, v[164:167] offset:36864
    ds_write_b128 v17, v[168:171] offset:40960
    ds_write_b128 v17, v[172:175] offset:45056
    ds_write_b128 v17, v[176:179] offset:49152
    ds_write_b128 v17, v[180:183] offset:53248
    ds_write_b128 v17, v[184:187] offset:57344
    ds_write_b128 v17, v[188:191] offset:61440
    ds_write_b128 v18, v[192:195] offset:0
    ds_write_b128 v18, v[196:199] offset:4096
    ds_write_b128 v18, v[200:203] offset:8192
    ds_write_b128 v18, v[204:207] offset:12288
    v_lshlrev_b32 v20, 2, v0
waitd_43:
    buffer_load_dword v21, v20, s[48:51], 0 offen sc1
    s_waitcnt vmcnt(0)
    v_readlane_b32 s98, v21, 51
    s_cmp_ge_u32 s98, 128
    s_cbranch_scc1 waitd_done_44
dno_45:
    s_sleep 8
    s_add_u32 s100, s100, 1
    s_cmp_lt_u32 s100, 262144
    s_cbranch_scc1 spin_ok_46
    s_mov_b32 s98, 1
    s_branch FAIL
spin_ok_46:
    s_branch waitd_43
waitd_done_44:
    v_lshlrev_b32 v20, 7, v0
    s_mov_b32 s68, 147456
S2_XW:
    buffer_load_dword v21, v20, s[44:47], s68 offen sc1
    s_waitcnt vmcnt(0)
    v_cmp_eq_u32 vcc, -1, v21
    s_cbranch_vccz S2_XOK
    s_sleep 8
    s_add_u32 s100, s100, 1
    s_cmp_lt_u32 s100, 262144
    s_cbranch_scc1 spin_ok_47
    s_mov_b32 s98, 12
    s_branch FAIL
spin_ok_47:
    s_branch S2_XW
S2_XOK:
    s_add_u32 s68, s71, 6291456
    buffer_load_dwordx4 a[0:3], v7, s[44:47], s68 offen offset:0 sc1
    buffer_load_dwordx4 a[4:7], v7, s[44:47], s68 offen offset:1024 sc1
    buffer_load_dwordx4 a[8:11], v7, s[44:47], s68 offen offset:2048 sc1
    buffer_load_dwordx4 a[12:15], v7, s[44:47], s68 offen offset:3072 sc1
    s_add_u32 s68, s71, 6295552
    buffer_load_dwordx4 a[16:19], v7, s[44:47], s68 offen offset:0 sc1
    buffer_load_dwordx4 a[20:23], v7, s[44:47], s68 offen offset:1024 sc1
    buffer_load_dwordx4 a[24:27], v7, s[44:47], s68 offen offset:2048 sc1
    buffer_load_dwordx4 a[28:31], v7, s[44:47], s68 offen offset:3072 sc1
    s_add_u32 s68, s71, 6299648
    buffer_load_dwordx4 a[32:35], v7, s[44:47], s68 offen offset:0 sc1
    buffer_load_dwordx4 a[36:39], v7, s[44:47], s68 offen offset:1024 sc1
    buffer_load_dwordx4 a[40:43], v7, s[44:47], s68 offen offset:2048 sc1
    buffer_load_dwordx4 a[44:47], v7, s[44:47], s68 offen offset:3072 sc1
    s_add_u32 s68, s71, 6303744
    buffer_load_dwordx4 a[48:51], v7, s[44:47], s68 offen offset:0 sc1
    buffer_load_dwordx4 a[52:55], v7, s[44:47], s68 offen offset:1024 sc1
    buffer_load_dwordx4 a[56:59], v7, s[44:47], s68 offen offset:2048 sc1
    buffer_load_dwordx4 a[60:63], v7, s[44:47], s68 offen offset:3072 sc1
    s_add_u32 s68, s71, 6307840
    buffer_load_dwordx4 a[64:67], v7, s[44:47], s68 offen offset:0 sc1
    buffer_load_dwordx4 a[68:71], v7, s[44:47], s68 offen offset:1024 sc1
    buffer_load_dwordx4 a[72:75], v7, s[44:47], s68 offen offset:2048 sc1
    buffer_load_dwordx4 a[76:79], v7, s[44:47], s68 offen offset:3072 sc1
    s_add_u32 s68, s71, 6311936
    buffer_load_dwordx4 a[80:83], v7, s[44:47], s68 offen offset:0 sc1
    buffer_load_dwordx4 a[84:87], v7, s[44:47], s68 offen offset:1024 sc1
    buffer_load_dwordx4 a[88:91], v7, s[44:47], s68 offen offset:2048 sc1
    buffer_load_dwordx4 a[92:95], v7, s[44:47], s68 offen offset:3072 sc1
    s_add_u32 s68, s71, 6316032
    buffer_load_dwordx4 a[96:99], v7, s[44:47], s68 offen offset:0 sc1
    buffer_load_dwordx4 a[100:103], v7, s[44:47], s68 offen offset:1024 sc1
    buffer_load_dwordx4 a[104:107], v7, s[44:47], s68 offen offset:2048 sc1
    buffer_load_dwordx4 a[108:111], v7, s[44:47], s68 offen offset:3072 sc1
    s_add_u32 s68, s71, 6320128
    buffer_load_dwordx4 a[112:115], v7, s[44:47], s68 offen offset:0 sc1
    buffer_load_dwordx4 a[116:119], v7, s[44:47], s68 offen offset:1024 sc1
    buffer_load_dwordx4 a[120:123], v7, s[44:47], s68 offen offset:2048 sc1
    buffer_load_dwordx4 a[124:127], v7, s[44:47], s68 offen offset:3072 sc1
    s_add_u32 s68, s71, 6324224
    buffer_load_dwordx4 a[128:131], v7, s[44:47], s68 offen offset:0 sc1
    buffer_load_dwordx4 a[132:135], v7, s[44:47], s68 offen offset:1024 sc1
    buffer_load_dwordx4 a[136:139], v7, s[44:47], s68 offen offset:2048 sc1
    buffer_load_dwordx4 a[140:143], v7, s[44:47], s68 offen offset:3072 sc1
    s_add_u32 s71, s71, 147456
    s_cmp_lt_u32 s71, 2359296
    s_cselect_b32 s71, s71, 1073741824
    s_waitcnt lgkmcnt(0)
    s_barrier
S2_LOOP:
    s_cmp_gt_u32 s78, s70
    s_cbranch_scc1 S2_KVOK
S2_KVPOLL:
    buffer_load_dword v48, off, s[44:47], s73 sc1
    s_waitcnt vmcnt(0)
    v_readfirstlane_b32 s78, v48
    s_cmp_gt_u32 s78, s70
    s_cbranch_scc1 S2_KVOK
    s_sleep 4
    s_add_u32 s100, s100, 1
    s_cmp_lt_u32 s100, 262144
    s_cbranch_scc1 spin_ok_48
    s_mov_b32 s98, 7
    s_branch FAIL
spin_ok_48:
    s_branch S2_KVPOLL
S2_KVOK:
    s_add_u32 s98, s72, 4096
    buffer_load_dwordx4 a[144:147], v5, s[44:47], s72 offen offset:0 sc1
    buffer_load_dwordx4 a[148:151], v5, s[44:47], s72 offen offset:512 sc1
    buffer_load_dwordx4 a[152:155], v5, s[44:47], s72 offen offset:2048 sc1
    buffer_load_dwordx4 a[156:159], v5, s[44:47], s72 offen offset:2560 sc1
    buffer_load_dwordx4 a[160:163], v5, s[44:47], s98 offen offset:0 sc1
    buffer_load_dwordx4 a[164:167], v5, s[44:47], s98 offen offset:512 sc1
    buffer_load_dwordx4 a[168:171], v5, s[44:47], s98 offen offset:2048 sc1
    buffer_load_dwordx4 a[172:175], v5, s[44:47], s98 offen offset:2560 sc1
    buffer_load_dwordx4 a[176:179], v6, s[44:47], s72 offen offset:0 sc1
    buffer_load_dwordx4 a[180:183], v6, s[44:47], s72 offen offset:512 sc1
    buffer_load_dwordx4 a[184:187], v6, s[44:47], s72 offen offset:1024 sc1
    buffer_load_dwordx4 a[188:191], v6, s[44:47], s72 offen offset:1536 sc1
    buffer_load_dwordx4 a[192:195], v6, s[44:47], s72 offen offset:2048 sc1
    buffer_load_dwordx4 a[196:199], v6, s[44:47], s72 offen offset:2560 sc1
    buffer_load_dwordx4 a[200:203], v6, s[44:47], s72 offen offset:3072 sc1
    buffer_load_dwordx4 a[204:207], v6, s[44:47], s72 offen offset:3584 sc1
    s_add_u32 s72, s72, 65536
    ds_read_b128 v[16:19], v1 offset:0
    ds_read_b128 v[20:23], v1 offset:1024
    ds_read_b128 v[24:27], v1 offset:2048
    ds_read_b128 v[28:31], v1 offset:3072
    ds_read_b128 v[32:35], v1 offset:4096
    ds_read_b128 v[36:39], v1 offset:5120
    ds_read_b128 v[40:43], v1 offset:6144
    s_waitcnt vmcnt(16)
    ds_read_b128 v[44:47], v1 offset:7168
    s_waitcnt lgkmcnt(7)
    v_mfma_f32_32x32x16_bf16 v[64:79], v[16:19], a[0:3], 0
    ds_read_b128 v[16:19], v1 offset:8192
    s_waitcnt lgkmcnt(7)
    v_mfma_f32_32x32x16_bf16 v[80:95], v[20:23], a[0:3], 0
    ds_read_b128 v[20:23], v1 offset:9216
    s_waitcnt lgkmcnt(7)
    v_mfma_f32_32x32x16_bf16 v[96:111], v[24:27], a[0:3], 0
    ds_read_b128 v[24:27], v1 offset:10240
    s_waitcnt lgkmcnt(7)
    v_mfma_f32_32x32x16_bf16 v[112:127], v[28:31], a[0:3], 0
    ds_read_b128 v[28:31], v1 offset:11264
    s_waitcnt lgkmcnt(7)
    v_mfma_f32_32x32x16_bf16 v[64:79], v[32:35], a[4:7], v[64:79]
    ds_read_b128 v[32:35], v1 offset:12288
    s_waitcnt lgkmcnt(7)
    v_mfma_f32_32x32x16_bf16 v[80:95], v[36:39], a[4:7], v[80:95]
    ds_read_b128 v[36:39], v1 offset:13312
    s_waitcnt lgkmcnt(7)
    v_mfma_f32_32x32x16_bf16 v[96:111], v[40:43], a[4:7], v[96:111]
    ds_read_b128 v[40:43], v1 offset:14336
    s_waitcnt lgkmcnt(7)
    v_mfma_f32_32x32x16_bf16 v[112:127], v[44:47], a[4:7], v[112:127]
    ds_read_b128 v[44:47], v1 offset:15360
    s_waitcnt lgkmcnt(7)
    v_mfma_f32_32x32x16_bf16 v[64:79], v[16:19], a[8:11], v[64:79]
    ds_read_b128 v[16:19], v1 offset:16384
    s_waitcnt lgkmcnt(7)
    v_mfma_f32_32x32x16_bf16 v[80:95], v[20:23], a[8:11], v[80:95]
    ds_read_b128 v[20:23], v1 offset:17408
    s_waitcnt lgkmcnt(7)
    v_mfma_f32_32x32x16_bf16 v[96:111], v[24:27], a[8:11], v[96:111]
    ds_read_b128 v[24:27], v1 offset:18432
    s_waitcnt lgkmcnt(7)
    v_mfma_f32_32x32x16_bf16 v[112:127], v[28:31], a[8:11], v[112:127]
    ds_read_b128 v[28:31], v1 offset:19456
    s_waitcnt lgkmcnt(7)
    v_mfma_f32_32x32x16_bf16 v[64:79], v[32:35], a[12:15], v[64:79]
    ds_read_b128 v[32:35], v1 offset:20480
    s_waitcnt lgkmcnt(7)
    v_mfma_f32_32x32x16_bf16 v[80:95], v[36:39], a[12:15], v[80:95]
    ds_read_b128 v[36:39], v1 offset:21504
    s_waitcnt lgkmcnt(7)
    v_mfma_f32_32x32x16_bf16 v[96:111], v[40:43], a[12:15], v[96:111]
    ds_read_b128 v[40:43], v1 offset:22528
    s_waitcnt lgkmcnt(7)
    v_mfma_f32_32x32x16_bf16 v[112:127], v[44:47], a[12:15], v[112:127]
    ds_read_b128 v[44:47], v1 offset:23552
    s_waitcnt lgkmcnt(7)
    v_mfma_f32_32x32x16_bf16 v[64:79], v[16:19], a[16:19], v[64:79]
    ds_read_b128 v[16:19], v1 offset:24576
    s_waitcnt lgkmcnt(7)
    v_mfma_f32_32x32x16_bf16 v[80:95], v[20:23], a[16:19], v[80:95]
    ds_read_b128 v[20:23], v1 offset:25600
    s_waitcnt lgkmcnt(7)
    v_mfma_f32_32x32x16_bf16 v[96:111], v[24:27], a[16:19], v[96:111]
    ds_read_b128 v[24:27], v1 offset:26624
    s_waitcnt lgkmcnt(7)
    v_mfma_f32_32x32x16_bf16 v[112:127], v[28:31], a[16:19], v[112:127]
    ds_read_b128 v[28:31], v1 offset:27648
    s_waitcnt lgkmcnt(7)
    v_mfma_f32_32x32x16_bf16 v[64:79], v[32:35], a[20:23], v[64:79]
    ds_read_b128 v[32:35], v1 offset:28672
    s_waitcnt lgkmcnt(7)
    v_mfma_f32_32x32x16_bf16 v[80:95], v[36:39], a[20:23], v[80:95]
    ds_read_b128 v[36:39], v1 offset:29696
    s_waitcnt lgkmcnt(7)
    v_mfma_f32_32x32x16_bf16 v[96:111], v[40:43], a[20:23], v[96:111]
    ds_read_b128 v[40:43], v1 offset:30720
    s_waitcnt lgkmcnt(7)
    v_mfma_f32_32x32x16_bf16 v[112:127], v[44:47], a[20:23], v[112:127]
    ds_read_b128 v[44:47], v1 offset:31744
    s_waitcnt lgkmcnt(7)
    v_mfma_f32_32x32x16_bf16 v[64:79], v[16:19], a[24:27], v[64:79]
    ds_read_b128 v[16:19], v1 offset:32768
    s_waitcnt lgkmcnt(7)
    v_mfma_f32_32x32x16_bf16 v[80:95], v[20:23], a[24:27], v[80:95]
    ds_read_b128 v[20:23], v1 offset:33792
    s_waitcnt lgkmcnt(7)
    v_mfma_f32_32x32x16_bf16 v[96:111], v[24:27], a[24:27], v[96:111]
    ds_read_b128 v[24:27], v1 offset:34816
    s_waitcnt lgkmcnt(7)
    v_mfma_f32_32x32x16_bf16 v[112:127], v[28:31], a[24:27], v[112:127]
    ds_read_b128 v[28:31], v1 offset:35840
    s_waitcnt lgkmcnt(7)
    v_mfma_f32_32x32x16_bf16 v[64:79], v[32:35], a[28:31], v[64:79]
    ds_read_b128 v[32:35], v1 offset:36864
    s_waitcnt lgkmcnt(7)
    v_mfma_f32_32x32x16_bf16 v[80:95], v[36:39], a[28:31], v[80:95]
    ds_read_b128 v[36:39], v1 offset:37888
    s_waitcnt lgkmcnt(7)
    v_mfma_f32_32x32x16_bf16 v[96:111], v[40:43], a[28:31], v[96:111]
    ds_read_b128 v[40:43], v1 offset:38912
    s_waitcnt lgkmcnt(7)
    v_mfma_f32_32x32x16_bf16 v[112:127], v[44:47], a[28:31], v[112:127]
    ds_read_b128 v[44:47], v1 offset:39936
    s_waitcnt lgkmcnt(7)
    v_mfma_f32_32x32x16_bf16 v[64:79], v[16:19], a[32:35], v[64:79]
    ds_read_b128 v[16:19], v1 offset:40960
    s_waitcnt lgkmcnt(7)
    v_mfma_f32_32x32x16_bf16 v[80:95], v[20:23], a[32:35], v[80:95]
    ds_read_b128 v[20:23], v1 offset:41984
    s_waitcnt lgkmcnt(7)
    v_mfma_f32_32x32x16_bf16 v[96:111], v[24:27], a[32:35], v[96:111]
    ds_read_b128 v[24:27], v1 offset:43008
    s_waitcnt lgkmcnt(7)
    v_mfma_f32_32x32x16_bf16 v[112:127], v[28:31], a[32:35], v[112:127]
    ds_read_b128 v[28:31], v1 offset:44032
    s_waitcnt lgkmcnt(7)
    v_mfma_f32_32x32x16_bf16 v[64:79], v[32:35], a[36:39], v[64:79]
    ds_read_b128 v[32:35], v1 offset:45056
    s_waitcnt lgkmcnt(7)
    v_mfma_f32_32x32x16_bf16 v[80:95], v[36:39], a[36:39], v[80:95]
    ds_read_b128 v[36:39], v1 offset:46080
    s_waitcnt lgkmcnt(7)
    v_mfma_f32_32x32x16_bf16 v[96:111], v[40:43], a[36:39], v[96:111]
    ds_read_b128 v[40:43], v1 offset:47104
    s_waitcnt lgkmcnt(7)
    v_mfma_f32_32x32x16_bf16 v[112:127], v[44:47], a[36:39], v[112:127]
    ds_read_b128 v[44:47], v1 offset:48128
    s_waitcnt lgkmcnt(7)
    v_mfma_f32_32x32x16_bf16 v[64:79], v[16:19], a[40:43], v[64:79]
    ds_read_b128 v[16:19], v1 offset:49152
    s_waitcnt lgkmcnt(7)
    v_mfma_f32_32x32x16_bf16 v[80:95], v[20:23], a[40:43], v[80:95]
    ds_read_b128 v[20:23], v1 offset:50176
    s_waitcnt lgkmcnt(7)
    v_mfma_f32_32x32x16_bf16 v[96:111], v[24:27], a[40:43], v[96:111]
    ds_read_b128 v[24:27], v1 offset:51200
    s_waitcnt lgkmcnt(7)
    v_mfma_f32_32x32x16_bf16 v[112:127], v[28:31], a[40:43], v[112:127]
    ds_read_b128 v[28:31], v1 offset:52224
    s_waitcnt lgkmcnt(7)
    v_mfma_f32_32x32x16_bf16 v[64:79], v[32:35], a[44:47], v[64:79]
    ds_read_b128 v[32:35], v1 offset:53248
    s_waitcnt lgkmcnt(7)
    v_mfma_f32_32x32x16_bf16 v[80:95], v[36:39], a[44:47], v[80:95]
    ds_read_b128 v[36:39], v1 offset:54272
    s_waitcnt lgkmcnt(7)
    v_mfma_f32_32x32x16_bf16 v[96:111], v[40:43], a[44:47], v[96:111]
    ds_read_b128 v[40:43], v1 offset:55296
    s_waitcnt lgkmcnt(7)
    v_mfma_f32_32x32x16_bf16 v[112:127], v[44:47], a[44:47], v[112:127]
    ds_read_b128 v[44:47], v1 offset:56320
    s_waitcnt lgkmcnt(7)
    v_mfma_f32_32x32x16_bf16 v[64:79], v[16:19], a[48:51], v[64:79]
    ds_read_b128 v[16:19], v1 offset:57344
    s_waitcnt lgkmcnt(7)
    v_mfma_f32_32x32x16_bf16 v[80:95], v[20:23], a[48:51], v[80:95]
    ds_read_b128 v[20:23], v1 offset:58368
    s_waitcnt lgkmcnt(7)
    v_mfma_f32_32x32x16_bf16 v[96:111], v[24:27], a[48:51], v[96:111]
    ds_read_b128 v[24:27], v1 offset:59392
    s_waitcnt lgkmcnt(7)
    v_mfma_f32_32x32x16_bf16 v[112:127], v[28:31], a[48:51], v[112:127]
    ds_read_b128 v[28:31], v1 offset:60416
    s_waitcnt lgkmcnt(7)
    v_mfma_f32_32x32x16_bf16 v[64:79], v[32:35], a[52:55], v[64:79]
    ds_read_b128 v[32:35], v1 offset:61440
    s_waitcnt lgkmcnt(7)
    v_mfma_f32_32x32x16_bf16 v[80:95], v[36:39], a[52:55], v[80:95]
    ds_read_b128 v[36:39], v1 offset:62464
    s_waitcnt lgkmcnt(7)
    v_mfma_f32_32x32x16_bf16 v[96:111], v[40:43], a[52:55], v[96:111]
    ds_read_b128 v[40:43], v1 offset:63488
    s_waitcnt lgkmcnt(7)
    v_mfma_f32_32x32x16_bf16 v[112:127], v[44:47], a[52:55], v[112:127]
    ds_read_b128 v[44:47], v1 offset:64512
    s_waitcnt lgkmcnt(7)
    v_mfma_f32_32x32x16_bf16 v[64:79], v[16:19], a[56:59], v[64:79]
    ds_read_b128 v[16:19], v2 offset:0
    s_waitcnt lgkmcnt(7)
    v_mfma_f32_32x32x16_bf16 v[80:95], v[20:23], a[56:59], v[80:95]
    ds_read_b128 v[20:23], v2 offset:1024
    s_waitcnt lgkmcnt(7)
    v_mfma_f32_32x32x16_bf16 v[96:111], v[24:27], a[56:59], v[96:111]
    ds_read_b128 v[24:27], v2 offset:2048
    s_waitcnt lgkmcnt(7)
    v_mfma_f32_32x32x16_bf16 v[112:127], v[28:31], a[56:59], v[112:127]
    ds_read_b128 v[28:31], v2 offset:3072
    s_waitcnt lgkmcnt(7)
    v_mfma_f32_32x32x16_bf16 v[64:79], v[32:35], a[60:63], v[64:79]
    ds_read_b128 v[32:35], v2 offset:4096
    s_waitcnt lgkmcnt(7)
    v_mfma_f32_32x32x16_bf16 v[80:95], v[36:39], a[60:63], v[80:95]
    ds_read_b128 v[36:39], v2 offset:5120
    s_waitcnt lgkmcnt(7)
    v_mfma_f32_32x32x16_bf16 v[96:111], v[40:43], a[60:63], v[96:111]
    ds_read_b128 v[40:43], v2 offset:6144
    s_waitcnt lgkmcnt(7)
    v_mfma_f32_32x32x16_bf16 v[112:127], v[44:47], a[60:63], v[112:127]
    ds_read_b128 v[44:47], v2 offset:7168
    s_waitcnt lgkmcnt(7)
    v_mfma_f32_32x32x16_bf16 v[64:79], v[16:19], a[64:67], v[64:79]
    ds_read_b128 v[16:19], v2 offset:8192
    s_waitcnt lgkmcnt(7)
    v_mfma_f32_32x32x16_bf16 v[80:95], v[20:23], a[64:67], v[80:95]
    ds_read_b128 v[20:23], v2 offset:9216
    s_waitcnt lgkmcnt(7)
    v_mfma_f32_32x32x16_bf16 v[96:111], v[24:27], a[64:67], v[96:111]
    ds_read_b128 v[24:27], v2 offset:10240
    s_waitcnt lgkmcnt(7)
    v_mfma_f32_32x32x16_bf16 v[112:127], v[28:31], a[64:67], v[112:127]
    ds_read_b128 v[28:31], v2 offset:11264
    s_waitcnt lgkmcnt(7)
    v_mfma_f32_32x32x16_bf16 v[64:79], v[32:35], a[68:71], v[64:79]
    ds_read_b128 v[32:35], v2 offset:12288
    s_waitcnt lgkmcnt(7)
    v_mfma_f32_32x32x16_bf16 v[80:95], v[36:39], a[68:71], v[80:95]
    ds_read_b128 v[36:39], v2 offset:13312
    s_waitcnt lgkmcnt(7)
    v_mfma_f32_32x32x16_bf16 v[96:111], v[40:43], a[68:71], v[96:111]
    ds_read_b128 v[40:43], v2 offset:14336
    s_waitcnt lgkmcnt(7)
    v_mfma_f32_32x32x16_bf16 v[112:127], v[44:47], a[68:71], v[112:127]
    ds_read_b128 v[44:47], v2 offset:15360
    s_waitcnt lgkmcnt(7)
    v_mfma_f32_32x32x16_bf16 v[64:79], v[16:19], a[72:75], v[64:79]
    ds_read_b128 v[16:19], v2 offset:16384
    s_waitcnt lgkmcnt(7)
    v_mfma_f32_32x32x16_bf16 v[80:95], v[20:23], a[72:75], v[80:95]
    ds_read_b128 v[20:23], v2 offset:17408
    s_waitcnt lgkmcnt(7)
    v_mfma_f32_32x32x16_bf16 v[96:111], v[24:27], a[72:75], v[96:111]
    ds_read_b128 v[24:27], v2 offset:18432
    s_waitcnt lgkmcnt(7)
    v_mfma_f32_32x32x16_bf16 v[112:127], v[28:31], a[72:75], v[112:127]
    ds_read_b128 v[28:31], v2 offset:19456
    s_waitcnt lgkmcnt(7)
    v_mfma_f32_32x32x16_bf16 v[64:79], v[32:35], a[76:79], v[64:79]
    ds_read_b128 v[32:35], v2 offset:20480
    s_waitcnt lgkmcnt(7)
    v_mfma_f32_32x32x16_bf16 v[80:95], v[36:39], a[76:79], v[80:95]
    ds_read_b128 v[36:39], v2 offset:21504
    s_waitcnt lgkmcnt(7)
    v_mfma_f32_32x32x16_bf16 v[96:111], v[40:43], a[76:79], v[96:111]
    ds_read_b128 v[40:43], v2 offset:22528
    s_waitcnt lgkmcnt(7)
    v_mfma_f32_32x32x16_bf16 v[112:127], v[44:47], a[76:79], v[112:127]
    ds_read_b128 v[44:47], v2 offset:23552
    s_waitcnt lgkmcnt(7)
    v_mfma_f32_32x32x16_bf16 v[64:79], v[16:19], a[80:83], v[64:79]
    ds_read_b128 v[16:19], v2 offset:24576
    s_waitcnt lgkmcnt(7)
    v_mfma_f32_32x32x16_bf16 v[80:95], v[20:23], a[80:83], v[80:95]
    ds_read_b128 v[20:23], v2 offset:25600
    s_waitcnt lgkmcnt(7)
    v_mfma_f32_32x32x16_bf16 v[96:111], v[24:27], a[80:83], v[96:111]
    ds_read_b128 v[24:27], v2 offset:26624
    s_waitcnt lgkmcnt(7)
    v_mfma_f32_32x32x16_bf16 v[112:127], v[28:31], a[80:83], v[112:127]
    ds_read_b128 v[28:31], v2 offset:27648
    s_waitcnt lgkmcnt(7)
    v_mfma_f32_32x32x16_bf16 v[64:79], v[32:35], a[84:87], v[64:79]
    ds_read_b128 v[32:35], v2 offset:28672
    s_waitcnt lgkmcnt(7)
    v_mfma_f32_32x32x16_bf16 v[80:95], v[36:39], a[84:87], v[80:95]
    ds_read_b128 v[36:39], v2 offset:29696
    s_waitcnt lgkmcnt(7)
    v_mfma_f32_32x32x16_bf16 v[96:111], v[40:43], a[84:87], v[96:111]
    ds_read_b128 v[40:43], v2 offset:30720
    s_waitcnt lgkmcnt(7)
    v_mfma_f32_32x32x16_bf16 v[112:127], v[44:47], a[84:87], v[112:127]
    ds_read_b128 v[44:47], v2 offset:31744
    s_waitcnt lgkmcnt(7)
    v_mfma_f32_32x32x16_bf16 v[64:79], v[16:19], a[88:91], v[64:79]
    ds_read_b128 v[16:19], v2 offset:32768
    s_waitcnt lgkmcnt(7)
    v_mfma_f32_32x32x16_bf16 v[80:95], v[20:23], a[88:91], v[80:95]
    ds_read_b128 v[20:23], v2 offset:33792
    s_waitcnt lgkmcnt(7)
    v_mfma_f32_32x32x16_bf16 v[96:111], v[24:27], a[88:91], v[96:111]
    ds_read_b128 v[24:27], v2 offset:34816
    s_waitcnt lgkmcnt(7)
    v_mfma_f32_32x32x16_bf16 v[112:127], v[28:31], a[88:91], v[112:127]
    ds_read_b128 v[28:31], v2 offset:35840
    s_waitcnt lgkmcnt(7)
    v_mfma_f32_32x32x16_bf16 v[64:79], v[32:35], a[92:95], v[64:79]
    ds_read_b128 v[32:35], v2 offset:36864
    s_waitcnt lgkmcnt(7)
    v_mfma_f32_32x32x16_bf16 v[80:95], v[36:39], a[92:95], v[80:95]
    ds_read_b128 v[36:39], v2 offset:37888
    s_waitcnt lgkmcnt(7)
    v_mfma_f32_32x32x16_bf16 v[96:111], v[40:43], a[92:95], v[96:111]
    ds_read_b128 v[40:43], v2 offset:38912
    s_waitcnt lgkmcnt(7)
    v_mfma_f32_32x32x16_bf16 v[112:127], v[44:47], a[92:95], v[112:127]
    ds_read_b128 v[44:47], v2 offset:39936
    s_waitcnt lgkmcnt(7)
    v_mfma_f32_32x32x16_bf16 v[64:79], v[16:19], a[96:99], v[64:79]
    ds_read_b128 v[16:19], v2 offset:40960
    s_waitcnt lgkmcnt(7)
    v_mfma_f32_32x32x16_bf16 v[80:95], v[20:23], a[96:99], v[80:95]
    ds_read_b128 v[20:23], v2 offset:41984
    s_waitcnt lgkmcnt(7)
    v_mfma_f32_32x32x16_bf16 v[96:111], v[24:27], a[96:99], v[96:111]
    ds_read_b128 v[24:27], v2 offset:43008
    s_waitcnt lgkmcnt(7)
    v_mfma_f32_32x32x16_bf16 v[112:127], v[28:31], a[96:99], v[112:127]
    ds_read_b128 v[28:31], v2 offset:44032
    s_waitcnt lgkmcnt(7)
    v_mfma_f32_32x32x16_bf16 v[64:79], v[32:35], a[100:103], v[64:79]
    ds_read_b128 v[32:35], v2 offset:45056
    s_waitcnt lgkmcnt(7)
    v_mfma_f32_32x32x16_bf16 v[80:95], v[36:39], a[100:103], v[80:95]
    ds_read_b128 v[36:39], v2 offset:46080
    s_waitcnt lgkmcnt(7)
    v_mfma_f32_32x32x16_bf16 v[96:111], v[40:43], a[100:103], v[96:111]
    ds_read_b128 v[40:43], v2 offset:47104
    s_waitcnt lgkmcnt(7)
    v_mfma_f32_32x32x16_bf16 v[112:127], v[44:47], a[100:103], v[112:127]
    ds_read_b128 v[44:47], v2 offset:48128
    s_waitcnt lgkmcnt(7)
    v_mfma_f32_32x32x16_bf16 v[64:79], v[16:19], a[104:107], v[64:79]
    ds_read_b128 v[16:19], v2 offset:49152
    s_waitcnt lgkmcnt(7)
    v_mfma_f32_32x32x16_bf16 v[80:95], v[20:23], a[104:107], v[80:95]
    ds_read_b128 v[20:23], v2 offset:50176
    s_waitcnt lgkmcnt(7)
    v_mfma_f32_32x32x16_bf16 v[96:111], v[24:27], a[104:107], v[96:111]
    ds_read_b128 v[24:27], v2 offset:51200
    s_waitcnt lgkmcnt(7)
    v_mfma_f32_32x32x16_bf16 v[112:127], v[28:31], a[104:107], v[112:127]
    ds_read_b128 v[28:31], v2 offset:52224
    s_waitcnt lgkmcnt(7)
    v_mfma_f32_32x32x16_bf16 v[64:79], v[32:35], a[108:111], v[64:79]
    ds_read_b128 v[32:35], v2 offset:53248
    s_waitcnt lgkmcnt(7)
    v_mfma_f32_32x32x16_bf16 v[80:95], v[36:39], a[108:111], v[80:95]
    ds_read_b128 v[36:39], v2 offset:54272
    s_waitcnt lgkmcnt(7)
    v_mfma_f32_32x32x16_bf16 v[96:111], v[40:43], a[108:111], v[96:111]
    ds_read_b128 v[40:43], v2 offset:55296
    s_waitcnt lgkmcnt(7)
    v_mfma_f32_32x32x16_bf16 v[112:127], v[44:47], a[108:111], v[112:127]
    ds_read_b128 v[44:47], v2 offset:56320
    s_waitcnt lgkmcnt(7)
    v_mfma_f32_32x32x16_bf16 v[64:79], v[16:19], a[112:115], v[64:79]
    ds_read_b128 v[16:19], v2 offset:57344
    s_waitcnt lgkmcnt(7)
    v_mfma_f32_32x32x16_bf16 v[80:95], v[20:23], a[112:115], v[80:95]
    ds_read_b128 v[20:23], v2 offset:58368
    s_waitcnt lgkmcnt(7)
    v_mfma_f32_32x32x16_bf16 v[96:111], v[24:27], a[112:115], v[96:111]
    ds_read_b128 v[24:27], v2 offset:59392
    s_waitcnt lgkmcnt(7)
    v_mfma_f32_32x32x16_bf16 v[112:127], v[28:31], a[112:115], v[112:127]
    ds_read_b128 v[28:31], v2 offset:60416
    s_waitcnt lgkmcnt(7)
    v_mfma_f32_32x32x16_bf16 v[64:79], v[32:35], a[116:119], v[64:79]
    ds_read_b128 v[32:35], v2 offset:61440
    s_waitcnt lgkmcnt(7)
    v_mfma_f32_32x32x16_bf16 v[80:95], v[36:39], a[116:119], v[80:95]
    ds_read_b128 v[36:39], v2 offset:62464
    s_waitcnt lgkmcnt(7)
    v_mfma_f32_32x32x16_bf16 v[96:111], v[40:43], a[116:119], v[96:111]
    ds_read_b128 v[40:43], v2 offset:63488
    s_waitcnt lgkmcnt(7)
    v_mfma_f32_32x32x16_bf16 v[112:127], v[44:47], a[116:119], v[112:127]
    ds_read_b128 v[44:47], v2 offset:64512
    s_waitcnt lgkmcnt(7)
    v_mfma_f32_32x32x16_bf16 v[64:79], v[16:19], a[120:123], v[64:79]
    ds_read_b128 v[16:19], v3 offset:0
    s_waitcnt lgkmcnt(7)
    v_mfma_f32_32x32x16_bf16 v[80:95], v[20:23], a[120:123], v[80:95]
    ds_read_b128 v[20:23], v3 offset:1024
    s_waitcnt lgkmcnt(7)
    v_mfma_f32_32x32x16_bf16 v[96:111], v[24:27], a[120:123], v[96:111]
    ds_read_b128 v[24:27], v3 offset:2048
    s_waitcnt lgkmcnt(7)
    v_mfma_f32_32x32x16_bf16 v[112:127], v[28:31], a[120:123], v[112:127]
    ds_read_b128 v[28:31], v3 offset:3072
    s_waitcnt lgkmcnt(7)
    v_mfma_f32_32x32x16_bf16 v[64:79], v[32:35], a[124:127], v[64:79]
    ds_read_b128 v[32:35], v3 offset:4096
    s_waitcnt lgkmcnt(7)
    v_mfma_f32_32x32x16_bf16 v[80:95], v[36:39], a[124:127], v[80:95]
    ds_read_b128 v[36:39], v3 offset:5120
    s_waitcnt lgkmcnt(7)
    v_mfma_f32_32x32x16_bf16 v[96:111], v[40:43], a[124:127], v[96:111]
    ds_read_b128 v[40:43], v3 offset:6144
    s_waitcnt lgkmcnt(7)
    v_mfma_f32_32x32x16_bf16 v[112:127], v[44:47], a[124:127], v[112:127]
    ds_read_b128 v[44:47], v3 offset:7168
    s_waitcnt lgkmcnt(7)
    v_mfma_f32_32x32x16_bf16 v[64:79], v[16:19], a[128:131], v[64:79]
    ds_read_b128 v[16:19], v3 offset:8192
    s_waitcnt lgkmcnt(7)
    v_mfma_f32_32x32x16_bf16 v[80:95], v[20:23], a[128:131], v[80:95]
    ds_read_b128 v[20:23], v3 offset:9216
    s_waitcnt lgkmcnt(7)
    v_mfma_f32_32x32x16_bf16 v[96:111], v[24:27], a[128:131], v[96:111]
    ds_read_b128 v[24:27], v3 offset:10240
    s_waitcnt lgkmcnt(7)
    v_mfma_f32_32x32x16_bf16 v[112:127], v[28:31], a[128:131], v[112:127]
    ds_read_b128 v[28:31], v3 offset:11264
    s_waitcnt lgkmcnt(7)
    v_mfma_f32_32x32x16_bf16 v[64:79], v[32:35], a[132:135], v[64:79]
    ds_read_b128 v[32:35], v3 offset:12288
    s_waitcnt lgkmcnt(7)
    v_mfma_f32_32x32x16_bf16 v[80:95], v[36:39], a[132:135], v[80:95]
    ds_read_b128 v[36:39], v3 offset:13312
    s_waitcnt lgkmcnt(7)
    v_mfma_f32_32x32x16_bf16 v[96:111], v[40:43], a[132:135], v[96:111]
    ds_read_b128 v[40:43], v3 offset:14336
    s_waitcnt lgkmcnt(7)
    v_mfma_f32_32x32x16_bf16 v[112:127], v[44:47], a[132:135], v[112:127]
    ds_read_b128 v[44:47], v3 offset:15360
    s_waitcnt lgkmcnt(7)
    v_mfma_f32_32x32x16_bf16 v[64:79], v[16:19], a[136:139], v[64:79]
    s_waitcnt lgkmcnt(6)
    v_mfma_f32_32x32x16_bf16 v[80:95], v[20:23], a[136:139], v[80:95]
    s_waitcnt lgkmcnt(5)
    v_mfma_f32_32x32x16_bf16 v[96:111], v[24:27], a[136:139], v[96:111]
    s_waitcnt lgkmcnt(4)
    v_mfma_f32_32x32x16_bf16 v[112:127], v[28:31], a[136:139], v[112:127]
    s_waitcnt lgkmcnt(3)
    v_mfma_f32_32x32x16_bf16 v[64:79], v[32:35], a[140:143], v[64:79]
    s_waitcnt lgkmcnt(2)
    v_mfma_f32_32x32x16_bf16 v[80:95], v[36:39], a[140:143], v[80:95]
    s_waitcnt lgkmcnt(1)
    v_mfma_f32_32x32x16_bf16 v[96:111], v[40:43], a[140:143], v[96:111]
    s_waitcnt lgkmcnt(0)
    v_mfma_f32_32x32x16_bf16 v[112:127], v[44:47], a[140:143], v[112:127]
    s_add_u32 s68, s71, 6291456
    buffer_load_dwordx4 a[0:3], v7, s[44:47], s68 offen offset:0 sc1
    buffer_load_dwordx4 a[4:7], v7, s[44:47], s68 offen offset:1024 sc1
    buffer_load_dwordx4 a[8:11], v7, s[44:47], s68 offen offset:2048 sc1
    buffer_load_dwordx4 a[12:15], v7, s[44:47], s68 offen offset:3072 sc1
    s_add_u32 s68, s71, 6295552
    buffer_load_dwordx4 a[16:19], v7, s[44:47], s68 offen offset:0 sc1
    buffer_load_dwordx4 a[20:23], v7, s[44:47], s68 offen offset:1024 sc1
    buffer_load_dwordx4 a[24:27], v7, s[44:47], s68 offen offset:2048 sc1
    buffer_load_dwordx4 a[28:31], v7, s[44:47], s68 offen offset:3072 sc1
    s_add_u32 s68, s71, 6299648
    buffer_load_dwordx4 a[32:35], v7, s[44:47], s68 offen offset:0 sc1
    buffer_load_dwordx4 a[36:39], v7, s[44:47], s68 offen offset:1024 sc1
    buffer_load_dwordx4 a[40:43], v7, s[44:47], s68 offen offset:2048 sc1
    buffer_load_dwordx4 a[44:47], v7, s[44:47], s68 offen offset:3072 sc1
    s_add_u32 s68, s71, 6303744
    buffer_load_dwordx4 a[48:51], v7, s[44:47], s68 offen offset:0 sc1
    buffer_load_dwordx4 a[52:55], v7, s[44:47], s68 offen offset:1024 sc1
    buffer_load_dwordx4 a[56:59], v7, s[44:47], s68 offen offset:2048 sc1
    buffer_load_dwordx4 a[60:63], v7, s[44:47], s68 offen offset:3072 sc1
    s_add_u32 s68, s71, 6307840
    buffer_load_dwordx4 a[64:67], v7, s[44:47], s68 offen offset:0 sc1
    buffer_load_dwordx4 a[68:71], v7, s[44:47], s68 offen offset:1024 sc1
    buffer_load_dwordx4 a[72:75], v7, s[44:47], s68 offen offset:2048 sc1
    buffer_load_dwordx4 a[76:79], v7, s[44:47], s68 offen offset:3072 sc1
    s_add_u32 s68, s71, 6311936
    buffer_load_dwordx4 a[80:83], v7, s[44:47], s68 offen offset:0 sc1
    buffer_load_dwordx4 a[84:87], v7, s[44:47], s68 offen offset:1024 sc1
    buffer_load_dwordx4 a[88:91], v7, s[44:47], s68 offen offset:2048 sc1
    buffer_load_dwordx4 a[92:95], v7, s[44:47], s68 offen offset:3072 sc1
    s_add_u32 s68, s71, 6316032
    buffer_load_dwordx4 a[96:99], v7, s[44:47], s68 offen offset:0 sc1
    buffer_load_dwordx4 a[100:103], v7, s[44:47], s68 offen offset:1024 sc1
    buffer_load_dwordx4 a[104:107], v7, s[44:47], s68 offen offset:2048 sc1
    buffer_load_dwordx4 a[108:111], v7, s[44:47], s68 offen offset:3072 sc1
    s_add_u32 s68, s71, 6320128
    buffer_load_dwordx4 a[112:115], v7, s[44:47], s68 offen offset:0 sc1
    buffer_load_dwordx4 a[116:119], v7, s[44:47], s68 offen offset:1024 sc1
    buffer_load_dwordx4 a[120:123], v7, s[44:47], s68 offen offset:2048 sc1
    buffer_load_dwordx4 a[124:127], v7, s[44:47], s68 offen offset:3072 sc1
    s_add_u32 s68, s71, 6324224
    buffer_load_dwordx4 a[128:131], v7, s[44:47], s68 offen offset:0 sc1
    buffer_load_dwordx4 a[132:135], v7, s[44:47], s68 offen offset:1024 sc1
    buffer_load_dwordx4 a[136:139], v7, s[44:47], s68 offen offset:2048 sc1
    buffer_load_dwordx4 a[140:143], v7, s[44:47], s68 offen offset:3072 sc1
    s_add_u32 s71, s71, 147456
    s_cmp_lt_u32 s71, 2359296
    s_cselect_b32 s71, s71, 1073741824
    v_cvt_pk_bf16_f32 v128, v64, v65
    v_cvt_pk_bf16_f32 v129, v66, v67
    v_cvt_pk_bf16_f32 v130, v68, v69
    v_cvt_pk_bf16_f32 v131, v70, v71
    v_cvt_pk_bf16_f32 v132, v72, v73
    v_cvt_pk_bf16_f32 v133, v74, v75
    v_cvt_pk_bf16_f32 v134, v76, v77
    v_cvt_pk_bf16_f32 v135, v78, v79
    v_cvt_pk_bf16_f32 v136, v80, v81
    v_cvt_pk_bf16_f32 v137, v82, v83
    v_cvt_pk_bf16_f32 v138, v84, v85
    v_cvt_pk_bf16_f32 v139, v86, v87
    v_cvt_pk_bf16_f32 v140, v88, v89
    v_cvt_pk_bf16_f32 v141, v90, v91
    v_cvt_pk_bf16_f32 v142, v92, v93
    v_cvt_pk_bf16_f32 v143, v94, v95
    v_cvt_pk_bf16_f32 v144, v96, v97
    v_cvt_pk_bf16_f32 v145, v98, v99
    v_cvt_pk_bf16_f32 v146, v100, v101
    v_cvt_pk_bf16_f32 v147, v102, v103
    v_cvt_pk_bf16_f32 v148, v104, v105
    v_cvt_pk_bf16_f32 v149, v106, v107
    v_cvt_pk_bf16_f32 v150, v108, v109
    v_cvt_pk_bf16_f32 v151, v110, v111
    v_cvt_pk_bf16_f32 v152, v112, v113
    v_cvt_pk_bf16_f32 v153, v114, v115
    v_cvt_pk_bf16_f32 v154, v116, v117
    v_cvt_pk_bf16_f32 v155, v118, v119
    v_cvt_pk_bf16_f32 v156, v120, v121
    v_cvt_pk_bf16_f32 v157, v122, v123
    v_cvt_pk_bf16_f32 v158, v124, v125
    v_cvt_pk_bf16_f32 v159, v126, v127
    s_waitcnt vmcnt(36)
    v_mfma_f32_32x32x16_bf16 v[160:175], a[144:147], v[128:131], 0
    v_mfma_f32_32x32x16_bf16 v[160:175], a[148:151], v[132:135], v[160:175]
    v_mfma_f32_32x32x16_bf16 v[160:175], a[152:155], v[136:139], v[160:175]
    v_mfma_f32_32x32x16_bf16 v[160:175], a[156:159], v[140:143], v[160:175]
    v_mfma_f32_32x32x16_bf16 v[160:175], a[160:163], v[144:147], v[160:175]
    v_mfma_f32_32x32x16_bf16 v[160:175], a[164:167], v[148:151], v[160:175]
    v_mfma_f32_32x32x16_bf16 v[160:175], a[168:171], v[152:155], v[160:175]
    v_mfma_f32_32x32x16_bf16 v[160:175], a[172:175], v[156:159], v[160:175]
    v_cmp_le_i32 vcc, 0, v11
    s_nop 10
    v_cndmask_b32 v160, v12, v160, vcc
    v_cmp_le_i32 vcc, 1, v11
    s_nop 1
    v_cndmask_b32 v161, v12, v161, vcc
    v_cmp_le_i32 vcc, 2, v11
    s_nop 1
    v_cndmask_b32 v162, v12, v162, vcc
    v_cmp_le_i32 vcc, 3, v11
    s_nop 1
    v_cndmask_b32 v163, v12, v163, vcc
    v_cmp_le_i32 vcc, 8, v11
    s_nop 1
    v_cndmask_b32 v164, v12, v164, vcc
    v_cmp_le_i32 vcc, 9, v11
    s_nop 1
    v_cndmask_b32 v165, v12, v165, vcc
    v_cmp_le_i32 vcc, 10, v11
    s_nop 1
    v_cndmask_b32 v166, v12, v166, vcc
    v_cmp_le_i32 vcc, 11, v11
    s_nop 1
    v_cndmask_b32 v167, v12, v167, vcc
    v_cmp_le_i32 vcc, 16, v11
    s_nop 1
    v_cndmask_b32 v168, v12, v168, vcc
    v_cmp_le_i32 vcc, 17, v11
    s_nop 1
    v_cndmask_b32 v169, v12, v169, vcc
    v_cmp_le_i32 vcc, 18, v11
    s_nop 1
    v_cndmask_b32 v170, v12, v170, vcc
    v_cmp_le_i32 vcc, 19, v11
    s_nop 1
    v_cndmask_b32 v171, v12, v171, vcc
    v_cmp_le_i32 vcc, 24, v11
    s_nop 1
    v_cndmask_b32 v172, v12, v172, vcc
    v_cmp_le_i32 vcc, 25, v11
    s_nop 1
    v_cndmask_b32 v173, v12, v173, vcc
    v_cmp_le_i32 vcc, 26, v11
    s_nop 1
    v_cndmask_b32 v174, v12, v174, vcc
    v_cmp_le_i32 vcc, 27, v11
    s_nop 1
    v_cndmask_b32 v175, v12, v175, vcc
    v_max3_f32 v52, v160, v161, v162
    v_max3_f32 v52, v52, v163, v164
    v_max3_f32 v52, v52, v165, v166
    v_max3_f32 v52, v52, v167, v168
    v_max3_f32 v52, v52, v169, v170
    v_max3_f32 v52, v52, v171, v172
    v_max3_f32 v52, v52, v173, v174
    v_max_f32 v52, v52, v175
S2_KMPOLL:
    buffer_load_dword v48, off, s[44:47], s74 sc1
    s_waitcnt vmcnt(0)
    v_readfirstlane_b32 s98, v48
    s_cmp_gt_u32 s98, s70
    s_cbranch_scc1 S2_KMOK
    s_sleep 4
    s_add_u32 s100, s100, 1
    s_cmp_lt_u32 s100, 262144
    s_cbranch_scc1 spin_ok_49
    s_mov_b32 s98, 8
    s_branch FAIL
spin_ok_49:
    s_branch S2_KMPOLL
S2_KMOK:
    buffer_load_dwordx4 v[176:179], v7, s[44:47], s76 offen offset:0 sc1
    buffer_load_dwordx4 v[180:183], v7, s[44:47], s76 offen offset:1024 sc1
    buffer_load_dwordx4 v[184:187], v7, s[44:47], s76 offen offset:2048 sc1
    buffer_load_dwordx4 v[188:191], v7, s[44:47], s76 offen offset:3072 sc1
    s_add_u32 s76, s76, 16384
    s_waitcnt vmcnt(3)
    ds_write2_b32 v9, v176, v177 offset0:0 offset1:64
    ds_write2_b32 v14, v178, v179 offset0:0 offset1:64
    s_waitcnt vmcnt(2)
    ds_write2_b32 v9, v180, v181 offset0:128 offset1:192
    ds_write2_b32 v14, v182, v183 offset0:128 offset1:192
    s_waitcnt vmcnt(1)
    ds_write2_b32 v13, v184, v185 offset0:0 offset1:64
    ds_write2_b32 v15, v186, v187 offset0:0 offset1:64
    s_waitcnt vmcnt(0)
    ds_write2_b32 v13, v188, v189 offset0:128 offset1:192
    ds_write2_b32 v15, v190, v191 offset0:128 offset1:192
    s_waitcnt lgkmcnt(0)
    ds_read_b64 v[224:225], v8 offset:0
    ds_read_b64 v[226:227], v8 offset:512
    ds_read_b64 v[228:229], v8 offset:1024
    ds_read_b64 v[230:231], v8 offset:1536
    ds_read_b64_tr_b16 v[176:177], v10 offset:0
    ds_read_b64_tr_b16 v[178:179], v10 offset:128
    ds_read_b64_tr_b16 v[180:181], v10 offset:256
    ds_read_b64_tr_b16 v[182:183], v10 offset:384
    ds_read_b64_tr_b16 v[184:185], v10 offset:512
    ds_read_b64_tr_b16 v[186:187], v10 offset:640
    ds_read_b64_tr_b16 v[188:189], v10 offset:768
    ds_read_b64_tr_b16 v[190:191], v10 offset:896
    ds_read_b64_tr_b16 v[192:193], v10 offset:1024
    ds_read_b64_tr_b16 v[194:195], v10 offset:1152
    ds_read_b64_tr_b16 v[196:197], v10 offset:1280
    ds_read_b64_tr_b16 v[198:199], v10 offset:1408
    ds_read_b64_tr_b16 v[200:201], v10 offset:1536
    ds_read_b64_tr_b16 v[202:203], v10 offset:1664
    ds_read_b64_tr_b16 v[204:205], v10 offset:1792
    ds_read_b64_tr_b16 v[206:207], v10 offset:1920
    s_waitcnt lgkmcnt(14)
    v_mfma_f32_32x32x16_bf16 v[208:223], v[176:179], v[128:131], 0
    s_waitcnt lgkmcnt(12)
    v_mfma_f32_32x32x16_bf16 v[208:223], v[180:183], v[132:135], v[208:223]
    s_waitcnt lgkmcnt(10)
    v_mfma_f32_32x32x16_bf16 v[208:223], v[184:187], v[136:139], v[208:223]
    s_waitcnt lgkmcnt(8)
    v_mfma_f32_32x32x16_bf16 v[208:223], v[188:191], v[140:143], v[208:223]
    s_waitcnt lgkmcnt(6)
    v_mfma_f32_32x32x16_bf16 v[208:223], v[192:195], v[144:147], v[208:223]
    s_waitcnt lgkmcnt(4)
    v_mfma_f32_32x32x16_bf16 v[208:223], v[196:199], v[148:151], v[208:223]
    s_waitcnt lgkmcnt(2)
    v_mfma_f32_32x32x16_bf16 v[208:223], v[200:203], v[152:155], v[208:223]
    s_waitcnt lgkmcnt(0)
    v_mfma_f32_32x32x16_bf16 v[208:223], v[204:207], v[156:159], v[208:223]
    s_nop 11
    v_max3_f32 v52, v52, v208, v209
    v_max3_f32 v52, v52, v210, v211
    v_mov_b32 v53, v52
    s_nop 1
    v_permlane32_swap_b32 v52, v53
    v_max_f32 v52, v52, v53
    v_mul_f32 v52, s79, v52
    v_fma_f32 v160, v160, s79, -v52
    v_fma_f32 v161, v161, s79, -v52
    v_fma_f32 v162, v162, s79, -v52
    v_fma_f32 v163, v163, s79, -v52
    v_fma_f32 v164, v164, s79, -v52
    v_fma_f32 v165, v165, s79, -v52
    v_fma_f32 v166, v166, s79, -v52
    v_fma_f32 v167, v167, s79, -v52
    v_fma_f32 v168, v168, s79, -v52
    v_fma_f32 v169, v169, s79, -v52
    v_fma_f32 v170, v170, s79, -v52
    v_fma_f32 v171, v171, s79, -v52
    v_fma_f32 v172, v172, s79, -v52
    v_fma_f32 v173, v173, s79, -v52
    v_fma_f32 v174, v174, s79, -v52
    v_fma_f32 v175, v175, s79, -v52
    v_fma_f32 v208, v208, s79, -v52
    v_fma_f32 v209, v209, s79, -v52
    v_fma_f32 v210, v210, s79, -v52
    v_fma_f32 v211, v211, s79, -v52
    v_exp_f32 v160, v160
    v_exp_f32 v161, v161
    v_exp_f32 v162, v162
    v_exp_f32 v163, v163
    v_exp_f32 v164, v164
    v_exp_f32 v165, v165
    v_exp_f32 v166, v166
    v_exp_f32 v167, v167
    v_exp_f32 v168, v168
    v_exp_f32 v169, v169
    v_exp_f32 v170, v170
    v_exp_f32 v171, v171
    v_exp_f32 v172, v172
    v_exp_f32 v173, v173
    v_exp_f32 v174, v174
    v_exp_f32 v175, v175
    v_exp_f32 v208, v208
    v_exp_f32 v209, v209
    v_exp_f32 v210, v210
    v_exp_f32 v211, v211
    v_cvt_pk_bf16_f32 v240, v160, v161
    v_cvt_pk_bf16_f32 v241, v162, v163
    v_cvt_pk_bf16_f32 v242, v164, v165
    v_cvt_pk_bf16_f32 v243, v166, v167
    v_cvt_pk_bf16_f32 v244, v168, v169
    v_cvt_pk_bf16_f32 v245, v170, v171
    v_cvt_pk_bf16_f32 v246, v172, v173
    v_cvt_pk_bf16_f32 v247, v174, v175
    v_cvt_pk_bf16_f32 v248, v208, v209
    v_cvt_pk_bf16_f32 v249, v210, v211
    s_waitcnt vmcnt(0)
    v_mfma_f32_32x32x16_bf16 v[64:79], a[176:179], v[240:243], 0
    v_add_f32 v54, v160, v161
    v_add_f32 v54, v54, v162
    v_add_f32 v54, v54, v163
    v_add_f32 v54, v54, v164
    v_mfma_f32_32x32x16_bf16 v[64:79], a[180:183], v[244:247], v[64:79]
    v_add_f32 v54, v54, v165
    v_add_f32 v54, v54, v166
    v_add_f32 v54, v54, v167
    v_add_f32 v54, v54, v168
    s_nop 5
    v_mfma_f32_32x32x8_bf16 v[64:79], v[224:225], v[248:249], v[64:79]
    v_add_f32 v54, v54, v169
    v_add_f32 v54, v54, v170
    v_add_f32 v54, v54, v171
    v_add_f32 v54, v54, v172
    v_mfma_f32_32x32x16_bf16 v[80:95], a[184:187], v[240:243], 0
    v_add_f32 v54, v54, v173
    v_add_f32 v54, v54, v174
    v_add_f32 v54, v54, v175
    v_add_f32 v54, v54, v208
    v_mfma_f32_32x32x16_bf16 v[80:95], a[188:191], v[244:247], v[80:95]
    v_add_f32 v54, v54, v209
    v_add_f32 v54, v54, v210
    v_add_f32 v54, v54, v211
    s_nop 6
    v_mfma_f32_32x32x8_bf16 v[80:95], v[226:227], v[248:249], v[80:95]
    v_mfma_f32_32x32x16_bf16 v[96:111], a[192:195], v[240:243], 0
    v_mfma_f32_32x32x16_bf16 v[96:111], a[196:199], v[244:247], v[96:111]
    s_nop 9
    v_mfma_f32_32x32x8_bf16 v[96:111], v[228:229], v[248:249], v[96:111]
    v_mfma_f32_32x32x16_bf16 v[112:127], a[200:203], v[240:243], 0
    v_mfma_f32_32x32x16_bf16 v[112:127], a[204:207], v[244:247], v[112:127]
    s_nop 9
    v_mfma_f32_32x32x8_bf16 v[112:127], v[230:231], v[248:249], v[112:127]
    v_mov_b32 v53, v54
    s_nop 1
    v_permlane32_swap_b32 v54, v53
    v_add_f32 v54, v54, v53
    v_rcp_f32 v54, v54
    s_add_u32 s98, s77, 4096
    v_pk_mul_f32 v[64:65], v[64:65], v[54:55] op_sel_hi:[1,0]
    v_pk_mul_f32 v[66:67], v[66:67], v[54:55] op_sel_hi:[1,0]
    v_pk_mul_f32 v[68:69], v[68:69], v[54:55] op_sel_hi:[1,0]
    v_pk_mul_f32 v[70:71], v[70:71], v[54:55] op_sel_hi:[1,0]
    v_cvt_pk_bf16_f32 v128, v64, v65
    v_cvt_pk_bf16_f32 v129, v66, v67
    v_cvt_pk_bf16_f32 v130, v68, v69
    v_cvt_pk_bf16_f32 v131, v70, v71
    buffer_store_dwordx4 v[128:131], v7, s[44:47], s77 offen offset:0 sc1
    v_pk_mul_f32 v[72:73], v[72:73], v[54:55] op_sel_hi:[1,0]
    v_pk_mul_f32 v[74:75], v[74:75], v[54:55] op_sel_hi:[1,0]
    v_pk_mul_f32 v[76:77], v[76:77], v[54:55] op_sel_hi:[1,0]
    v_pk_mul_f32 v[78:79], v[78:79], v[54:55] op_sel_hi:[1,0]
    v_cvt_pk_bf16_f32 v132, v72, v73
    v_cvt_pk_bf16_f32 v133, v74, v75
    v_cvt_pk_bf16_f32 v134, v76, v77
    v_cvt_pk_bf16_f32 v135, v78, v79
    buffer_store_dwordx4 v[132:135], v7, s[44:47], s77 offen offset:1024 sc1
    v_pk_mul_f32 v[80:81], v[80:81], v[54:55] op_sel_hi:[1,0]
    v_pk_mul_f32 v[82:83], v[82:83], v[54:55] op_sel_hi:[1,0]
    v_pk_mul_f32 v[84:85], v[84:85], v[54:55] op_sel_hi:[1,0]
    v_pk_mul_f32 v[86:87], v[86:87], v[54:55] op_sel_hi:[1,0]
    v_cvt_pk_bf16_f32 v136, v80, v81
    v_cvt_pk_bf16_f32 v137, v82, v83
    v_cvt_pk_bf16_f32 v138, v84, v85
    v_cvt_pk_bf16_f32 v139, v86, v87
    buffer_store_dwordx4 v[136:139], v7, s[44:47], s77 offen offset:2048 sc1
    v_pk_mul_f32 v[88:89], v[88:89], v[54:55] op_sel_hi:[1,0]
    v_pk_mul_f32 v[90:91], v[90:91], v[54:55] op_sel_hi:[1,0]
    v_pk_mul_f32 v[92:93], v[92:93], v[54:55] op_sel_hi:[1,0]
    v_pk_mul_f32 v[94:95], v[94:95], v[54:55] op_sel_hi:[1,0]
    v_cvt_pk_bf16_f32 v140, v88, v89
    v_cvt_pk_bf16_f32 v141, v90, v91
    v_cvt_pk_bf16_f32 v142, v92, v93
    v_cvt_pk_bf16_f32 v143, v94, v95
    buffer_store_dwordx4 v[140:143], v7, s[44:47], s77 offen offset:3072 sc1
    v_pk_mul_f32 v[96:97], v[96:97], v[54:55] op_sel_hi:[1,0]
    v_pk_mul_f32 v[98:99], v[98:99], v[54:55] op_sel_hi:[1,0]
    v_pk_mul_f32 v[100:101], v[100:101], v[54:55] op_sel_hi:[1,0]
    v_pk_mul_f32 v[102:103], v[102:103], v[54:55] op_sel_hi:[1,0]
    v_cvt_pk_bf16_f32 v144, v96, v97
    v_cvt_pk_bf16_f32 v145, v98, v99
    v_cvt_pk_bf16_f32 v146, v100, v101
    v_cvt_pk_bf16_f32 v147, v102, v103
    buffer_store_dwordx4 v[144:147], v7, s[44:47], s98 offen offset:0 sc1
    v_pk_mul_f32 v[104:105], v[104:105], v[54:55] op_sel_hi:[1,0]
    v_pk_mul_f32 v[106:107], v[106:107], v[54:55] op_sel_hi:[1,0]
    v_pk_mul_f32 v[108:109], v[108:109], v[54:55] op_sel_hi:[1,0]
    v_pk_mul_f32 v[110:111], v[110:111], v[54:55] op_sel_hi:[1,0]
    v_cvt_pk_bf16_f32 v148, v104, v105
    v_cvt_pk_bf16_f32 v149, v106, v107
    v_cvt_pk_bf16_f32 v150, v108, v109
    v_cvt_pk_bf16_f32 v151, v110, v111
    buffer_store_dwordx4 v[148:151], v7, s[44:47], s98 offen offset:1024 sc1
    v_pk_mul_f32 v[112:113], v[112:113], v[54:55] op_sel_hi:[1,0]
    v_pk_mul_f32 v[114:115], v[114:115], v[54:55] op_sel_hi:[1,0]
    v_pk_mul_f32 v[116:117], v[116:117], v[54:55] op_sel_hi:[1,0]
    v_pk_mul_f32 v[118:119], v[118:119], v[54:55] op_sel_hi:[1,0]
    v_cvt_pk_bf16_f32 v152, v112, v113
    v_cvt_pk_bf16_f32 v153, v114, v115
    v_cvt_pk_bf16_f32 v154, v116, v117
    v_cvt_pk_bf16_f32 v155, v118, v119
    buffer_store_dwordx4 v[152:155], v7, s[44:47], s98 offen offset:2048 sc1
    v_pk_mul_f32 v[120:121], v[120:121], v[54:55] op_sel_hi:[1,0]
    v_pk_mul_f32 v[122:123], v[122:123], v[54:55] op_sel_hi:[1,0]
    v_pk_mul_f32 v[124:125], v[124:125], v[54:55] op_sel_hi:[1,0]
    v_pk_mul_f32 v[126:127], v[126:127], v[54:55] op_sel_hi:[1,0]
    v_cvt_pk_bf16_f32 v156, v120, v121
    v_cvt_pk_bf16_f32 v157, v122, v123
    v_cvt_pk_bf16_f32 v158, v124, v125
    v_cvt_pk_bf16_f32 v159, v126, v127
    buffer_store_dwordx4 v[156:159], v7, s[44:47], s98 offen offset:3072 sc1
    s_add_u32 s77, s77, 32768
    s_add_u32 s80, s80, 1
    v_mov_b32 v48, s80
    s_waitcnt vmcnt(0)
    s_mov_b64 exec, 1
    buffer_store_dword v48, off, s[44:47], s75 sc1
    s_mov_b64 exec, -1
    s_add_u32 s70, s70, 4
    s_cmp_lt_u32 s70, 64
    s_cbranch_scc1 S2_LOOP
    s_branch END
.p2align 6
ROLE_S3:
    s_cmp_eq_u32 s7, 1
    s_cbranch_scc1 S3_NOHOLD
    v_lshlrev_b32 v16, 2, v0
waitd_50:
    buffer_load_dword v17, v16, s[48:51], 0 offen sc1
    s_waitcnt vmcnt(0)
    v_readlane_b32 s98, v17, 51
    s_cmp_ge_u32 s98, 128
    s_cbranch_scc1 waitd_done_51
dno_52:
    s_sleep 8
    s_add_u32 s100, s100, 1
    s_cmp_lt_u32 s100, 262144
    s_cbranch_scc1 spin_ok_53
    s_mov_b32 s98, 1
    s_branch FAIL
spin_ok_53:
    s_branch waitd_50
waitd_done_51:
    s_lshl_b32 s97, s6, 5
    s_add_u32 s97, s97, s5
    s_lshl_b32 s97, s97, 7
    s_add_u32 s97, s97, 8192
hold_54:
    buffer_load_dword v17, off, s[44:47], s97 offset:64 sc1
    s_waitcnt vmcnt(0)
    v_readfirstlane_b32 s99, v17
    s_cmp_ge_u32 s99, 1
    s_cbranch_scc1 hold_54_ok
    s_sleep 16
    s_add_u32 s100, s100, 1
    s_cmp_lt_u32 s100, 262144
    s_cbranch_scc1 spin_ok_55
    s_mov_b32 s98, 14
    s_branch FAIL
spin_ok_55:
    s_branch hold_54
hold_54_ok:
S3_NOHOLD:
    s_mov_b32 s52, s18
    s_and_b32 s53, s19, 0xffff
    s_mov_b32 s54, 4718592
    s_mov_b32 s55, 0x20000
    s_mul_i32 s70, s5, 43
    s_lshr_b32 s70, s70, 8
    s_mul_i32 s98, s70, 6
    s_sub_u32 s71, s5, s98
    s_mul_i32 s69, s3, 24576
    v_add_u32 v16, 0, v0
    v_mul_u32_u24 v17, 43691, v16
    v_lshrrev_b32 v17, 19, v17
    v_mul_u32_u24 v18, 12, v17
    v_sub_u32 v18, v16, v18
    v_mul_u32_u24 v17, 1152, v17
    v_lshl_add_u32 v1, v18, 4, v17
    v_add_u32 v16, 64, v0
    v_mul_u32_u24 v17, 43691, v16
    v_lshrrev_b32 v17, 19, v17
    v_mul_u32_u24 v18, 12, v17
    v_sub_u32 v18, v16, v18
    v_mul_u32_u24 v17, 1152, v17
    v_lshl_add_u32 v2, v18, 4, v17
    v_add_u32 v16, 128, v0
    v_mul_u32_u24 v17, 43691, v16
    v_lshrrev_b32 v17, 19, v17
    v_mul_u32_u24 v18, 12, v17
    v_sub_u32 v18, v16, v18
    v_mul_u32_u24 v17, 1152, v17
    v_lshl_add_u32 v3, v18, 4, v17
    s_lshl_b32 s72, s70, 3
    s_lshl_b32 s98, s3, 1
    s_add_u32 s72, s72, s98
    s_mul_i32 s78, s72, 147456
    s_mul_i32 s98, s71, 192
    s_add_u32 s78, s78, s98
    s_add_u32 s68, s78, 0
    s_add_u32 m0, s69, 0
    s_nop 0
    buffer_load_dwordx4 v1, s[52:55], s68 offen nt lds
    s_add_u32 m0, s69, 1024
    s_nop 0
    buffer_load_dwordx4 v2, s[52:55], s68 offen nt lds
    s_add_u32 m0, s69, 2048
    s_nop 0
    buffer_load_dwordx4 v3, s[52:55], s68 offen nt lds
    s_add_u32 s68, s78, 18432
    s_add_u32 m0, s69, 3072
    s_nop 0
    buffer_load_dwordx4 v1, s[52:55], s68 offen nt lds
    s_add_u32 m0, s69, 4096
    s_nop 0
    buffer_load_dwordx4 v2, s[52:55], s68 offen nt lds
    s_add_u32 m0, s69, 5120
    s_nop 0
    buffer_load_dwordx4 v3, s[52:55], s68 offen nt lds
    s_add_u32 s68, s78, 36864
    s_add_u32 m0, s69, 6144
    s_nop 0
    buffer_load_dwordx4 v1, s[52:55], s68 offen nt lds
    s_add_u32 m0, s69, 7168
    s_nop 0
    buffer_load_dwordx4 v2, s[52:55], s68 offen nt lds
    s_add_u32 m0, s69, 8192
    s_nop 0
    buffer_load_dwordx4 v3, s[52:55], s68 offen nt lds
    s_add_u32 s68, s78, 55296
    s_add_u32 m0, s69, 9216
    s_nop 0
    buffer_load_dwordx4 v1, s[52:55], s68 offen nt lds
    s_add_u32 m0, s69, 10240
    s_nop 0
    buffer_load_dwordx4 v2, s[52:55], s68 offen nt lds
    s_add_u32 m0, s69, 11264
    s_nop 0
    buffer_load_dwordx4 v3, s[52:55], s68 offen nt lds
    s_add_u32 s68, s78, 73728
    s_add_u32 m0, s69, 12288
    s_nop 0
    buffer_load_dwordx4 v1, s[52:55], s68 offen nt lds
    s_add_u32 m0, s69, 13312
    s_nop 0
    buffer_load_dwordx4 v2, s[52:55], s68 offen nt lds
    s_add_u32 m0, s69, 14336
    s_nop 0
    buffer_load_dwordx4 v3, s[52:55], s68 offen nt lds
    s_add_u32 s68, s78, 92160
    s_add_u32 m0, s69, 15360
    s_nop 0
    buffer_load_dwordx4 v1, s[52:55], s68 offen nt lds
    s_add_u32 m0, s69, 16384
    s_nop 0
    buffer_load_dwordx4 v2, s[52:55], s68 offen nt lds
    s_add_u32 m0, s69, 17408
    s_nop 0
    buffer_load_dwordx4 v3, s[52:55], s68 offen nt lds
    s_add_u32 s68, s78, 110592
    s_add_u32 m0, s69, 18432
    s_nop 0
    buffer_load_dwordx4 v1, s[52:55], s68 offen nt lds
    s_add_u32 m0, s69, 19456
    s_nop 0
    buffer_load_dwordx4 v2, s[52:55], s68 offen nt lds
    s_add_u32 m0, s69, 20480
    s_nop 0
    buffer_load_dwordx4 v3, s[52:55], s68 offen nt lds
    s_add_u32 s68, s78, 129024
    s_add_u32 m0, s69, 21504
    s_nop 0
    buffer_load_dwordx4 v1, s[52:55], s68 offen nt lds
    s_add_u32 m0, s69, 22528
    s_nop 0
    buffer_load_dwordx4 v2, s[52:55], s68 offen nt lds
    s_add_u32 m0, s69, 23552
    s_nop 0
    buffer_load_dwordx4 v3, s[52:55], s68 offen nt lds
    v_lshrrev_b32 v16, 5, v0
    v_bfe_u32 v17, v0, 2, 2
    v_lshl_add_u32 v17, v16, 2, v17
    v_mul_u32_u24 v17, 192, v17
    v_bfe_u32 v18, v0, 4, 1
    v_lshl_add_u32 v17, v18, 5, v17
    v_and_b32 v18, 3, v0
    v_lshl_add_u32 v17, v18, 3, v17
    v_add_u32 v4, s69, v17
    v_lshlrev_b32 v5, 4, v0
    s_mul_i32 s98, s3, 12288
    v_add_u32 v6, s98, v5
    s_mul_i32 s98, s3, 3072
    v_add_u32 v7, s98, v5
    v_and_b32 v16, 1, v0
    v_lshlrev_b32 v8, 7, v16
    s_lshl_b32 s98, s6, 5
    s_add_u32 s98, s98, s72
    s_mul_i32 s98, s98, 65
    s_lshl_b32 s73, s98, 13
    s_add_u32 s73, s73, 104857600
    s_lshl_b32 s98, s6, 5
    s_add_u32 s98, s98, s72
    s_lshl_b32 s74, s98, 7
    s_add_u32 s74, s74, 16384
    s_mul_i32 s98, s6, 24
    s_add_u32 s98, s98, s5
    s_lshl_b32 s98, s98, 2
    s_add_u32 s98, s98, s3
    s_lshl_b32 s75, s98, 7
    s_add_u32 s75, s75, 24576
    s_lshl_b32 s98, s7, 6
    s_add_u32 s75, s75, s98
    s_lshl_b32 s98, s6, 2
    s_add_u32 s98, s98, s70
    s_mul_i32 s76, s98, 73728
    s_mul_i32 s98, s71, 12288
    s_add_u32 s76, s76, s98
    s_mul_i32 s98, s3, 3072
    s_add_u32 s76, s76, s98
    s_add_u32 s76, s76, 140509184
    s_waitcnt vmcnt(0)
    ds_read_b64_tr_b16 a[0:1], v4 offset:0
    ds_read_b64_tr_b16 a[2:3], v4 offset:1536
    ds_read_b64_tr_b16 a[4:5], v4 offset:64
    ds_read_b64_tr_b16 a[6:7], v4 offset:1600
    ds_read_b64_tr_b16 a[8:9], v4 offset:128
    ds_read_b64_tr_b16 a[10:11], v4 offset:1664
    ds_read_b64_tr_b16 a[12:13], v4 offset:3072
    ds_read_b64_tr_b16 a[14:15], v4 offset:4608
    ds_read_b64_tr_b16 a[16:17], v4 offset:3136
    ds_read_b64_tr_b16 a[18:19], v4 offset:4672
    ds_read_b64_tr_b16 a[20:21], v4 offset:3200
    ds_read_b64_tr_b16 a[22:23], v4 offset:4736
    ds_read_b64_tr_b16 a[24:25], v4 offset:6144
    ds_read_b64_tr_b16 a[26:27], v4 offset:7680
    ds_read_b64_tr_b16 a[28:29], v4 offset:6208
    ds_read_b64_tr_b16 a[30:31], v4 offset:7744
    ds_read_b64_tr_b16 a[32:33], v4 offset:6272
    ds_read_b64_tr_b16 a[34:35], v4 offset:7808
    ds_read_b64_tr_b16 a[36:37], v4 offset:9216
    ds_read_b64_tr_b16 a[38:39], v4 offset:10752
    ds_read_b64_tr_b16 a[40:41], v4 offset:9280
    ds_read_b64_tr_b16 a[42:43], v4 offset:10816
    ds_read_b64_tr_b16 a[44:45], v4 offset:9344
    ds_read_b64_tr_b16 a[46:47], v4 offset:10880
    ds_read_b64_tr_b16 a[48:49], v4 offset:12288
    ds_read_b64_tr_b16 a[50:51], v4 offset:13824
    ds_read_b64_tr_b16 a[52:53], v4 offset:12352
    ds_read_b64_tr_b16 a[54:55], v4 offset:13888
    ds_read_b64_tr_b16 a[56:57], v4 offset:12416
    ds_read_b64_tr_b16 a[58:59], v4 offset:13952
    ds_read_b64_tr_b16 a[60:61], v4 offset:15360
    ds_read_b64_tr_b16 a[62:63], v4 offset:16896
    ds_read_b64_tr_b16 a[64:65], v4 offset:15424
    ds_read_b64_tr_b16 a[66:67], v4 offset:16960
    ds_read_b64_tr_b16 a[68:69], v4 offset:15488
    ds_read_b64_tr_b16 a[70:71], v4 offset:17024
    ds_read_b64_tr_b16 a[72:73], v4 offset:18432
    ds_read_b64_tr_b16 a[74:75], v4 offset:19968
    ds_read_b64_tr_b16 a[76:77], v4 offset:18496
    ds_read_b64_tr_b16 a[78:79], v4 offset:20032
    ds_read_b64_tr_b16 a[80:81], v4 offset:18560
    ds_read_b64_tr_b16 a[82:83], v4 offset:20096
    ds_read_b64_tr_b16 a[84:85], v4 offset:21504
    ds_read_b64_tr_b16 a[86:87], v4 offset:23040
    ds_read_b64_tr_b16 a[88:89], v4 offset:21568
    ds_read_b64_tr_b16 a[90:91], v4 offset:23104
    ds_read_b64_tr_b16 a[92:93], v4 offset:21632
    ds_read_b64_tr_b16 a[94:95], v4 offset:23168
    s_waitcnt lgkmcnt(0)
    s_add_u32 s68, s78, 147456
    s_add_u32 m0, s69, 0
    s_nop 0
    buffer_load_dwordx4 v1, s[52:55], s68 offen nt lds
    s_add_u32 m0, s69, 1024
    s_nop 0
    buffer_load_dwordx4 v2, s[52:55], s68 offen nt lds
    s_add_u32 m0, s69, 2048
    s_nop 0
    buffer_load_dwordx4 v3, s[52:55], s68 offen nt lds
    s_add_u32 s68, s78, 165888
    s_add_u32 m0, s69, 3072
    s_nop 0
    buffer_load_dwordx4 v1, s[52:55], s68 offen nt lds
    s_add_u32 m0, s69, 4096
    s_nop 0
    buffer_load_dwordx4 v2, s[52:55], s68 offen nt lds
    s_add_u32 m0, s69, 5120
    s_nop 0
    buffer_load_dwordx4 v3, s[52:55], s68 offen nt lds
    s_add_u32 s68, s78, 184320
    s_add_u32 m0, s69, 6144
    s_nop 0
    buffer_load_dwordx4 v1, s[52:55], s68 offen nt lds
    s_add_u32 m0, s69, 7168
    s_nop 0
    buffer_load_dwordx4 v2, s[52:55], s68 offen nt lds
    s_add_u32 m0, s69, 8192
    s_nop 0
    buffer_load_dwordx4 v3, s[52:55], s68 offen nt lds
    s_add_u32 s68, s78, 202752
    s_add_u32 m0, s69, 9216
    s_nop 0
    buffer_load_dwordx4 v1, s[52:55], s68 offen nt lds
    s_add_u32 m0, s69, 10240
    s_nop 0
    buffer_load_dwordx4 v2, s[52:55], s68 offen nt lds
    s_add_u32 m0, s69, 11264
    s_nop 0
    buffer_load_dwordx4 v3, s[52:55], s68 offen nt lds
    s_add_u32 s68, s78, 221184
    s_add_u32 m0, s69, 12288
    s_nop 0
    buffer_load_dwordx4 v1, s[52:55], s68 offen nt lds
    s_add_u32 m0, s69, 13312
    s_nop 0
    buffer_load_dwordx4 v2, s[52:55], s68 offen nt lds
    s_add_u32 m0, s69, 14336
    s_nop 0
    buffer_load_dwordx4 v3, s[52:55], s68 offen nt lds
    s_add_u32 s68, s78, 239616
    s_add_u32 m0, s69, 15360
    s_nop 0
    buffer_load_dwordx4 v1, s[52:55], s68 offen nt lds
    s_add_u32 m0, s69, 16384
    s_nop 0
    buffer_load_dwordx4 v2, s[52:55], s68 offen nt lds
    s_add_u32 m0, s69, 17408
    s_nop 0
    buffer_load_dwordx4 v3, s[52:55], s68 offen nt lds
    s_add_u32 s68, s78, 258048
    s_add_u32 m0, s69, 18432
    s_nop 0
    buffer_load_dwordx4 v1, s[52:55], s68 offen nt lds
    s_add_u32 m0, s69, 19456
    s_nop 0
    buffer_load_dwordx4 v2, s[52:55], s68 offen nt lds
    s_add_u32 m0, s69, 20480
    s_nop 0
    buffer_load_dwordx4 v3, s[52:55], s68 offen nt lds
    s_add_u32 s68, s78, 276480
    s_add_u32 m0, s69, 21504
    s_nop 0
    buffer_load_dwordx4 v1, s[52:55], s68 offen nt lds
    s_add_u32 m0, s69, 22528
    s_nop 0
    buffer_load_dwordx4 v2, s[52:55], s68 offen nt lds
    s_add_u32 m0, s69, 23552
    s_nop 0
    buffer_load_dwordx4 v3, s[52:55], s68 offen nt lds
    s_waitcnt vmcnt(0)
    ds_read_b64_tr_b16 a[96:97], v4 offset:0
    ds_read_b64_tr_b16 a[98:99], v4 offset:1536
    ds_read_b64_tr_b16 a[100:101], v4 offset:64
    ds_read_b64_tr_b16 a[102:103], v4 offset:1600
    ds_read_b64_tr_b16 a[104:105], v4 offset:128
    ds_read_b64_tr_b16 a[106:107], v4 offset:1664
    ds_read_b64_tr_b16 a[108:109], v4 offset:3072
    ds_read_b64_tr_b16 a[110:111], v4 offset:4608
    ds_read_b64_tr_b16 a[112:113], v4 offset:3136
    ds_read_b64_tr_b16 a[114:115], v4 offset:4672
    ds_read_b64_tr_b16 a[116:117], v4 offset:3200
    ds_read_b64_tr_b16 a[118:119], v4 offset:4736
    ds_read_b64_tr_b16 a[120:121], v4 offset:6144
    ds_read_b64_tr_b16 a[122:123], v4 offset:7680
    ds_read_b64_tr_b16 a[124:125], v4 offset:6208
    ds_read_b64_tr_b16 a[126:127], v4 offset:7744
    ds_read_b64_tr_b16 a[128:129], v4 offset:6272
    ds_read_b64_tr_b16 a[130:131], v4 offset:7808
    ds_read_b64_tr_b16 a[132:133], v4 offset:9216
    ds_read_b64_tr_b16 a[134:135], v4 offset:10752
    ds_read_b64_tr_b16 a[136:137], v4 offset:9280
    ds_read_b64_tr_b16 a[138:139], v4 offset:10816
    ds_read_b64_tr_b16 a[140:141], v4 offset:9344
    ds_read_b64_tr_b16 a[142:143], v4 offset:10880
    ds_read_b64_tr_b16 a[144:145], v4 offset:12288
    ds_read_b64_tr_b16 a[146:147], v4 offset:13824
    ds_read_b64_tr_b16 a[148:149], v4 offset:12352
    ds_read_b64_tr_b16 a[150:151], v4 offset:13888
    ds_read_b64_tr_b16 a[152:153], v4 offset:12416
    ds_read_b64_tr_b16 a[154:155], v4 offset:13952
    ds_read_b64_tr_b16 a[156:157], v4 offset:15360
    ds_read_b64_tr_b16 a[158:159], v4 offset:16896
    ds_read_b64_tr_b16 a[160:161], v4 offset:15424
    ds_read_b64_tr_b16 a[162:163], v4 offset:16960
    ds_read_b64_tr_b16 a[164:165], v4 offset:15488
    ds_read_b64_tr_b16 a[166:167], v4 offset:17024
    ds_read_b64_tr_b16 a[168:169], v4 offset:18432
    ds_read_b64_tr_b16 a[170:171], v4 offset:19968
    ds_read_b64_tr_b16 a[172:173], v4 offset:18496
    ds_read_b64_tr_b16 a[174:175], v4 offset:20032
    ds_read_b64_tr_b16 a[176:177], v4 offset:18560
    ds_read_b64_tr_b16 a[178:179], v4 offset:20096
    ds_read_b64_tr_b16 a[180:181], v4 offset:21504
    ds_read_b64_tr_b16 a[182:183], v4 offset:23040
    ds_read_b64_tr_b16 a[184:185], v4 offset:21568
    ds_read_b64_tr_b16 a[186:187], v4 offset:23104
    ds_read_b64_tr_b16 a[188:189], v4 offset:21632
    ds_read_b64_tr_b16 a[190:191], v4 offset:23168
    s_waitcnt lgkmcnt(0)
    v_lshlrev_b32 v16, 2, v0
waitd_56:
    buffer_load_dword v17, v16, s[48:51], 0 offen sc1
    s_waitcnt vmcnt(0)
    v_readlane_b32 s98, v17, 51
    s_cmp_ge_u32 s98, 128
    s_cbranch_scc1 waitd_done_57
dno_58:
    s_sleep 8
    s_add_u32 s100, s100, 1
    s_cmp_lt_u32 s100, 262144
    s_cbranch_scc1 spin_ok_59
    s_mov_b32 s98, 1
    s_branch FAIL
spin_ok_59:
    s_branch waitd_56
waitd_done_57:
    s_barrier
    s_mul_i32 s72, s7, 57
    s_mov_b32 s85, s73
    s_mov_b32 s86, s76
    s_mov_b32 s77, 0
    s_mov_b32 s78, 0
    s_lshr_b32 s79, s72, 2
    s_and_b32 s98, s72, 3
    s_lshl_b32 s98, s98, 2
    s_add_u32 s80, s74, s98
S3_FIRST:
    buffer_load_dword v9, v8, s[44:47], s80 offen sc1
    s_waitcnt vmcnt(0)
    v_cmp_ge_u32 vcc, s79, v9
    s_cbranch_vccz S3_FIRST_OK
    s_sleep 4
    s_add_u32 s100, s100, 1
    s_cmp_lt_u32 s100, 262144
    s_cbranch_scc1 spin_ok_60
    s_mov_b32 s98, 9
    s_branch FAIL
spin_ok_60:
    s_branch S3_FIRST
S3_FIRST_OK:
    s_lshl_b32 s73, s72, 13
    s_add_u32 s73, s73, s85
    s_add_u32 s68, s73, 0
    buffer_load_dwordx4 v[64:67], v5, s[44:47], s68 offen offset:0 sc1
    buffer_load_dwordx4 v[68:71], v5, s[44:47], s68 offen offset:1024 sc1
    buffer_load_dwordx4 v[72:75], v5, s[44:47], s68 offen offset:2048 sc1
    buffer_load_dwordx4 v[76:79], v5, s[44:47], s68 offen offset:3072 sc1
    s_add_u32 s68, s73, 4096
    buffer_load_dwordx4 v[80:83], v5, s[44:47], s68 offen offset:0 sc1
    buffer_load_dwordx4 v[84:87], v5, s[44:47], s68 offen offset:1024 sc1
    buffer_load_dwordx4 v[88:91], v5, s[44:47], s68 offen offset:2048 sc1
    buffer_load_dwordx4 v[92:95], v5, s[44:47], s68 offen offset:3072 sc1
    s_add_u32 s68, s73, 532480
    buffer_load_dwordx4 v[96:99], v5, s[44:47], s68 offen offset:0 sc1
    buffer_load_dwordx4 v[100:103], v5, s[44:47], s68 offen offset:1024 sc1
    buffer_load_dwordx4 v[104:107], v5, s[44:47], s68 offen offset:2048 sc1
    buffer_load_dwordx4 v[108:111], v5, s[44:47], s68 offen offset:3072 sc1
    s_add_u32 s68, s73, 536576
    buffer_load_dwordx4 v[112:115], v5, s[44:47], s68 offen offset:0 sc1
    buffer_load_dwordx4 v[116:119], v5, s[44:47], s68 offen offset:1024 sc1
    buffer_load_dwordx4 v[120:123], v5, s[44:47], s68 offen offset:2048 sc1
    buffer_load_dwordx4 v[124:127], v5, s[44:47], s68 offen offset:3072 sc1
    s_cmp_ge_u32 s72, 56
    s_addc_u32 s82, s72, 1
    s_cmp_ge_u32 s82, 56
    s_addc_u32 s83, s82, 1
    s_lshl_b32 s73, s82, 13
    s_add_u32 s73, s73, s85
    s_mul_i32 s76, s72, 589824
    s_add_u32 s76, s76, s86
    s_mov_b64 vcc, -1
S3_0:
    s_mov_b32 s77, 0
    s_cbranch_vccnz S3_0_N1
    s_waitcnt vmcnt(15)
    v_mfma_f32_32x32x16_bf16 v[16:31], a[0:3], v[64:67], 0
    s_add_u32 s68, s73, 0
    buffer_load_dwordx4 v[128:131], v5, s[44:47], s68 offen offset:0 sc1
    v_mfma_f32_32x32x16_bf16 v[32:47], a[4:7], v[64:67], 0
    buffer_load_dwordx4 v[132:135], v5, s[44:47], s68 offen offset:1024 sc1
    v_mfma_f32_32x32x16_bf16 v[48:63], a[8:11], v[64:67], 0
    s_waitcnt vmcnt(16)
    v_mfma_f32_32x32x16_bf16 v[16:31], a[12:15], v[68:71], v[16:31]
    buffer_load_dwordx4 v[136:139], v5, s[44:47], s68 offen offset:2048 sc1
    v_mfma_f32_32x32x16_bf16 v[32:47], a[16:19], v[68:71], v[32:47]
    buffer_load_dwordx4 v[140:143], v5, s[44:47], s68 offen offset:3072 sc1
    v_mfma_f32_32x32x16_bf16 v[48:63], a[20:23], v[68:71], v[48:63]
    s_waitcnt vmcnt(17)
    v_mfma_f32_32x32x16_bf16 v[16:31], a[24:27], v[72:75], v[16:31]
    s_add_u32 s68, s73, 4096
    buffer_load_dwordx4 v[144:147], v5, s[44:47], s68 offen offset:0 sc1
    v_mfma_f32_32x32x16_bf16 v[32:47], a[28:31], v[72:75], v[32:47]
    buffer_load_dwordx4 v[148:151], v5, s[44:47], s68 offen offset:1024 sc1
    v_mfma_f32_32x32x16_bf16 v[48:63], a[32:35], v[72:75], v[48:63]
    s_waitcnt vmcnt(18)
    v_mfma_f32_32x32x16_bf16 v[16:31], a[36:39], v[76:79], v[16:31]
    buffer_load_dwordx4 v[152:155], v5, s[44:47], s68 offen offset:2048 sc1
    v_mfma_f32_32x32x16_bf16 v[32:47], a[40:43], v[76:79], v[32:47]
    buffer_load_dwordx4 v[156:159], v5, s[44:47], s68 offen offset:3072 sc1
    v_mfma_f32_32x32x16_bf16 v[48:63], a[44:47], v[76:79], v[48:63]
    s_waitcnt vmcnt(19)
    v_mfma_f32_32x32x16_bf16 v[16:31], a[48:51], v[80:83], v[16:31]
    s_add_u32 s68, s73, 532480
    buffer_load_dwordx4 v[160:163], v5, s[44:47], s68 offen offset:0 sc1
    v_mfma_f32_32x32x16_bf16 v[32:47], a[52:55], v[80:83], v[32:47]
    buffer_load_dwordx4 v[164:167], v5, s[44:47], s68 offen offset:1024 sc1
    v_mfma_f32_32x32x16_bf16 v[48:63], a[56:59], v[80:83], v[48:63]
    s_waitcnt vmcnt(20)
    v_mfma_f32_32x32x16_bf16 v[16:31], a[60:63], v[84:87], v[16:31]
    buffer_load_dwordx4 v[168:171], v5, s[44:47], s68 offen offset:2048 sc1
    v_mfma_f32_32x32x16_bf16 v[32:47], a[64:67], v[84:87], v[32:47]
    buffer_load_dwordx4 v[172:175], v5, s[44:47], s68 offen offset:3072 sc1
    v_mfma_f32_32x32x16_bf16 v[48:63], a[68:71], v[84:87], v[48:63]
    s_waitcnt vmcnt(21)
    v_mfma_f32_32x32x16_bf16 v[16:31], a[72:75], v[88:91], v[16:31]
    s_add_u32 s68, s73, 536576
    buffer_load_dwordx4 v[176:179], v5, s[44:47], s68 offen offset:0 sc1
    v_mfma_f32_32x32x16_bf16 v[32:47], a[76:79], v[88:91], v[32:47]
    buffer_load_dwordx4 v[180:183], v5, s[44:47], s68 offen offset:1024 sc1
    v_mfma_f32_32x32x16_bf16 v[48:63], a[80:83], v[88:91], v[48:63]
    s_waitcnt vmcnt(22)
    v_mfma_f32_32x32x16_bf16 v[16:31], a[84:87], v[92:95], v[16:31]
    buffer_load_dwordx4 v[184:187], v5, s[44:47], s68 offen offset:2048 sc1
    v_mfma_f32_32x32x16_bf16 v[32:47], a[88:91], v[92:95], v[32:47]
    buffer_load_dwordx4 v[188:191], v5, s[44:47], s68 offen offset:3072 sc1
    v_mfma_f32_32x32x16_bf16 v[48:63], a[92:95], v[92:95], v[48:63]
    s_mov_b32 s77, 1
    s_waitcnt vmcnt(16)
    s_cmp_eq_u32 s78, 0
    s_cbranch_scc1 S3_0_P1
    v_mov_b32 v10, s84
    s_mov_b64 exec, 1
    buffer_store_dword v10, off, s[44:47], s75 sc1
    s_mov_b64 exec, -1
S3_0_P1:
    s_branch S3_0_N2
S3_0_N1:
    s_lshr_b32 s79, s82, 2
    s_and_b32 s98, s82, 3
    s_lshl_b32 s98, s98, 2
    s_add_u32 s80, s74, s98
    buffer_load_dword v9, v8, s[44:47], s80 offen sc1
    s_waitcnt vmcnt(16)
    v_mfma_f32_32x32x16_bf16 v[16:31], a[0:3], v[64:67], 0
    v_mfma_f32_32x32x16_bf16 v[32:47], a[4:7], v[64:67], 0
    v_mfma_f32_32x32x16_bf16 v[48:63], a[8:11], v[64:67], 0
    s_waitcnt vmcnt(15)
    v_mfma_f32_32x32x16_bf16 v[16:31], a[12:15], v[68:71], v[16:31]
    v_mfma_f32_32x32x16_bf16 v[32:47], a[16:19], v[68:71], v[32:47]
    v_mfma_f32_32x32x16_bf16 v[48:63], a[20:23], v[68:71], v[48:63]
    s_waitcnt vmcnt(14)
    v_mfma_f32_32x32x16_bf16 v[16:31], a[24:27], v[72:75], v[16:31]
    v_mfma_f32_32x32x16_bf16 v[32:47], a[28:31], v[72:75], v[32:47]
    v_mfma_f32_32x32x16_bf16 v[48:63], a[32:35], v[72:75], v[48:63]
    s_waitcnt vmcnt(13)
    v_mfma_f32_32x32x16_bf16 v[16:31], a[36:39], v[76:79], v[16:31]
    v_mfma_f32_32x32x16_bf16 v[32:47], a[40:43], v[76:79], v[32:47]
    v_mfma_f32_32x32x16_bf16 v[48:63], a[44:47], v[76:79], v[48:63]
    s_waitcnt vmcnt(12)
    v_mfma_f32_32x32x16_bf16 v[16:31], a[48:51], v[80:83], v[16:31]
    v_mfma_f32_32x32x16_bf16 v[32:47], a[52:55], v[80:83], v[32:47]
    v_mfma_f32_32x32x16_bf16 v[48:63], a[56:59], v[80:83], v[48:63]
    s_waitcnt vmcnt(11)
    v_mfma_f32_32x32x16_bf16 v[16:31], a[60:63], v[84:87], v[16:31]
    v_mfma_f32_32x32x16_bf16 v[32:47], a[64:67], v[84:87], v[32:47]
    v_mfma_f32_32x32x16_bf16 v[48:63], a[68:71], v[84:87], v[48:63]
    s_waitcnt vmcnt(10)
    v_mfma_f32_32x32x16_bf16 v[16:31], a[72:75], v[88:91], v[16:31]
    v_mfma_f32_32x32x16_bf16 v[32:47], a[76:79], v[88:91], v[32:47]
    v_mfma_f32_32x32x16_bf16 v[48:63], a[80:83], v[88:91], v[48:63]
    s_waitcnt vmcnt(9)
    v_mfma_f32_32x32x16_bf16 v[16:31], a[84:87], v[92:95], v[16:31]
    v_mfma_f32_32x32x16_bf16 v[32:47], a[88:91], v[92:95], v[32:47]
    v_mfma_f32_32x32x16_bf16 v[48:63], a[92:95], v[92:95], v[48:63]
    s_waitcnt vmcnt(0)
    v_cmp_ge_u32 vcc, s79, v9
    s_cmp_eq_u32 s78, 0
    s_cbranch_scc1 S3_0_P2
    v_mov_b32 v10, s84
    s_mov_b64 exec, 1
    buffer_store_dword v10, off, s[44:47], s75 sc1
    s_mov_b64 exec, -1
S3_0_P2:
    s_cbranch_vccnz S3_0_N2F
    s_lshr_b32 s79, s83, 2
    s_and_b32 s98, s83, 3
    s_lshl_b32 s98, s98, 2
    s_add_u32 s80, s74, s98
    buffer_load_dword v9, v8, s[44:47], s80 offen sc1
    v_mfma_f32_32x32x16_bf16 v[16:31], a[96:99], v[96:99], v[16:31]
    s_add_u32 s68, s73, 0
    buffer_load_dwordx4 v[128:131], v5, s[44:47], s68 offen offset:0 sc1
    v_mfma_f32_32x32x16_bf16 v[32:47], a[100:103], v[96:99], v[32:47]
    buffer_load_dwordx4 v[132:135], v5, s[44:47], s68 offen offset:1024 sc1
    v_mfma_f32_32x32x16_bf16 v[48:63], a[104:107], v[96:99], v[48:63]
    v_mfma_f32_32x32x16_bf16 v[16:31], a[108:111], v[100:103], v[16:31]
    buffer_load_dwordx4 v[136:139], v5, s[44:47], s68 offen offset:2048 sc1
    v_mfma_f32_32x32x16_bf16 v[32:47], a[112:115], v[100:103], v[32:47]
    buffer_load_dwordx4 v[140:143], v5, s[44:47], s68 offen offset:3072 sc1
    v_mfma_f32_32x32x16_bf16 v[48:63], a[116:119], v[100:103], v[48:63]
    v_mfma_f32_32x32x16_bf16 v[16:31], a[120:123], v[104:107], v[16:31]
    s_add_u32 s68, s73, 4096
    buffer_load_dwordx4 v[144:147], v5, s[44:47], s68 offen offset:0 sc1
    v_mfma_f32_32x32x16_bf16 v[32:47], a[124:127], v[104:107], v[32:47]
    buffer_load_dwordx4 v[148:151], v5, s[44:47], s68 offen offset:1024 sc1
    v_mfma_f32_32x32x16_bf16 v[48:63], a[128:131], v[104:107], v[48:63]
    v_mfma_f32_32x32x16_bf16 v[16:31], a[132:135], v[108:111], v[16:31]
    buffer_load_dwordx4 v[152:155], v5, s[44:47], s68 offen offset:2048 sc1
    v_mfma_f32_32x32x16_bf16 v[32:47], a[136:139], v[108:111], v[32:47]
    buffer_load_dwordx4 v[156:159], v5, s[44:47], s68 offen offset:3072 sc1
    v_mfma_f32_32x32x16_bf16 v[48:63], a[140:143], v[108:111], v[48:63]
    v_mfma_f32_32x32x16_bf16 v[16:31], a[144:147], v[112:115], v[16:31]
    s_add_u32 s68, s73, 532480
    buffer_load_dwordx4 v[160:163], v5, s[44:47], s68 offen offset:0 sc1
    v_mfma_f32_32x32x16_bf16 v[32:47], a[148:151], v[112:115], v[32:47]
    buffer_load_dwordx4 v[164:167], v5, s[44:47], s68 offen offset:1024 sc1
    v_mfma_f32_32x32x16_bf16 v[48:63], a[152:155], v[112:115], v[48:63]
    v_mfma_f32_32x32x16_bf16 v[16:31], a[156:159], v[116:119], v[16:31]
    buffer_load_dwordx4 v[168:171], v5, s[44:47], s68 offen offset:2048 sc1
    v_mfma_f32_32x32x16_bf16 v[32:47], a[160:163], v[116:119], v[32:47]
    buffer_load_dwordx4 v[172:175], v5, s[44:47], s68 offen offset:3072 sc1
    v_mfma_f32_32x32x16_bf16 v[48:63], a[164:167], v[116:119], v[48:63]
    v_mfma_f32_32x32x16_bf16 v[16:31], a[168:171], v[120:123], v[16:31]
    s_add_u32 s68, s73, 536576
    buffer_load_dwordx4 v[176:179], v5, s[44:47], s68 offen offset:0 sc1
    v_mfma_f32_32x32x16_bf16 v[32:47], a[172:175], v[120:123], v[32:47]
    buffer_load_dwordx4 v[180:183], v5, s[44:47], s68 offen offset:1024 sc1
    v_mfma_f32_32x32x16_bf16 v[48:63], a[176:179], v[120:123], v[48:63]
    v_mfma_f32_32x32x16_bf16 v[16:31], a[180:183], v[124:127], v[16:31]
    buffer_load_dwordx4 v[184:187], v5, s[44:47], s68 offen offset:2048 sc1
    v_mfma_f32_32x32x16_bf16 v[32:47], a[184:187], v[124:127], v[32:47]
    buffer_load_dwordx4 v[188:191], v5, s[44:47], s68 offen offset:3072 sc1
    v_mfma_f32_32x32x16_bf16 v[48:63], a[188:191], v[124:127], v[48:63]
    s_mov_b32 s77, 1
    s_mov_b32 s77, 3
    s_branch S3_0_MD
S3_0_N2F:
    buffer_load_dword v9, v8, s[44:47], s80 offen sc1
S3_0_N2:
    v_mfma_f32_32x32x16_bf16 v[16:31], a[96:99], v[96:99], v[16:31]
    v_mfma_f32_32x32x16_bf16 v[32:47], a[100:103], v[96:99], v[32:47]
    v_mfma_f32_32x32x16_bf16 v[48:63], a[104:107], v[96:99], v[48:63]
    v_mfma_f32_32x32x16_bf16 v[16:31], a[108:111], v[100:103], v[16:31]
    v_mfma_f32_32x32x16_bf16 v[32:47], a[112:115], v[100:103], v[32:47]
    v_mfma_f32_32x32x16_bf16 v[48:63], a[116:119], v[100:103], v[48:63]
    v_mfma_f32_32x32x16_bf16 v[16:31], a[120:123], v[104:107], v[16:31]
    v_mfma_f32_32x32x16_bf16 v[32:47], a[124:127], v[104:107], v[32:47]
    v_mfma_f32_32x32x16_bf16 v[48:63], a[128:131], v[104:107], v[48:63]
    v_mfma_f32_32x32x16_bf16 v[16:31], a[132:135], v[108:111], v[16:31]
    v_mfma_f32_32x32x16_bf16 v[32:47], a[136:139], v[108:111], v[32:47]
    v_mfma_f32_32x32x16_bf16 v[48:63], a[140:143], v[108:111], v[48:63]
    v_mfma_f32_32x32x16_bf16 v[16:31], a[144:147], v[112:115], v[16:31]
    v_mfma_f32_32x32x16_bf16 v[32:47], a[148:151], v[112:115], v[32:47]
    v_mfma_f32_32x32x16_bf16 v[48:63], a[152:155], v[112:115], v[48:63]
    v_mfma_f32_32x32x16_bf16 v[16:31], a[156:159], v[116:119], v[16:31]
    v_mfma_f32_32x32x16_bf16 v[32:47], a[160:163], v[116:119], v[32:47]
    v_mfma_f32_32x32x16_bf16 v[48:63], a[164:167], v[116:119], v[48:63]
    v_mfma_f32_32x32x16_bf16 v[16:31], a[168:171], v[120:123], v[16:31]
    v_mfma_f32_32x32x16_bf16 v[32:47], a[172:175], v[120:123], v[32:47]
    v_mfma_f32_32x32x16_bf16 v[48:63], a[176:179], v[120:123], v[48:63]
    v_mfma_f32_32x32x16_bf16 v[16:31], a[180:183], v[124:127], v[16:31]
    v_mfma_f32_32x32x16_bf16 v[32:47], a[184:187], v[124:127], v[32:47]
    v_mfma_f32_32x32x16_bf16 v[48:63], a[188:191], v[124:127], v[48:63]
S3_0_MD:
    v_add_u32 v11, 0, v6
    v_add_u32 v12, 0, v7
    s_nop 7
    ds_write_b128 v11, v[16:19] offset:0
    ds_write_b128 v11, v[20:23] offset:1024
    ds_write_b128 v11, v[24:27] offset:2048
    ds_write_b128 v11, v[28:31] offset:3072
    ds_write_b128 v11, v[32:35] offset:4096
    ds_write_b128 v11, v[36:39] offset:5120
    ds_write_b128 v11, v[40:43] offset:6144
    ds_write_b128 v11, v[44:47] offset:7168
    ds_write_b128 v11, v[48:51] offset:8192
    ds_write_b128 v11, v[52:55] offset:9216
    ds_write_b128 v11, v[56:59] offset:10240
    ds_write_b128 v11, v[60:63] offset:11264
    s_cmp_eq_u32 s77, 1
    s_cbranch_scc1 S3_0_AH
    s_cmp_eq_u32 s77, 3
    s_cbranch_scc1 S3_0_RED
    s_waitcnt vmcnt(0)
    v_cmp_ge_u32 vcc, s79, v9
    s_cbranch_vccnz S3_0_RED
    s_add_u32 s68, s73, 0
    buffer_load_dwordx4 v[128:131], v5, s[44:47], s68 offen offset:0 sc1
    buffer_load_dwordx4 v[132:135], v5, s[44:47], s68 offen offset:1024 sc1
    buffer_load_dwordx4 v[136:139], v5, s[44:47], s68 offen offset:2048 sc1
    buffer_load_dwordx4 v[140:143], v5, s[44:47], s68 offen offset:3072 sc1
    s_add_u32 s68, s73, 4096
    buffer_load_dwordx4 v[144:147], v5, s[44:47], s68 offen offset:0 sc1
    buffer_load_dwordx4 v[148:151], v5, s[44:47], s68 offen offset:1024 sc1
    buffer_load_dwordx4 v[152:155], v5, s[44:47], s68 offen offset:2048 sc1
    buffer_load_dwordx4 v[156:159], v5, s[44:47], s68 offen offset:3072 sc1
    s_add_u32 s68, s73, 532480
    buffer_load_dwordx4 v[160:163], v5, s[44:47], s68 offen offset:0 sc1
    buffer_load_dwordx4 v[164:167], v5, s[44:47], s68 offen offset:1024 sc1
    buffer_load_dwordx4 v[168:171], v5, s[44:47], s68 offen offset:2048 sc1
    buffer_load_dwordx4 v[172:175], v5, s[44:47], s68 offen offset:3072 sc1
    s_add_u32 s68, s73, 536576
    buffer_load_dwordx4 v[176:179], v5, s[44:47], s68 offen offset:0 sc1
    buffer_load_dwordx4 v[180:183], v5, s[44:47], s68 offen offset:1024 sc1
    buffer_load_dwordx4 v[184:187], v5, s[44:47], s68 offen offset:2048 sc1
    buffer_load_dwordx4 v[188:191], v5, s[44:47], s68 offen offset:3072 sc1
    s_mov_b32 s77, 2
    s_branch S3_0_RED
S3_0_AH:
    s_lshr_b32 s79, s83, 2
    s_and_b32 s98, s83, 3
    s_lshl_b32 s98, s98, 2
    s_add_u32 s80, s74, s98
    buffer_load_dword v9, v8, s[44:47], s80 offen sc1
S3_0_RED:
    s_waitcnt lgkmcnt(0)
    s_barrier
    ds_read_b128 v[192:195], v12 offset:0
    ds_read_b128 v[196:199], v12 offset:12288
    ds_read_b128 v[200:203], v12 offset:24576
    ds_read_b128 v[204:207], v12 offset:36864
    ds_read_b128 v[208:211], v12 offset:1024
    ds_read_b128 v[212:215], v12 offset:13312
    ds_read_b128 v[216:219], v12 offset:25600
    ds_read_b128 v[220:223], v12 offset:37888
    ds_read_b128 v[224:227], v12 offset:2048
    ds_read_b128 v[228:231], v12 offset:14336
    ds_read_b128 v[232:235], v12 offset:26624
    ds_read_b128 v[236:239], v12 offset:38912
    s_waitcnt lgkmcnt(8)
    v_pk_add_f32 v[192:193], v[192:193], v[196:197]
    v_pk_add_f32 v[194:195], v[194:195], v[198:199]
    v_pk_add_f32 v[200:201], v[200:201], v[204:205]
    v_pk_add_f32 v[202:203], v[202:203], v[206:207]
    v_pk_add_f32 v[192:193], v[192:193], v[200:201]
    v_pk_add_f32 v[194:195], v[194:195], v[202:203]
    buffer_store_dwordx4 v[192:195], v5, s[44:47], s76 offen offset:0 sc1
    s_waitcnt lgkmcnt(4)
    v_pk_add_f32 v[208:209], v[208:209], v[212:213]
    v_pk_add_f32 v[210:211], v[210:211], v[214:215]
    v_pk_add_f32 v[216:217], v[216:217], v[220:221]
    v_pk_add_f32 v[218:219], v[218:219], v[222:223]
    v_pk_add_f32 v[208:209], v[208:209], v[216:217]
    v_pk_add_f32 v[210:211], v[210:211], v[218:219]
    buffer_store_dwordx4 v[208:211], v5, s[44:47], s76 offen offset:1024 sc1
    s_waitcnt lgkmcnt(0)
    v_pk_add_f32 v[224:225], v[224:225], v[228:229]
    v_pk_add_f32 v[226:227], v[226:227], v[230:231]
    v_pk_add_f32 v[232:233], v[232:233], v[236:237]
    v_pk_add_f32 v[234:235], v[234:235], v[238:239]
    v_pk_add_f32 v[224:225], v[224:225], v[232:233]
    v_pk_add_f32 v[226:227], v[226:227], v[234:235]
    buffer_store_dwordx4 v[224:227], v5, s[44:47], s76 offen offset:2048 sc1
    s_add_u32 s84, s72, 1
    s_mov_b32 s78, s77
    s_mov_b64 vcc, -1
    s_cmp_eq_u32 s77, 2
    s_cbranch_scc1 S3_0_NEXT
    s_cmp_eq_u32 s77, 0
    s_cbranch_scc1 S3_0_IDLE
    s_waitcnt vmcnt(19)
    s_cmp_eq_u32 s77, 3
    s_cbranch_scc1 S3_0_LK
    s_waitcnt vmcnt(3)
S3_0_LK:
    v_cmp_ge_u32 vcc, s79, v9
    s_branch S3_0_NEXT
S3_0_IDLE:
    buffer_load_dword v9, v8, s[44:47], s80 offen sc1
    s_waitcnt vmcnt(0)
    v_cmp_ge_u32 vcc, s79, v9
    v_mov_b32 v10, s84
    s_mov_b64 exec, 1
    buffer_store_dword v10, off, s[44:47], s75 sc1
    s_mov_b64 exec, -1
    s_cmp_gt_u32 s82, 63
    s_cbranch_scc1 S3_END
    s_cbranch_vccz S3_0_POLL_OK
S3_0_POLL:
    buffer_load_dword v9, v8, s[44:47], s80 offen sc1
    s_waitcnt vmcnt(0)
    v_cmp_ge_u32 vcc, s79, v9
    s_cbranch_vccz S3_0_POLL_OK
    s_sleep 4
    s_add_u32 s100, s100, 1
    s_cmp_lt_u32 s100, 262144
    s_cbranch_scc1 spin_ok_61
    s_mov_b32 s98, 10
    s_branch FAIL
spin_ok_61:
    s_branch S3_0_POLL
S3_0_POLL_OK:
    s_add_u32 s68, s73, 0
    buffer_load_dwordx4 v[128:131], v5, s[44:47], s68 offen offset:0 sc1
    buffer_load_dwordx4 v[132:135], v5, s[44:47], s68 offen offset:1024 sc1
    buffer_load_dwordx4 v[136:139], v5, s[44:47], s68 offen offset:2048 sc1
    buffer_load_dwordx4 v[140:143], v5, s[44:47], s68 offen offset:3072 sc1
    s_add_u32 s68, s73, 4096
    buffer_load_dwordx4 v[144:147], v5, s[44:47], s68 offen offset:0 sc1
    buffer_load_dwordx4 v[148:151], v5, s[44:47], s68 offen offset:1024 sc1
    buffer_load_dwordx4 v[152:155], v5, s[44:47], s68 offen offset:2048 sc1
    buffer_load_dwordx4 v[156:159], v5, s[44:47], s68 offen offset:3072 sc1
    s_add_u32 s68, s73, 532480
    buffer_load_dwordx4 v[160:163], v5, s[44:47], s68 offen offset:0 sc1
    buffer_load_dwordx4 v[164:167], v5, s[44:47], s68 offen offset:1024 sc1
    buffer_load_dwordx4 v[168:171], v5, s[44:47], s68 offen offset:2048 sc1
    buffer_load_dwordx4 v[172:175], v5, s[44:47], s68 offen offset:3072 sc1
    s_add_u32 s68, s73, 536576
    buffer_load_dwordx4 v[176:179], v5, s[44:47], s68 offen offset:0 sc1
    buffer_load_dwordx4 v[180:183], v5, s[44:47], s68 offen offset:1024 sc1
    buffer_load_dwordx4 v[184:187], v5, s[44:47], s68 offen offset:2048 sc1
    buffer_load_dwordx4 v[188:191], v5, s[44:47], s68 offen offset:3072 sc1
    s_mov_b64 vcc, -1
S3_0_NEXT:
    s_mov_b32 s72, s82
    s_cmp_ge_u32 s72, 56
    s_addc_u32 s82, s72, 1
    s_cmp_ge_u32 s82, 56
    s_addc_u32 s83, s82, 1
    s_lshl_b32 s73, s82, 13
    s_add_u32 s73, s73, s85
    s_mul_i32 s76, s72, 589824
    s_add_u32 s76, s76, s86
S3_1:
    s_mov_b32 s77, 0
    s_cbranch_vccnz S3_1_N1
    s_waitcnt vmcnt(15)
    v_mfma_f32_32x32x16_bf16 v[16:31], a[0:3], v[128:131], 0
    s_add_u32 s68, s73, 0
    buffer_load_dwordx4 v[64:67], v5, s[44:47], s68 offen offset:0 sc1
    v_mfma_f32_32x32x16_bf16 v[32:47], a[4:7], v[128:131], 0
    buffer_load_dwordx4 v[68:71], v5, s[44:47], s68 offen offset:1024 sc1
    v_mfma_f32_32x32x16_bf16 v[48:63], a[8:11], v[128:131], 0
    s_waitcnt vmcnt(16)
    v_mfma_f32_32x32x16_bf16 v[16:31], a[12:15], v[132:135], v[16:31]
    buffer_load_dwordx4 v[72:75], v5, s[44:47], s68 offen offset:2048 sc1
    v_mfma_f32_32x32x16_bf16 v[32:47], a[16:19], v[132:135], v[32:47]
    buffer_load_dwordx4 v[76:79], v5, s[44:47], s68 offen offset:3072 sc1
    v_mfma_f32_32x32x16_bf16 v[48:63], a[20:23], v[132:135], v[48:63]
    s_waitcnt vmcnt(17)
    v_mfma_f32_32x32x16_bf16 v[16:31], a[24:27], v[136:139], v[16:31]
    s_add_u32 s68, s73, 4096
    buffer_load_dwordx4 v[80:83], v5, s[44:47], s68 offen offset:0 sc1
    v_mfma_f32_32x32x16_bf16 v[32:47], a[28:31], v[136:139], v[32:47]
    buffer_load_dwordx4 v[84:87], v5, s[44:47], s68 offen offset:1024 sc1
    v_mfma_f32_32x32x16_bf16 v[48:63], a[32:35], v[136:139], v[48:63]
    s_waitcnt vmcnt(18)
    v_mfma_f32_32x32x16_bf16 v[16:31], a[36:39], v[140:143], v[16:31]
    buffer_load_dwordx4 v[88:91], v5, s[44:47], s68 offen offset:2048 sc1
    v_mfma_f32_32x32x16_bf16 v[32:47], a[40:43], v[140:143], v[32:47]
    buffer_load_dwordx4 v[92:95], v5, s[44:47], s68 offen offset:3072 sc1
    v_mfma_f32_32x32x16_bf16 v[48:63], a[44:47], v[140:143], v[48:63]
    s_waitcnt vmcnt(19)
    v_mfma_f32_32x32x16_bf16 v[16:31], a[48:51], v[144:147], v[16:31]
    s_add_u32 s68, s73, 532480
    buffer_load_dwordx4 v[96:99], v5, s[44:47], s68 offen offset:0 sc1
    v_mfma_f32_32x32x16_bf16 v[32:47], a[52:55], v[144:147], v[32:47]
    buffer_load_dwordx4 v[100:103], v5, s[44:47], s68 offen offset:1024 sc1
    v_mfma_f32_32x32x16_bf16 v[48:63], a[56:59], v[144:147], v[48:63]
    s_waitcnt vmcnt(20)
    v_mfma_f32_32x32x16_bf16 v[16:31], a[60:63], v[148:151], v[16:31]
    buffer_load_dwordx4 v[104:107], v5, s[44:47], s68 offen offset:2048 sc1
    v_mfma_f32_32x32x16_bf16 v[32:47], a[64:67], v[148:151], v[32:47]
    buffer_load_dwordx4 v[108:111], v5, s[44:47], s68 offen offset:3072 sc1
    v_mfma_f32_32x32x16_bf16 v[48:63], a[68:71], v[148:151], v[48:63]
    s_waitcnt vmcnt(21)
    v_mfma_f32_32x32x16_bf16 v[16:31], a[72:75], v[152:155], v[16:31]
    s_add_u32 s68, s73, 536576
    buffer_load_dwordx4 v[112:115], v5, s[44:47], s68 offen offset:0 sc1
    v_mfma_f32_32x32x16_bf16 v[32:47], a[76:79], v[152:155], v[32:47]
    buffer_load_dwordx4 v[116:119], v5, s[44:47], s68 offen offset:1024 sc1
    v_mfma_f32_32x32x16_bf16 v[48:63], a[80:83], v[152:155], v[48:63]
    s_waitcnt vmcnt(22)
    v_mfma_f32_32x32x16_bf16 v[16:31], a[84:87], v[156:159], v[16:31]
    buffer_load_dwordx4 v[120:123], v5, s[44:47], s68 offen offset:2048 sc1
    v_mfma_f32_32x32x16_bf16 v[32:47], a[88:91], v[156:159], v[32:47]
    buffer_load_dwordx4 v[124:127], v5, s[44:47], s68 offen offset:3072 sc1
    v_mfma_f32_32x32x16_bf16 v[48:63], a[92:95], v[156:159], v[48:63]
    s_mov_b32 s77, 1
    s_waitcnt vmcnt(16)
    s_cmp_eq_u32 s78, 0
    s_cbranch_scc1 S3_1_P1
    v_mov_b32 v10, s84
    s_mov_b64 exec, 1
    buffer_store_dword v10, off, s[44:47], s75 sc1
    s_mov_b64 exec, -1
S3_1_P1:
    s_branch S3_1_N2
S3_1_N1:
    s_lshr_b32 s79, s82, 2
    s_and_b32 s98, s82, 3
    s_lshl_b32 s98, s98, 2
    s_add_u32 s80, s74, s98
    buffer_load_dword v9, v8, s[44:47], s80 offen sc1
    s_waitcnt vmcnt(16)
    v_mfma_f32_32x32x16_bf16 v[16:31], a[0:3], v[128:131], 0
    v_mfma_f32_32x32x16_bf16 v[32:47], a[4:7], v[128:131], 0
    v_mfma_f32_32x32x16_bf16 v[48:63], a[8:11], v[128:131], 0
    s_waitcnt vmcnt(15)
    v_mfma_f32_32x32x16_bf16 v[16:31], a[12:15], v[132:135], v[16:31]
    v_mfma_f32_32x32x16_bf16 v[32:47], a[16:19], v[132:135], v[32:47]
    v_mfma_f32_32x32x16_bf16 v[48:63], a[20:23], v[132:135], v[48:63]
    s_waitcnt vmcnt(14)
    v_mfma_f32_32x32x16_bf16 v[16:31], a[24:27], v[136:139], v[16:31]
    v_mfma_f32_32x32x16_bf16 v[32:47], a[28:31], v[136:139], v[32:47]
    v_mfma_f32_32x32x16_bf16 v[48:63], a[32:35], v[136:139], v[48:63]
    s_waitcnt vmcnt(13)
    v_mfma_f32_32x32x16_bf16 v[16:31], a[36:39], v[140:143], v[16:31]
    v_mfma_f32_32x32x16_bf16 v[32:47], a[40:43], v[140:143], v[32:47]
    v_mfma_f32_32x32x16_bf16 v[48:63], a[44:47], v[140:143], v[48:63]
    s_waitcnt vmcnt(12)
    v_mfma_f32_32x32x16_bf16 v[16:31], a[48:51], v[144:147], v[16:31]
    v_mfma_f32_32x32x16_bf16 v[32:47], a[52:55], v[144:147], v[32:47]
    v_mfma_f32_32x32x16_bf16 v[48:63], a[56:59], v[144:147], v[48:63]
    s_waitcnt vmcnt(11)
    v_mfma_f32_32x32x16_bf16 v[16:31], a[60:63], v[148:151], v[16:31]
    v_mfma_f32_32x32x16_bf16 v[32:47], a[64:67], v[148:151], v[32:47]
    v_mfma_f32_32x32x16_bf16 v[48:63], a[68:71], v[148:151], v[48:63]
    s_waitcnt vmcnt(10)
    v_mfma_f32_32x32x16_bf16 v[16:31], a[72:75], v[152:155], v[16:31]
    v_mfma_f32_32x32x16_bf16 v[32:47], a[76:79], v[152:155], v[32:47]
    v_mfma_f32_32x32x16_bf16 v[48:63], a[80:83], v[152:155], v[48:63]
    s_waitcnt vmcnt(9)
    v_mfma_f32_32x32x16_bf16 v[16:31], a[84:87], v[156:159], v[16:31]
    v_mfma_f32_32x32x16_bf16 v[32:47], a[88:91], v[156:159], v[32:47]
    v_mfma_f32_32x32x16_bf16 v[48:63], a[92:95], v[156:159], v[48:63]
    s_waitcnt vmcnt(0)
    v_cmp_ge_u32 vcc, s79, v9
    s_cmp_eq_u32 s78, 0
    s_cbranch_scc1 S3_1_P2
    v_mov_b32 v10, s84
    s_mov_b64 exec, 1
    buffer_store_dword v10, off, s[44:47], s75 sc1
    s_mov_b64 exec, -1
S3_1_P2:
    s_cbranch_vccnz S3_1_N2F
    s_lshr_b32 s79, s83, 2
    s_and_b32 s98, s83, 3
    s_lshl_b32 s98, s98, 2
    s_add_u32 s80, s74, s98
    buffer_load_dword v9, v8, s[44:47], s80 offen sc1
    v_mfma_f32_32x32x16_bf16 v[16:31], a[96:99], v[160:163], v[16:31]
    s_add_u32 s68, s73, 0
    buffer_load_dwordx4 v[64:67], v5, s[44:47], s68 offen offset:0 sc1
    v_mfma_f32_32x32x16_bf16 v[32:47], a[100:103], v[160:163], v[32:47]
    buffer_load_dwordx4 v[68:71], v5, s[44:47], s68 offen offset:1024 sc1
    v_mfma_f32_32x32x16_bf16 v[48:63], a[104:107], v[160:163], v[48:63]
    v_mfma_f32_32x32x16_bf16 v[16:31], a[108:111], v[164:167], v[16:31]
    buffer_load_dwordx4 v[72:75], v5, s[44:47], s68 offen offset:2048 sc1
    v_mfma_f32_32x32x16_bf16 v[32:47], a[112:115], v[164:167], v[32:47]
    buffer_load_dwordx4 v[76:79], v5, s[44:47], s68 offen offset:3072 sc1
    v_mfma_f32_32x32x16_bf16 v[48:63], a[116:119], v[164:167], v[48:63]
    v_mfma_f32_32x32x16_bf16 v[16:31], a[120:123], v[168:171], v[16:31]
    s_add_u32 s68, s73, 4096
    buffer_load_dwordx4 v[80:83], v5, s[44:47], s68 offen offset:0 sc1
    v_mfma_f32_32x32x16_bf16 v[32:47], a[124:127], v[168:171], v[32:47]
    buffer_load_dwordx4 v[84:87], v5, s[44:47], s68 offen offset:1024 sc1
    v_mfma_f32_32x32x16_bf16 v[48:63], a[128:131], v[168:171], v[48:63]
    v_mfma_f32_32x32x16_bf16 v[16:31], a[132:135], v[172:175], v[16:31]
    buffer_load_dwordx4 v[88:91], v5, s[44:47], s68 offen offset:2048 sc1
    v_mfma_f32_32x32x16_bf16 v[32:47], a[136:139], v[172:175], v[32:47]
    buffer_load_dwordx4 v[92:95], v5, s[44:47], s68 offen offset:3072 sc1
    v_mfma_f32_32x32x16_bf16 v[48:63], a[140:143], v[172:175], v[48:63]
    v_mfma_f32_32x32x16_bf16 v[16:31], a[144:147], v[176:179], v[16:31]
    s_add_u32 s68, s73, 532480
    buffer_load_dwordx4 v[96:99], v5, s[44:47], s68 offen offset:0 sc1
    v_mfma_f32_32x32x16_bf16 v[32:47], a[148:151], v[176:179], v[32:47]
    buffer_load_dwordx4 v[100:103], v5, s[44:47], s68 offen offset:1024 sc1
    v_mfma_f32_32x32x16_bf16 v[48:63], a[152:155], v[176:179], v[48:63]
    v_mfma_f32_32x32x16_bf16 v[16:31], a[156:159], v[180:183], v[16:31]
    buffer_load_dwordx4 v[104:107], v5, s[44:47], s68 offen offset:2048 sc1
    v_mfma_f32_32x32x16_bf16 v[32:47], a[160:163], v[180:183], v[32:47]
    buffer_load_dwordx4 v[108:111], v5, s[44:47], s68 offen offset:3072 sc1
    v_mfma_f32_32x32x16_bf16 v[48:63], a[164:167], v[180:183], v[48:63]
    v_mfma_f32_32x32x16_bf16 v[16:31], a[168:171], v[184:187], v[16:31]
    s_add_u32 s68, s73, 536576
    buffer_load_dwordx4 v[112:115], v5, s[44:47], s68 offen offset:0 sc1
    v_mfma_f32_32x32x16_bf16 v[32:47], a[172:175], v[184:187], v[32:47]
    buffer_load_dwordx4 v[116:119], v5, s[44:47], s68 offen offset:1024 sc1
    v_mfma_f32_32x32x16_bf16 v[48:63], a[176:179], v[184:187], v[48:63]
    v_mfma_f32_32x32x16_bf16 v[16:31], a[180:183], v[188:191], v[16:31]
    buffer_load_dwordx4 v[120:123], v5, s[44:47], s68 offen offset:2048 sc1
    v_mfma_f32_32x32x16_bf16 v[32:47], a[184:187], v[188:191], v[32:47]
    buffer_load_dwordx4 v[124:127], v5, s[44:47], s68 offen offset:3072 sc1
    v_mfma_f32_32x32x16_bf16 v[48:63], a[188:191], v[188:191], v[48:63]
    s_mov_b32 s77, 1
    s_mov_b32 s77, 3
    s_branch S3_1_MD
S3_1_N2F:
    buffer_load_dword v9, v8, s[44:47], s80 offen sc1
S3_1_N2:
    v_mfma_f32_32x32x16_bf16 v[16:31], a[96:99], v[160:163], v[16:31]
    v_mfma_f32_32x32x16_bf16 v[32:47], a[100:103], v[160:163], v[32:47]
    v_mfma_f32_32x32x16_bf16 v[48:63], a[104:107], v[160:163], v[48:63]
    v_mfma_f32_32x32x16_bf16 v[16:31], a[108:111], v[164:167], v[16:31]
    v_mfma_f32_32x32x16_bf16 v[32:47], a[112:115], v[164:167], v[32:47]
    v_mfma_f32_32x32x16_bf16 v[48:63], a[116:119], v[164:167], v[48:63]
    v_mfma_f32_32x32x16_bf16 v[16:31], a[120:123], v[168:171], v[16:31]
    v_mfma_f32_32x32x16_bf16 v[32:47], a[124:127], v[168:171], v[32:47]
    v_mfma_f32_32x32x16_bf16 v[48:63], a[128:131], v[168:171], v[48:63]
    v_mfma_f32_32x32x16_bf16 v[16:31], a[132:135], v[172:175], v[16:31]
    v_mfma_f32_32x32x16_bf16 v[32:47], a[136:139], v[172:175], v[32:47]
    v_mfma_f32_32x32x16_bf16 v[48:63], a[140:143], v[172:175], v[48:63]
    v_mfma_f32_32x32x16_bf16 v[16:31], a[144:147], v[176:179], v[16:31]
    v_mfma_f32_32x32x16_bf16 v[32:47], a[148:151], v[176:179], v[32:47]
    v_mfma_f32_32x32x16_bf16 v[48:63], a[152:155], v[176:179], v[48:63]
    v_mfma_f32_32x32x16_bf16 v[16:31], a[156:159], v[180:183], v[16:31]
    v_mfma_f32_32x32x16_bf16 v[32:47], a[160:163], v[180:183], v[32:47]
    v_mfma_f32_32x32x16_bf16 v[48:63], a[164:167], v[180:183], v[48:63]
    v_mfma_f32_32x32x16_bf16 v[16:31], a[168:171], v[184:187], v[16:31]
    v_mfma_f32_32x32x16_bf16 v[32:47], a[172:175], v[184:187], v[32:47]
    v_mfma_f32_32x32x16_bf16 v[48:63], a[176:179], v[184:187], v[48:63]
    v_mfma_f32_32x32x16_bf16 v[16:31], a[180:183], v[188:191], v[16:31]
    v_mfma_f32_32x32x16_bf16 v[32:47], a[184:187], v[188:191], v[32:47]
    v_mfma_f32_32x32x16_bf16 v[48:63], a[188:191], v[188:191], v[48:63]
S3_1_MD:
    v_add_u32 v11, 49152, v6
    v_add_u32 v12, 49152, v7
    s_nop 7
    ds_write_b128 v11, v[16:19] offset:0
    ds_write_b128 v11, v[20:23] offset:1024
    ds_write_b128 v11, v[24:27] offset:2048
    ds_write_b128 v11, v[28:31] offset:3072
    ds_write_b128 v11, v[32:35] offset:4096
    ds_write_b128 v11, v[36:39] offset:5120
    ds_write_b128 v11, v[40:43] offset:6144
    ds_write_b128 v11, v[44:47] offset:7168
    ds_write_b128 v11, v[48:51] offset:8192
    ds_write_b128 v11, v[52:55] offset:9216
    ds_write_b128 v11, v[56:59] offset:10240
    ds_write_b128 v11, v[60:63] offset:11264
    s_cmp_eq_u32 s77, 1
    s_cbranch_scc1 S3_1_AH
    s_cmp_eq_u32 s77, 3
    s_cbranch_scc1 S3_1_RED
    s_waitcnt vmcnt(0)
    v_cmp_ge_u32 vcc, s79, v9
    s_cbranch_vccnz S3_1_RED
    s_add_u32 s68, s73, 0
    buffer_load_dwordx4 v[64:67], v5, s[44:47], s68 offen offset:0 sc1
    buffer_load_dwordx4 v[68:71], v5, s[44:47], s68 offen offset:1024 sc1
    buffer_load_dwordx4 v[72:75], v5, s[44:47], s68 offen offset:2048 sc1
    buffer_load_dwordx4 v[76:79], v5, s[44:47], s68 offen offset:3072 sc1
    s_add_u32 s68, s73, 4096
    buffer_load_dwordx4 v[80:83], v5, s[44:47], s68 offen offset:0 sc1
    buffer_load_dwordx4 v[84:87], v5, s[44:47], s68 offen offset:1024 sc1
    buffer_load_dwordx4 v[88:91], v5, s[44:47], s68 offen offset:2048 sc1
    buffer_load_dwordx4 v[92:95], v5, s[44:47], s68 offen offset:3072 sc1
    s_add_u32 s68, s73, 532480
    buffer_load_dwordx4 v[96:99], v5, s[44:47], s68 offen offset:0 sc1
    buffer_load_dwordx4 v[100:103], v5, s[44:47], s68 offen offset:1024 sc1
    buffer_load_dwordx4 v[104:107], v5, s[44:47], s68 offen offset:2048 sc1
    buffer_load_dwordx4 v[108:111], v5, s[44:47], s68 offen offset:3072 sc1
    s_add_u32 s68, s73, 536576
    buffer_load_dwordx4 v[112:115], v5, s[44:47], s68 offen offset:0 sc1
    buffer_load_dwordx4 v[116:119], v5, s[44:47], s68 offen offset:1024 sc1
    buffer_load_dwordx4 v[120:123], v5, s[44:47], s68 offen offset:2048 sc1
    buffer_load_dwordx4 v[124:127], v5, s[44:47], s68 offen offset:3072 sc1
    s_mov_b32 s77, 2
    s_branch S3_1_RED
S3_1_AH:
    s_lshr_b32 s79, s83, 2
    s_and_b32 s98, s83, 3
    s_lshl_b32 s98, s98, 2
    s_add_u32 s80, s74, s98
    buffer_load_dword v9, v8, s[44:47], s80 offen sc1
S3_1_RED:
    s_waitcnt lgkmcnt(0)
    s_barrier
    ds_read_b128 v[192:195], v12 offset:0
    ds_read_b128 v[196:199], v12 offset:12288
    ds_read_b128 v[200:203], v12 offset:24576
    ds_read_b128 v[204:207], v12 offset:36864
    ds_read_b128 v[208:211], v12 offset:1024
    ds_read_b128 v[212:215], v12 offset:13312
    ds_read_b128 v[216:219], v12 offset:25600
    ds_read_b128 v[220:223], v12 offset:37888
    ds_read_b128 v[224:227], v12 offset:2048
    ds_read_b128 v[228:231], v12 offset:14336
    ds_read_b128 v[232:235], v12 offset:26624
    ds_read_b128 v[236:239], v12 offset:38912
    s_waitcnt lgkmcnt(8)
    v_pk_add_f32 v[192:193], v[192:193], v[196:197]
    v_pk_add_f32 v[194:195], v[194:195], v[198:199]
    v_pk_add_f32 v[200:201], v[200:201], v[204:205]
    v_pk_add_f32 v[202:203], v[202:203], v[206:207]
    v_pk_add_f32 v[192:193], v[192:193], v[200:201]
    v_pk_add_f32 v[194:195], v[194:195], v[202:203]
    buffer_store_dwordx4 v[192:195], v5, s[44:47], s76 offen offset:0 sc1
    s_waitcnt lgkmcnt(4)
    v_pk_add_f32 v[208:209], v[208:209], v[212:213]
    v_pk_add_f32 v[210:211], v[210:211], v[214:215]
    v_pk_add_f32 v[216:217], v[216:217], v[220:221]
    v_pk_add_f32 v[218:219], v[218:219], v[222:223]
    v_pk_add_f32 v[208:209], v[208:209], v[216:217]
    v_pk_add_f32 v[210:211], v[210:211], v[218:219]
    buffer_store_dwordx4 v[208:211], v5, s[44:47], s76 offen offset:1024 sc1
    s_waitcnt lgkmcnt(0)
    v_pk_add_f32 v[224:225], v[224:225], v[228:229]
    v_pk_add_f32 v[226:227], v[226:227], v[230:231]
    v_pk_add_f32 v[232:233], v[232:233], v[236:237]
    v_pk_add_f32 v[234:235], v[234:235], v[238:239]
    v_pk_add_f32 v[224:225], v[224:225], v[232:233]
    v_pk_add_f32 v[226:227], v[226:227], v[234:235]
    buffer_store_dwordx4 v[224:227], v5, s[44:47], s76 offen offset:2048 sc1
    s_add_u32 s84, s72, 1
    s_mov_b32 s78, s77
    s_mov_b64 vcc, -1
    s_cmp_eq_u32 s77, 2
    s_cbranch_scc1 S3_1_NEXT
    s_cmp_eq_u32 s77, 0
    s_cbranch_scc1 S3_1_IDLE
    s_waitcnt vmcnt(19)
    s_cmp_eq_u32 s77, 3
    s_cbranch_scc1 S3_1_LK
    s_waitcnt vmcnt(3)
S3_1_LK:
    v_cmp_ge_u32 vcc, s79, v9
    s_branch S3_1_NEXT
S3_1_IDLE:
    buffer_load_dword v9, v8, s[44:47], s80 offen sc1
    s_waitcnt vmcnt(0)
    v_cmp_ge_u32 vcc, s79, v9
    v_mov_b32 v10, s84
    s_mov_b64 exec, 1
    buffer_store_dword v10, off, s[44:47], s75 sc1
    s_mov_b64 exec, -1
    s_cmp_gt_u32 s82, 63
    s_cbranch_scc1 S3_END
    s_cbranch_vccz S3_1_POLL_OK
S3_1_POLL:
    buffer_load_dword v9, v8, s[44:47], s80 offen sc1
    s_waitcnt vmcnt(0)
    v_cmp_ge_u32 vcc, s79, v9
    s_cbranch_vccz S3_1_POLL_OK
    s_sleep 4
    s_add_u32 s100, s100, 1
    s_cmp_lt_u32 s100, 262144
    s_cbranch_scc1 spin_ok_62
    s_mov_b32 s98, 10
    s_branch FAIL
spin_ok_62:
    s_branch S3_1_POLL
S3_1_POLL_OK:
    s_add_u32 s68, s73, 0
    buffer_load_dwordx4 v[64:67], v5, s[44:47], s68 offen offset:0 sc1
    buffer_load_dwordx4 v[68:71], v5, s[44:47], s68 offen offset:1024 sc1
    buffer_load_dwordx4 v[72:75], v5, s[44:47], s68 offen offset:2048 sc1
    buffer_load_dwordx4 v[76:79], v5, s[44:47], s68 offen offset:3072 sc1
    s_add_u32 s68, s73, 4096
    buffer_load_dwordx4 v[80:83], v5, s[44:47], s68 offen offset:0 sc1
    buffer_load_dwordx4 v[84:87], v5, s[44:47], s68 offen offset:1024 sc1
    buffer_load_dwordx4 v[88:91], v5, s[44:47], s68 offen offset:2048 sc1
    buffer_load_dwordx4 v[92:95], v5, s[44:47], s68 offen offset:3072 sc1
    s_add_u32 s68, s73, 532480
    buffer_load_dwordx4 v[96:99], v5, s[44:47], s68 offen offset:0 sc1
    buffer_load_dwordx4 v[100:103], v5, s[44:47], s68 offen offset:1024 sc1
    buffer_load_dwordx4 v[104:107], v5, s[44:47], s68 offen offset:2048 sc1
    buffer_load_dwordx4 v[108:111], v5, s[44:47], s68 offen offset:3072 sc1
    s_add_u32 s68, s73, 536576
    buffer_load_dwordx4 v[112:115], v5, s[44:47], s68 offen offset:0 sc1
    buffer_load_dwordx4 v[116:119], v5, s[44:47], s68 offen offset:1024 sc1
    buffer_load_dwordx4 v[120:123], v5, s[44:47], s68 offen offset:2048 sc1
    buffer_load_dwordx4 v[124:127], v5, s[44:47], s68 offen offset:3072 sc1
    s_mov_b64 vcc, -1
S3_1_NEXT:
    s_mov_b32 s72, s82
    s_cmp_ge_u32 s72, 56
    s_addc_u32 s82, s72, 1
    s_cmp_ge_u32 s82, 56
    s_addc_u32 s83, s82, 1
    s_lshl_b32 s73, s82, 13
    s_add_u32 s73, s73, s85
    s_mul_i32 s76, s72, 589824
    s_add_u32 s76, s76, s86
    s_branch S3_0
S3_END:
    s_branch END
.p2align 6
ROLE_R:
    s_waitcnt vmcnt(0)
    s_mov_b32 s52, s8
    s_and_b32 s53, s9, 0xffff
    s_mov_b32 s54, 2359296
    s_mov_b32 s55, 0x20000
    s_mov_b32 s56, s36
    s_and_b32 s57, s37, 0xffff
    s_mov_b32 s58, 1152
    s_mov_b32 s59, 0x20000
    s_mov_b32 s60, s38
    s_and_b32 s61, s39, 0xffff
    s_mov_b32 s62, 2359296
    s_mov_b32 s63, 0x20000
    s_lshl_b32 s68, s6, 3
    s_add_u32 s68, s68, s5
    s_sub_u32 s68, s68, 24
    s_lshl_b32 s68, s68, 2
    s_add_u32 s68, s68, s3
    v_and_b32 v16, 31, v0
    v_lshrrev_b32 v17, 5, v0
    v_mul_u32_u24 v18, 1152, v16
    v_lshl_add_u32 v1, v17, 4, v18
    v_lshlrev_b32 v2, 4, v17
    v_lshlrev_b32 v4, 4, v0
    v_lshlrev_b32 v6, 2, v16
    v_mov_b32 v5, v1
    s_mov_b32 s76, 0xffff0000
    s_mul_i32 s75, s68, 36864
    v_mov_b32 v20, 0
    buffer_load_dwordx4 v[32:35], v1, s[52:55], s75 offen offset:0
    buffer_load_dwordx4 v[112:115], v2, s[56:59], 0 offen offset:0
    buffer_load_dwordx4 v[36:39], v1, s[52:55], s75 offen offset:32
    buffer_load_dwordx4 v[116:119], v2, s[56:59], 0 offen offset:32
    buffer_load_dwordx4 v[40:43], v1, s[52:55], s75 offen offset:64
    buffer_load_dwordx4 v[120:123], v2, s[56:59], 0 offen offset:64
    buffer_load_dwordx4 v[44:47], v1, s[52:55], s75 offen offset:96
    buffer_load_dwordx4 v[124:127], v2, s[56:59], 0 offen offset:96
    buffer_load_dwordx4 v[48:51], v1, s[52:55], s75 offen offset:128
    buffer_load_dwordx4 v[128:131], v2, s[56:59], 0 offen offset:128
    buffer_load_dwordx4 v[52:55], v1, s[52:55], s75 offen offset:160
    buffer_load_dwordx4 v[132:135], v2, s[56:59], 0 offen offset:160
    buffer_load_dwordx4 v[56:59], v1, s[52:55], s75 offen offset:192
    buffer_load_dwordx4 v[136:139], v2, s[56:59], 0 offen offset:192
    buffer_load_dwordx4 v[60:63], v1, s[52:55], s75 offen offset:224
    buffer_load_dwordx4 v[140:143], v2, s[56:59], 0 offen offset:224
    buffer_load_dwordx4 v[64:67], v1, s[52:55], s75 offen offset:256
    buffer_load_dwordx4 v[144:147], v2, s[56:59], 0 offen offset:256
    buffer_load_dwordx4 v[68:71], v1, s[52:55], s75 offen offset:288
    buffer_load_dwordx4 v[148:151], v2, s[56:59], 0 offen offset:288
    buffer_load_dwordx4 v[72:75], v1, s[52:55], s75 offen offset:320
    buffer_load_dwordx4 v[152:155], v2, s[56:59], 0 offen offset:320
    buffer_load_dwordx4 v[76:79], v1, s[52:55], s75 offen offset:352
    buffer_load_dwordx4 v[156:159], v2, s[56:59], 0 offen offset:352
    buffer_load_dwordx4 v[80:83], v1, s[52:55], s75 offen offset:384
    buffer_load_dwordx4 v[160:163], v2, s[56:59], 0 offen offset:384
    buffer_load_dwordx4 v[84:87], v1, s[52:55], s75 offen offset:416
    buffer_load_dwordx4 v[164:167], v2, s[56:59], 0 offen offset:416
    buffer_load_dwordx4 v[88:91], v1, s[52:55], s75 offen offset:448
    buffer_load_dwordx4 v[168:171], v2, s[56:59], 0 offen offset:448
    buffer_load_dwordx4 v[92:95], v1, s[52:55], s75 offen offset:480
    buffer_load_dwordx4 v[172:175], v2, s[56:59], 0 offen offset:480
    buffer_load_dwordx4 v[96:99], v1, s[52:55], s75 offen offset:512
    buffer_load_dwordx4 v[176:179], v2, s[56:59], 0 offen offset:512
    buffer_load_dwordx4 v[100:103], v1, s[52:55], s75 offen offset:544
    buffer_load_dwordx4 v[180:183], v2, s[56:59], 0 offen offset:544
    s_waitcnt vmcnt(0)
    s_add_u32 s70, s75, 6291456
    buffer_store_dwordx4 v[32:35], v4, s[44:47], s70 offen offset:0 sc1
    buffer_store_dwordx4 v[36:39], v4, s[44:47], s70 offen offset:1024 sc1
    buffer_store_dwordx4 v[40:43], v4, s[44:47], s70 offen offset:2048 sc1
    buffer_store_dwordx4 v[44:47], v4, s[44:47], s70 offen offset:3072 sc1
    s_add_u32 s70, s75, 6295552
    buffer_store_dwordx4 v[48:51], v4, s[44:47], s70 offen offset:0 sc1
    buffer_store_dwordx4 v[52:55], v4, s[44:47], s70 offen offset:1024 sc1
    buffer_store_dwordx4 v[56:59], v4, s[44:47], s70 offen offset:2048 sc1
    buffer_store_dwordx4 v[60:63], v4, s[44:47], s70 offen offset:3072 sc1
    s_add_u32 s70, s75, 6299648
    buffer_store_dwordx4 v[64:67], v4, s[44:47], s70 offen offset:0 sc1
    buffer_store_dwordx4 v[68:71], v4, s[44:47], s70 offen offset:1024 sc1
    buffer_store_dwordx4 v[72:75], v4, s[44:47], s70 offen offset:2048 sc1
    buffer_store_dwordx4 v[76:79], v4, s[44:47], s70 offen offset:3072 sc1
    s_add_u32 s70, s75, 6303744
    buffer_store_dwordx4 v[80:83], v4, s[44:47], s70 offen offset:0 sc1
    buffer_store_dwordx4 v[84:87], v4, s[44:47], s70 offen offset:1024 sc1
    buffer_store_dwordx4 v[88:91], v4, s[44:47], s70 offen offset:2048 sc1
    buffer_store_dwordx4 v[92:95], v4, s[44:47], s70 offen offset:3072 sc1
    s_add_u32 s70, s75, 6307840
    buffer_store_dwordx4 v[96:99], v4, s[44:47], s70 offen offset:0 sc1
    buffer_store_dwordx4 v[100:103], v4, s[44:47], s70 offen offset:1024 sc1
    v_dot2c_f32_bf16 v20, v32, v112
    v_dot2c_f32_bf16 v20, v33, v113
    v_dot2c_f32_bf16 v20, v34, v114
    v_dot2c_f32_bf16 v20, v35, v115
    v_dot2c_f32_bf16 v20, v36, v116
    v_dot2c_f32_bf16 v20, v37, v117
    v_dot2c_f32_bf16 v20, v38, v118
    v_dot2c_f32_bf16 v20, v39, v119
    v_dot2c_f32_bf16 v20, v40, v120
    v_dot2c_f32_bf16 v20, v41, v121
    v_dot2c_f32_bf16 v20, v42, v122
    v_dot2c_f32_bf16 v20, v43, v123
    v_dot2c_f32_bf16 v20, v44, v124
    v_dot2c_f32_bf16 v20, v45, v125
    v_dot2c_f32_bf16 v20, v46, v126
    v_dot2c_f32_bf16 v20, v47, v127
    v_dot2c_f32_bf16 v20, v48, v128
    v_dot2c_f32_bf16 v20, v49, v129
    v_dot2c_f32_bf16 v20, v50, v130
    v_dot2c_f32_bf16 v20, v51, v131
    v_dot2c_f32_bf16 v20, v52, v132
    v_dot2c_f32_bf16 v20, v53, v133
    v_dot2c_f32_bf16 v20, v54, v134
    v_dot2c_f32_bf16 v20, v55, v135
    v_dot2c_f32_bf16 v20, v56, v136
    v_dot2c_f32_bf16 v20, v57, v137
    v_dot2c_f32_bf16 v20, v58, v138
    v_dot2c_f32_bf16 v20, v59, v139
    v_dot2c_f32_bf16 v20, v60, v140
    v_dot2c_f32_bf16 v20, v61, v141
    v_dot2c_f32_bf16 v20, v62, v142
    v_dot2c_f32_bf16 v20, v63, v143
    v_dot2c_f32_bf16 v20, v64, v144
    v_dot2c_f32_bf16 v20, v65, v145
    v_dot2c_f32_bf16 v20, v66, v146
    v_dot2c_f32_bf16 v20, v67, v147
    v_dot2c_f32_bf16 v20, v68, v148
    v_dot2c_f32_bf16 v20, v69, v149
    v_dot2c_f32_bf16 v20, v70, v150
    v_dot2c_f32_bf16 v20, v71, v151
    v_dot2c_f32_bf16 v20, v72, v152
    v_dot2c_f32_bf16 v20, v73, v153
    v_dot2c_f32_bf16 v20, v74, v154
    v_dot2c_f32_bf16 v20, v75, v155
    v_dot2c_f32_bf16 v20, v76, v156
    v_dot2c_f32_bf16 v20, v77, v157
    v_dot2c_f32_bf16 v20, v78, v158
    v_dot2c_f32_bf16 v20, v79, v159
    v_dot2c_f32_bf16 v20, v80, v160
    v_dot2c_f32_bf16 v20, v81, v161
    v_dot2c_f32_bf16 v20, v82, v162
    v_dot2c_f32_bf16 v20, v83, v163
    v_dot2c_f32_bf16 v20, v84, v164
    v_dot2c_f32_bf16 v20, v85, v165
    v_dot2c_f32_bf16 v20, v86, v166
    v_dot2c_f32_bf16 v20, v87, v167
    v_dot2c_f32_bf16 v20, v88, v168
    v_dot2c_f32_bf16 v20, v89, v169
    v_dot2c_f32_bf16 v20, v90, v170
    v_dot2c_f32_bf16 v20, v91, v171
    v_dot2c_f32_bf16 v20, v92, v172
    v_dot2c_f32_bf16 v20, v93, v173
    v_dot2c_f32_bf16 v20, v94, v174
    v_dot2c_f32_bf16 v20, v95, v175
    v_dot2c_f32_bf16 v20, v96, v176
    v_dot2c_f32_bf16 v20, v97, v177
    v_dot2c_f32_bf16 v20, v98, v178
    v_dot2c_f32_bf16 v20, v99, v179
    v_dot2c_f32_bf16 v20, v100, v180
    v_dot2c_f32_bf16 v20, v101, v181
    v_dot2c_f32_bf16 v20, v102, v182
    v_dot2c_f32_bf16 v20, v103, v183
    buffer_load_dwordx4 v[32:35], v1, s[52:55], s75 offen offset:576
    buffer_load_dwordx4 v[112:115], v2, s[56:59], 0 offen offset:576
    buffer_load_dwordx4 v[36:39], v1, s[52:55], s75 offen offset:608
    buffer_load_dwordx4 v[116:119], v2, s[56:59], 0 offen offset:608
    buffer_load_dwordx4 v[40:43], v1, s[52:55], s75 offen offset:640
    buffer_load_dwordx4 v[120:123], v2, s[56:59], 0 offen offset:640
    buffer_load_dwordx4 v[44:47], v1, s[52:55], s75 offen offset:672
    buffer_load_dwordx4 v[124:127], v2, s[56:59], 0 offen offset:672
    buffer_load_dwordx4 v[48:51], v1, s[52:55], s75 offen offset:704
    buffer_load_dwordx4 v[128:131], v2, s[56:59], 0 offen offset:704
    buffer_load_dwordx4 v[52:55], v1, s[52:55], s75 offen offset:736
    buffer_load_dwordx4 v[132:135], v2, s[56:59], 0 offen offset:736
    buffer_load_dwordx4 v[56:59], v1, s[52:55], s75 offen offset:768
    buffer_load_dwordx4 v[136:139], v2, s[56:59], 0 offen offset:768
    buffer_load_dwordx4 v[60:63], v1, s[52:55], s75 offen offset:800
    buffer_load_dwordx4 v[140:143], v2, s[56:59], 0 offen offset:800
    buffer_load_dwordx4 v[64:67], v1, s[52:55], s75 offen offset:832
    buffer_load_dwordx4 v[144:147], v2, s[56:59], 0 offen offset:832
    buffer_load_dwordx4 v[68:71], v1, s[52:55], s75 offen offset:864
    buffer_load_dwordx4 v[148:151], v2, s[56:59], 0 offen offset:864
    buffer_load_dwordx4 v[72:75], v1, s[52:55], s75 offen offset:896
    buffer_load_dwordx4 v[152:155], v2, s[56:59], 0 offen offset:896
    buffer_load_dwordx4 v[76:79], v1, s[52:55], s75 offen offset:928
    buffer_load_dwordx4 v[156:159], v2, s[56:59], 0 offen offset:928
    buffer_load_dwordx4 v[80:83], v1, s[52:55], s75 offen offset:960
    buffer_load_dwordx4 v[160:163], v2, s[56:59], 0 offen offset:960
    buffer_load_dwordx4 v[84:87], v1, s[52:55], s75 offen offset:992
    buffer_load_dwordx4 v[164:167], v2, s[56:59], 0 offen offset:992
    buffer_load_dwordx4 v[88:91], v1, s[52:55], s75 offen offset:1024
    buffer_load_dwordx4 v[168:171], v2, s[56:59], 0 offen offset:1024
    buffer_load_dwordx4 v[92:95], v1, s[52:55], s75 offen offset:1056
    buffer_load_dwordx4 v[172:175], v2, s[56:59], 0 offen offset:1056
    buffer_load_dwordx4 v[96:99], v1, s[52:55], s75 offen offset:1088
    buffer_load_dwordx4 v[176:179], v2, s[56:59], 0 offen offset:1088
    buffer_load_dwordx4 v[100:103], v1, s[52:55], s75 offen offset:1120
    buffer_load_dwordx4 v[180:183], v2, s[56:59], 0 offen offset:1120
    s_waitcnt vmcnt(0)
    s_add_u32 s70, s75, 6309888
    buffer_store_dwordx4 v[32:35], v4, s[44:47], s70 offen offset:0 sc1
    buffer_store_dwordx4 v[36:39], v4, s[44:47], s70 offen offset:1024 sc1
    buffer_store_dwordx4 v[40:43], v4, s[44:47], s70 offen offset:2048 sc1
    buffer_store_dwordx4 v[44:47], v4, s[44:47], s70 offen offset:3072 sc1
    s_add_u32 s70, s75, 6313984
    buffer_store_dwordx4 v[48:51], v4, s[44:47], s70 offen offset:0 sc1
    buffer_store_dwordx4 v[52:55], v4, s[44:47], s70 offen offset:1024 sc1
    buffer_store_dwordx4 v[56:59], v4, s[44:47], s70 offen offset:2048 sc1
    buffer_store_dwordx4 v[60:63], v4, s[44:47], s70 offen offset:3072 sc1
    s_add_u32 s70, s75, 6318080
    buffer_store_dwordx4 v[64:67], v4, s[44:47], s70 offen offset:0 sc1
    buffer_store_dwordx4 v[68:71], v4, s[44:47], s70 offen offset:1024 sc1
    buffer_store_dwordx4 v[72:75], v4, s[44:47], s70 offen offset:2048 sc1
    buffer_store_dwordx4 v[76:79], v4, s[44:47], s70 offen offset:3072 sc1
    s_add_u32 s70, s75, 6322176
    buffer_store_dwordx4 v[80:83], v4, s[44:47], s70 offen offset:0 sc1
    buffer_store_dwordx4 v[84:87], v4, s[44:47], s70 offen offset:1024 sc1
    buffer_store_dwordx4 v[88:91], v4, s[44:47], s70 offen offset:2048 sc1
    buffer_store_dwordx4 v[92:95], v4, s[44:47], s70 offen offset:3072 sc1
    s_add_u32 s70, s75, 6326272
    buffer_store_dwordx4 v[96:99], v4, s[44:47], s70 offen offset:0 sc1
    buffer_store_dwordx4 v[100:103], v4, s[44:47], s70 offen offset:1024 sc1
    v_dot2c_f32_bf16 v20, v32, v112
    v_dot2c_f32_bf16 v20, v33, v113
    v_dot2c_f32_bf16 v20, v34, v114
    v_dot2c_f32_bf16 v20, v35, v115
    v_dot2c_f32_bf16 v20, v36, v116
    v_dot2c_f32_bf16 v20, v37, v117
    v_dot2c_f32_bf16 v20, v38, v118
    v_dot2c_f32_bf16 v20, v39, v119
    v_dot2c_f32_bf16 v20, v40, v120
    v_dot2c_f32_bf16 v20, v41, v121
    v_dot2c_f32_bf16 v20, v42, v122
    v_dot2c_f32_bf16 v20, v43, v123
    v_dot2c_f32_bf16 v20, v44, v124
    v_dot2c_f32_bf16 v20, v45, v125
    v_dot2c_f32_bf16 v20, v46, v126
    v_dot2c_f32_bf16 v20, v47, v127
    v_dot2c_f32_bf16 v20, v48, v128
    v_dot2c_f32_bf16 v20, v49, v129
    v_dot2c_f32_bf16 v20, v50, v130
    v_dot2c_f32_bf16 v20, v51, v131
    v_dot2c_f32_bf16 v20, v52, v132
    v_dot2c_f32_bf16 v20, v53, v133
    v_dot2c_f32_bf16 v20, v54, v134
    v_dot2c_f32_bf16 v20, v55, v135
    v_dot2c_f32_bf16 v20, v56, v136
    v_dot2c_f32_bf16 v20, v57, v137
    v_dot2c_f32_bf16 v20, v58, v138
    v_dot2c_f32_bf16 v20, v59, v139
    v_dot2c_f32_bf16 v20, v60, v140
    v_dot2c_f32_bf16 v20, v61, v141
    v_dot2c_f32_bf16 v20, v62, v142
    v_dot2c_f32_bf16 v20, v63, v143
    v_dot2c_f32_bf16 v20, v64, v144
    v_dot2c_f32_bf16 v20, v65, v145
    v_dot2c_f32_bf16 v20, v66, v146
    v_dot2c_f32_bf16 v20, v67, v147
    v_dot2c_f32_bf16 v20, v68, v148
    v_dot2c_f32_bf16 v20, v69, v149
    v_dot2c_f32_bf16 v20, v70, v150
    v_dot2c_f32_bf16 v20, v71, v151
    v_dot2c_f32_bf16 v20, v72, v152
    v_dot2c_f32_bf16 v20, v73, v153
    v_dot2c_f32_bf16 v20, v74, v154
    v_dot2c_f32_bf16 v20, v75, v155
    v_dot2c_f32_bf16 v20, v76, v156
    v_dot2c_f32_bf16 v20, v77, v157
    v_dot2c_f32_bf16 v20, v78, v158
    v_dot2c_f32_bf16 v20, v79, v159
    v_dot2c_f32_bf16 v20, v80, v160
    v_dot2c_f32_bf16 v20, v81, v161
    v_dot2c_f32_bf16 v20, v82, v162
    v_dot2c_f32_bf16 v20, v83, v163
    v_dot2c_f32_bf16 v20, v84, v164
    v_dot2c_f32_bf16 v20, v85, v165
    v_dot2c_f32_bf16 v20, v86, v166
    v_dot2c_f32_bf16 v20, v87, v167
    v_dot2c_f32_bf16 v20, v88, v168
    v_dot2c_f32_bf16 v20, v89, v169
    v_dot2c_f32_bf16 v20, v90, v170
    v_dot2c_f32_bf16 v20, v91, v171
    v_dot2c_f32_bf16 v20, v92, v172
    v_dot2c_f32_bf16 v20, v93, v173
    v_dot2c_f32_bf16 v20, v94, v174
    v_dot2c_f32_bf16 v20, v95, v175
    v_dot2c_f32_bf16 v20, v96, v176
    v_dot2c_f32_bf16 v20, v97, v177
    v_dot2c_f32_bf16 v20, v98, v178
    v_dot2c_f32_bf16 v20, v99, v179
    v_dot2c_f32_bf16 v20, v100, v180
    v_dot2c_f32_bf16 v20, v101, v181
    v_dot2c_f32_bf16 v20, v102, v182
    v_dot2c_f32_bf16 v20, v103, v183
    s_nop 3
    v_mov_b32 v21, v20
    s_nop 1
    v_permlane32_swap_b32 v20, v21
    v_add_f32 v20, v20, v21
    v_cvt_pk_bf16_f32 v20, v20, v20
    v_lshlrev_b32 v20, 16, v20
    v_mul_f32 v20, 0xbfb8aa3b, v20
    v_exp_f32 v20, v20
    s_nop 0
    v_add_f32 v20, 1.0, v20
    v_rcp_f32 v20, v20
    s_nop 0
    v_cvt_pk_bf16_f32 v20, v20, v20
    v_lshlrev_b32 v20, 16, v20
    v_lshlrev_b32 v22, 2, v0
waitd_63:
    buffer_load_dword v23, v22, s[48:51], 0 offen sc1
    s_waitcnt vmcnt(0)
    v_readlane_b32 s98, v23, 51
    s_cmp_ge_u32 s98, 128
    s_cbranch_scc1 waitd_done_64
dno_65:
    s_sleep 8
    s_add_u32 s100, s100, 1
    s_cmp_lt_u32 s100, 262144
    s_cbranch_scc1 spin_ok_66
    s_mov_b32 s98, 1
    s_branch FAIL
spin_ok_66:
    s_branch waitd_63
waitd_done_64:
    s_lshl_b32 s75, s68, 7
    s_add_u32 s75, s75, 147456
    buffer_store_dword v20, v6, s[44:47], s75 offen sc1
    s_cmp_ge_u32 s68, 48
    s_cbranch_scc1 END
    s_cmp_ge_u32 s68, 24
    s_cselect_b32 s69, 1, 0
    s_mul_i32 s98, s69, 24
    s_sub_u32 s98, s68, s98
    s_mul_i32 s72, s69, 589824
    s_mul_i32 s99, s98, 3072
    s_add_u32 s72, s72, s99
    s_add_u32 s72, s72, 140509184
    s_mul_i32 s73, s69, 36864
    s_mul_i32 s99, s98, 48
    s_add_u32 s73, s73, s99
    s_lshl_b32 s74, s69, 7
    s_add_u32 s74, s74, 147456
    v_and_b32 v18, 7, v0
    v_mul_u32_u24 v18, 24, v18
    v_add_u32 v18, s98, v18
    v_lshlrev_b32 v18, 7, v18
    v_add_u32 v3, 24576, v18
    v_mul_u32_u24 v18, 1152, v16
    v_lshl_add_u32 v5, v17, 3, v18
R_LOOP:
    buffer_load_dword v7, v6, s[44:47], s74 offen sc1
    s_and_b32 s71, s69, 1
    s_lshl_b32 s71, s71, 6
    s_cmp_gt_u32 s69, 56
    s_cselect_b32 s71, s71, 0
    buffer_load_dword v16, v3, s[44:47], s71 offen sc1
    s_waitcnt vmcnt(0)
    v_cmp_ge_u32 vcc, s69, v16
    v_cmp_eq_u32 s[96:97], -1, v7
    s_or_b64 vcc, vcc, s[96:97]
    s_cbranch_vccz R_GO
    s_sleep 4
    s_add_u32 s100, s100, 1
    s_cmp_lt_u32 s100, 262144
    s_cbranch_scc1 spin_ok_67
    s_mov_b32 s98, 11
    s_branch FAIL
spin_ok_67:
    s_branch R_LOOP
R_GO:
    s_add_u32 s75, s72, 0
    buffer_load_dwordx4 v[32:35], v4, s[44:47], s75 offen offset:0 sc1
    buffer_load_dwordx4 v[36:39], v4, s[44:47], s75 offen offset:1024 sc1
    buffer_load_dwordx4 v[40:43], v4, s[44:47], s75 offen offset:2048 sc1
    s_add_u32 s75, s72, 73728
    buffer_load_dwordx4 v[44:47], v4, s[44:47], s75 offen offset:0 sc1
    buffer_load_dwordx4 v[48:51], v4, s[44:47], s75 offen offset:1024 sc1
    buffer_load_dwordx4 v[52:55], v4, s[44:47], s75 offen offset:2048 sc1
    s_add_u32 s75, s72, 147456
    buffer_load_dwordx4 v[56:59], v4, s[44:47], s75 offen offset:0 sc1
    buffer_load_dwordx4 v[60:63], v4, s[44:47], s75 offen offset:1024 sc1
    buffer_load_dwordx4 v[64:67], v4, s[44:47], s75 offen offset:2048 sc1
    s_add_u32 s75, s72, 221184
    buffer_load_dwordx4 v[68:71], v4, s[44:47], s75 offen offset:0 sc1
    buffer_load_dwordx4 v[72:75], v4, s[44:47], s75 offen offset:1024 sc1
    buffer_load_dwordx4 v[76:79], v4, s[44:47], s75 offen offset:2048 sc1
    s_add_u32 s75, s72, 294912
    buffer_load_dwordx4 v[80:83], v4, s[44:47], s75 offen offset:0 sc1
    buffer_load_dwordx4 v[84:87], v4, s[44:47], s75 offen offset:1024 sc1
    buffer_load_dwordx4 v[88:91], v4, s[44:47], s75 offen offset:2048 sc1
    s_add_u32 s75, s72, 368640
    buffer_load_dwordx4 v[92:95], v4, s[44:47], s75 offen offset:0 sc1
    buffer_load_dwordx4 v[96:99], v4, s[44:47], s75 offen offset:1024 sc1
    buffer_load_dwordx4 v[100:103], v4, s[44:47], s75 offen offset:2048 sc1
    s_add_u32 s75, s72, 442368
    buffer_load_dwordx4 v[104:107], v4, s[44:47], s75 offen offset:0 sc1
    buffer_load_dwordx4 v[108:111], v4, s[44:47], s75 offen offset:1024 sc1
    buffer_load_dwordx4 v[112:115], v4, s[44:47], s75 offen offset:2048 sc1
    s_add_u32 s75, s72, 516096
    buffer_load_dwordx4 v[116:119], v4, s[44:47], s75 offen offset:0 sc1
    buffer_load_dwordx4 v[120:123], v4, s[44:47], s75 offen offset:1024 sc1
    buffer_load_dwordx4 v[124:127], v4, s[44:47], s75 offen offset:2048 sc1
    v_sub_f32 v8, 1.0, v7
    v_cvt_pk_bf16_f32 v8, v8, v8
    v_lshlrev_b32 v8, 16, v8
    s_waitcnt vmcnt(18)
    v_pk_add_f32 v[32:33], v[32:33], v[44:45]
    v_pk_add_f32 v[34:35], v[34:35], v[46:47]
    v_pk_add_f32 v[36:37], v[36:37], v[48:49]
    v_pk_add_f32 v[38:39], v[38:39], v[50:51]
    v_pk_add_f32 v[40:41], v[40:41], v[52:53]
    v_pk_add_f32 v[42:43], v[42:43], v[54:55]
    s_waitcnt vmcnt(15)
    v_pk_add_f32 v[32:33], v[32:33], v[56:57]
    v_pk_add_f32 v[34:35], v[34:35], v[58:59]
    v_pk_add_f32 v[36:37], v[36:37], v[60:61]
    v_pk_add_f32 v[38:39], v[38:39], v[62:63]
    v_pk_add_f32 v[40:41], v[40:41], v[64:65]
    v_pk_add_f32 v[42:43], v[42:43], v[66:67]
    s_waitcnt vmcnt(12)
    v_pk_add_f32 v[32:33], v[32:33], v[68:69]
    v_pk_add_f32 v[34:35], v[34:35], v[70:71]
    v_pk_add_f32 v[36:37], v[36:37], v[72:73]
    v_pk_add_f32 v[38:39], v[38:39], v[74:75]
    v_pk_add_f32 v[40:41], v[40:41], v[76:77]
    v_pk_add_f32 v[42:43], v[42:43], v[78:79]
    v_cvt_pk_bf16_f32 v16, v32, v33
    v_lshlrev_b32 v32, 16, v16
    v_and_b32 v33, s76, v16
    v_mul_f32 v32, v7, v32
    v_mul_f32 v33, v7, v33
    v_cvt_pk_bf16_f32 v16, v32, v33
    v_lshlrev_b32 v32, 16, v16
    v_and_b32 v33, s76, v16
    v_cvt_pk_bf16_f32 v16, v34, v35
    v_lshlrev_b32 v34, 16, v16
    v_and_b32 v35, s76, v16
    v_mul_f32 v34, v7, v34
    v_mul_f32 v35, v7, v35
    v_cvt_pk_bf16_f32 v16, v34, v35
    v_lshlrev_b32 v34, 16, v16
    v_and_b32 v35, s76, v16
    v_cvt_pk_bf16_f32 v16, v36, v37
    v_lshlrev_b32 v36, 16, v16
    v_and_b32 v37, s76, v16
    v_mul_f32 v36, v7, v36
    v_mul_f32 v37, v7, v37
    v_cvt_pk_bf16_f32 v16, v36, v37
    v_lshlrev_b32 v36, 16, v16
    v_and_b32 v37, s76, v16
    v_cvt_pk_bf16_f32 v16, v38, v39
    v_lshlrev_b32 v38, 16, v16
    v_and_b32 v39, s76, v16
    v_mul_f32 v38, v7, v38
    v_mul_f32 v39, v7, v39
    v_cvt_pk_bf16_f32 v16, v38, v39
    v_lshlrev_b32 v38, 16, v16
    v_and_b32 v39, s76, v16
    v_cvt_pk_bf16_f32 v16, v40, v41
    v_lshlrev_b32 v40, 16, v16
    v_and_b32 v41, s76, v16
    v_mul_f32 v40, v7, v40
    v_mul_f32 v41, v7, v41
    v_cvt_pk_bf16_f32 v16, v40, v41
    v_lshlrev_b32 v40, 16, v16
    v_and_b32 v41, s76, v16
    v_cvt_pk_bf16_f32 v16, v42, v43
    v_lshlrev_b32 v42, 16, v16
    v_and_b32 v43, s76, v16
    v_mul_f32 v42, v7, v42
    v_mul_f32 v43, v7, v43
    v_cvt_pk_bf16_f32 v16, v42, v43
    v_lshlrev_b32 v42, 16, v16
    v_and_b32 v43, s76, v16
    s_waitcnt vmcnt(6)
    v_pk_add_f32 v[80:81], v[80:81], v[92:93]
    v_pk_add_f32 v[82:83], v[82:83], v[94:95]
    v_pk_add_f32 v[84:85], v[84:85], v[96:97]
    v_pk_add_f32 v[86:87], v[86:87], v[98:99]
    v_pk_add_f32 v[88:89], v[88:89], v[100:101]
    v_pk_add_f32 v[90:91], v[90:91], v[102:103]
    s_waitcnt vmcnt(3)
    v_pk_add_f32 v[80:81], v[80:81], v[104:105]
    v_pk_add_f32 v[82:83], v[82:83], v[106:107]
    v_pk_add_f32 v[84:85], v[84:85], v[108:109]
    v_pk_add_f32 v[86:87], v[86:87], v[110:111]
    v_pk_add_f32 v[88:89], v[88:89], v[112:113]
    v_pk_add_f32 v[90:91], v[90:91], v[114:115]
    s_waitcnt vmcnt(0)
    v_pk_add_f32 v[80:81], v[80:81], v[116:117]
    v_pk_add_f32 v[82:83], v[82:83], v[118:119]
    v_pk_add_f32 v[84:85], v[84:85], v[120:121]
    v_pk_add_f32 v[86:87], v[86:87], v[122:123]
    v_pk_add_f32 v[88:89], v[88:89], v[124:125]
    v_pk_add_f32 v[90:91], v[90:91], v[126:127]
    v_cvt_pk_bf16_f32 v16, v80, v81
    v_lshlrev_b32 v80, 16, v16
    v_and_b32 v81, s76, v16
    v_mul_f32 v80, v8, v80
    v_mul_f32 v81, v8, v81
    v_cvt_pk_bf16_f32 v16, v80, v81
    v_lshlrev_b32 v80, 16, v16
    v_and_b32 v81, s76, v16
    v_cvt_pk_bf16_f32 v16, v82, v83
    v_lshlrev_b32 v82, 16, v16
    v_and_b32 v83, s76, v16
    v_mul_f32 v82, v8, v82
    v_mul_f32 v83, v8, v83
    v_cvt_pk_bf16_f32 v16, v82, v83
    v_lshlrev_b32 v82, 16, v16
    v_and_b32 v83, s76, v16
    v_cvt_pk_bf16_f32 v16, v84, v85
    v_lshlrev_b32 v84, 16, v16
    v_and_b32 v85, s76, v16
    v_mul_f32 v84, v8, v84
    v_mul_f32 v85, v8, v85
    v_cvt_pk_bf16_f32 v16, v84, v85
    v_lshlrev_b32 v84, 16, v16
    v_and_b32 v85, s76, v16
    v_cvt_pk_bf16_f32 v16, v86, v87
    v_lshlrev_b32 v86, 16, v16
    v_and_b32 v87, s76, v16
    v_mul_f32 v86, v8, v86
    v_mul_f32 v87, v8, v87
    v_cvt_pk_bf16_f32 v16, v86, v87
    v_lshlrev_b32 v86, 16, v16
    v_and_b32 v87, s76, v16
    v_cvt_pk_bf16_f32 v16, v88, v89
    v_lshlrev_b32 v88, 16, v16
    v_and_b32 v89, s76, v16
    v_mul_f32 v88, v8, v88
    v_mul_f32 v89, v8, v89
    v_cvt_pk_bf16_f32 v16, v88, v89
    v_lshlrev_b32 v88, 16, v16
    v_and_b32 v89, s76, v16
    v_cvt_pk_bf16_f32 v16, v90, v91
    v_lshlrev_b32 v90, 16, v16
    v_and_b32 v91, s76, v16
    v_mul_f32 v90, v8, v90
    v_mul_f32 v91, v8, v91
    v_cvt_pk_bf16_f32 v16, v90, v91
    v_lshlrev_b32 v90, 16, v16
    v_and_b32 v91, s76, v16
    v_pk_add_f32 v[32:33], v[32:33], v[80:81]
    v_cvt_pk_bf16_f32 v20, v32, v33
    v_pk_add_f32 v[34:35], v[34:35], v[82:83]
    v_cvt_pk_bf16_f32 v21, v34, v35
    v_pk_add_f32 v[36:37], v[36:37], v[84:85]
    v_cvt_pk_bf16_f32 v22, v36, v37
    v_pk_add_f32 v[38:39], v[38:39], v[86:87]
    v_cvt_pk_bf16_f32 v23, v38, v39
    v_pk_add_f32 v[40:41], v[40:41], v[88:89]
    v_cvt_pk_bf16_f32 v24, v40, v41
    v_pk_add_f32 v[42:43], v[42:43], v[90:91]
    v_cvt_pk_bf16_f32 v25, v42, v43
    buffer_store_dwordx2 v[20:21], v5, s[60:63], s73 offen offset:0
    buffer_store_dwordx2 v[22:23], v5, s[60:63], s73 offen offset:16
    buffer_store_dwordx2 v[24:25], v5, s[60:63], s73 offen offset:32
    s_add_u32 s72, s72, 1179648
    s_add_u32 s73, s73, 73728
    s_add_u32 s74, s74, 256
    s_add_u32 s69, s69, 2
    s_cmp_lt_u32 s69, 64
    s_cbranch_scc1 R_LOOP
    s_branch END
FAIL:
    s_mov_b64 exec, 1
    v_mov_b32 v1, s98
    s_lshl_b32 s99, s4, 2
    buffer_store_dword v1, off, s[48:51], s99 offset:208 sc1
END:
    s_endpgm
.section .rodata,"a"
.p2align 6
.amdhsa_kernel gated_mix__memory_aug_recurrent_mem_tr__memory_aug_recurrent_mem_tr__prompt_kernel
  .amdhsa_next_free_vgpr 512
  .amdhsa_next_free_sgpr 102
  .amdhsa_accum_offset 256
  .amdhsa_group_segment_fixed_size 0
  .amdhsa_kernarg_size 144
  .amdhsa_user_sgpr_count 2
  .amdhsa_user_sgpr_kernarg_segment_ptr 1
  .amdhsa_system_sgpr_workgroup_id_x 1
  .amdhsa_float_denorm_mode_32 3
.end_amdhsa_kernel
```
